```python
import torch

def _softmax(x, axis=-1):
    return torch.softmax(x, dim=axis)

def _gelu(x):
    return torch.nn.functional.gelu(x, approximate='tanh')

def _silu(x):
    return torch.nn.functional.silu(x)

def _sigmoid(x):
    return torch.sigmoid(x)

def _layernorm(x, axis=-1, eps=1e-05):
    m = x.mean(dim=axis, keepdim=True)
    v = x.var(dim=axis, keepdim=True, unbiased=False)
    return (x - m) / torch.sqrt(v + eps)

def _scatter_add(tgt, idx, src, axis=0):
    return tgt.clone().index_add_(axis, idx, src)

def _segment_sum(src, seg, n):
    out = torch.zeros((n,) + src.shape[1:], dtype=src.dtype)
    return out.index_add_(0, seg, src)

def _pad(x, pw):
    flat = tuple((v for pair in reversed(pw) for v in pair))
    return torch.nn.functional.pad(x, flat)
kernel_name = 'standalone__varlen_attn_packed__ragged'

def setup_inputs():

    _w = lambda a: (lambda t: t.to(torch.bfloat16) if t.is_floating_point() else t)(torch.as_tensor(a))
    cu = torch.tensor([0, 992, 1451, 1933, 2583, 3189, 3578, 4512, 5082], dtype=torch.int64)
    T, H, D = (int(cu[-1]), 16, 128)
    return {'q': _w((lambda *s: torch.randn(*s, dtype=torch.bfloat16) * 0.8)(T, H, D)), 'k': _w((lambda *s: torch.randn(*s, dtype=torch.bfloat16) * 0.8)(T, H, D)), 'v': _w((lambda *s: torch.randn(*s, dtype=torch.bfloat16) * 0.05)(T, H, D)), 'cu': _w(cu)}

def reference(q, k, v, cu):
    T, H, D = q.shape
    out = torch.zeros_like(q)
    scale = D ** (-0.5)
    outs = []
    for i in range(len(cu) - 1):
        s, e = (int(cu[i]), int(cu[i + 1]))
        qi, ki, vi = (q[s:e].clone(), k[s:e].clone(), v[s:e].clone())
        p = _softmax(torch.einsum('qhd,khd->hqk', qi, ki) * scale, axis=-1)
        outs.append(torch.einsum('hqk,khd->qhd', p, vi))
    return torch.concatenate(outs, axis=0)
```

```asm
; @launch grid=(256,1,1) block=(256,1,1) lds=157504
.amdgcn_target "amdgcn-amd-amdhsa--gfx950"
.text
.globl standalone__varlen_attn_packed__ragged_kernel
.p2align 12
.fill 832, 4, 0xbf800000
.p2align 8
.type standalone__varlen_attn_packed__ragged_kernel,@function
standalone__varlen_attn_packed__ragged_kernel:
    s_load_dwordx4 s[64:67], s[0:1], 0
    s_load_dwordx2 s[12:13], s[0:1], 16
    s_load_dwordx2 s[16:17], s[0:1], 32
    s_cmp_ge_u32 s2, 256
    s_cbranch_scc1 L_end
    s_getpc_b64 s[58:59]
L_pc:
    s_lshr_b32 s3, s2, 3
    v_lshlrev_b32 v1, 3, v0
    v_lshl_add_u32 v1, s3, 11, v1
    v_min_u32 v1, L_hot_end-L_pc, v1
    v_mov_b32 v3, s59
    v_add_co_u32 v2, vcc, s58, v1
    s_nop 1
    v_addc_co_u32 v3, vcc, 0, v3, vcc
    global_load_dword a165, v[2:3], off
    v_lshrrev_b32_e64 v1, 6, v0
    v_and_b32 v0, 63, v0
    v_readfirstlane_b32 s20, v1
    s_and_b32 s21, s2, 7
    s_bfe_u32 s3, s2, 65539
    s_lshl1_add_u32 s21, s21, s3
    s_lshr_b32 s3, s2, 4
    s_mov_b32 s55, 0x5c51478d
    s_cmp_eq_u32 s3, 1
    s_cmov_b32 s55, 0x6674cdfa
    s_cmp_eq_u32 s3, 2
    s_cmov_b32 s55, 0xab4bca17
    s_cmp_eq_u32 s3, 3
    s_cmov_b32 s55, 0x9851478d
    s_cmp_eq_u32 s3, 4
    s_cmov_b32 s55, 0x807c0000
    s_cmp_eq_u32 s3, 5
    s_cmov_b32 s55, 0x827c0000
    s_cmp_eq_u32 s3, 6
    s_cmov_b32 s55, 0x847c0000
    s_cmp_eq_u32 s3, 7
    s_cmov_b32 s55, 0x867c0000
    s_cmp_eq_u32 s3, 8
    s_cmov_b32 s55, 0xa074cdfa
    s_cmp_eq_u32 s3, 9
    s_cmov_b32 s55, 0xa274cdfa
    s_cmp_eq_u32 s3, 10
    s_cmov_b32 s55, 0xa474cdfa
    s_cmp_eq_u32 s3, 11
    s_cmov_b32 s55, 0x684bca17
    s_cmp_eq_u32 s3, 12
    s_cmov_b32 s55, 0x69cbca17
    s_cmp_eq_u32 s3, 13
    s_cmov_b32 s55, 0x9a51478d
    s_cmp_eq_u32 s3, 14
    s_cmov_b32 s55, 0x883c45ab
    s_cmp_eq_u32 s3, 15
    s_cmov_b32 s55, 0x8a3c45ab
    v_lshrrev_b32_e64 v2, 4, v0
    v_and_b32 v3, 15, v0
    v_lshlrev_b32_e64 v4, 15, v2
    v_lshl_add_u32 v4, v3, 4, v4
    s_lshl_b32 s3, s20, 13
    v_add_u32_e64 v250, s3, v4
    v_add_u32 v251, 2944, v250
    v_add_u32 v252, 3056, v250
    v_and_b32_e64 v4, 1, v2
    v_lshlrev_b32_e64 v4, 1, v4
    v_xor_b32 v4, v3, v4
    v_lshlrev_b32_e64 v5, 12, v2
    v_lshl_add_u32 v253, v4, 4, v5
    v_lshl_add_u32 v4, v3, 4, v5
    v_accvgpr_write_b32 a164, v4
    s_mul_i32 s33, s20, 4384
    s_mul_i32 s50, s20, 13056
    s_add_u32 s50, s50, 105216
    s_mov_b32 s54, 0
    s_mov_b32 s10, 0x13da000
    s_mov_b32 s7, 0x20000
    s_mov_b32 s11, 0x20000
    s_mov_b32 s15, 0x20000
    s_mov_b32 s19, 0x20000
L_restart:
    s_and_b32 s40, s55, 0x1fff
    s_bfe_u32 s41, s55, 655373
    s_bfe_u32 s42, s55, 196635
    s_lshl1_add_u32 s42, s42, s21
    s_and_b32 s42, s42, 15
    s_lshl4_add_u32 s42, s40, s42
    s_lshl_b32 s74, s42, 8
    s_sub_u32 s43, s41, 1
    s_and_b32 s44, s43, 31
    s_add_u32 s44, s44, 1
    s_lshl_b32 s75, s44, 12
    s_add_u32 s42, s40, s44
    s_lshl_b32 s42, s42, 12
    s_add_u32 s14, s42, 2176
    s_add_u32 s42, s40, s41
    s_lshl_b32 s6, s42, 12
    s_lshr_b32 s76, s55, 30
    s_add_u32 s76, s76, 2
    s_mul_i32 s42, s76, s20
    s_bfe_u32 s40, s55, 262167
    s_lshl2_add_u32 s42, s40, s42
    s_lshl_b32 s42, s42, 16
    s_add_u32 s73, s74, s42
    s_lshr_b32 s72, s43, 5
    s_add_u32 s72, s72, 1
    s_and_b32 s40, s72, 1
    s_lshl1_add_u32 s76, s76, s40
    s_mov_b32 s22, s74
    s_add_u32 s24, s74, s75
    s_mov_b32 s25, 0x20000
    s_add_u32 s40, s24, s25
    s_bitcmp1_b32 s76, 0
    s_cselect_b32 s23, s24, 2.0
    s_cmov_b32 s24, s40
    s_mov_b32 s49, 0xffea0000
    s_bfe_u32 s3, s74, 131080
    s_cmp_eq_u32 s3, 1
    s_cmov_b32 s49, 0xa8000000
    s_lshr_b32 s3, s2, 3
    s_and_b32 s3, s3, 30
    s_lshr_b32 s49, s49, s3
    s_and_b32 s49, s49, 3
    s_mov_b32 s51, s50
    s_mov_b32 s52, s73
    s_mov_b32 s18, s6
    s_mov_b32 m0, s33
    s_cmp_lg_u32 s54, 0
    s_cbranch_scc1 L_haveptr
    s_waitcnt lgkmcnt(0)
    s_mov_b64 s[4:5], s[64:65]
    s_mov_b64 s[8:9], s[66:67]
    s_sub_u32 s12, s12, 2176
    s_subb_u32 s13, s13, 0
L_haveptr:
    buffer_load_dwordx4 v250, s[8:11], s22 offen offset:0 lds
    buffer_load_dwordx4 v251, s[8:11], s22 offen offset:1152 lds
    s_add_u32 m0, s33, 17536
    s_nop 0
    buffer_load_dwordx4 v250, s[8:11], s23 offen offset:0 lds
    buffer_load_dwordx4 v251, s[8:11], s23 offen offset:1152 lds
    s_cmp_gt_u32 s49, 1
    s_cselect_b64 vcc, -1, 0
    s_cbranch_vccnz L_sk0
    s_mov_b32 m0, s51
    s_addk_i32 s51, 2176
    buffer_load_dwordx4 v253, s[4:7], s52 offen offset:0 nt lds
    s_addk_i32 s52, 15296
    buffer_load_dwordx4 v253, s[4:7], s52 offen offset:1088 nt lds
    s_add_i32 s52, s52, 17472
L_sk0:
    v_mbcnt_lo_u32_b32 v14, -1, 0
    v_mbcnt_hi_u32_b32 v14, -1, v14
    v_bfe_u32 v12, v14, 4, 1
    v_and_b32_e64 v13, 1, v14
    v_lshl_add_u32 v12, v12, 2, v13
    v_lshlrev_b32 v188, 1, v12
    v_mul_u32_u24 v13, 0xaaaa, v13
    v_add_u32 v255, 0x4444, v13
    v_lshrrev_b32 v13, 4, v14
    v_xor_b32 v13, v13, v14
    v_bfe_i32 v13, v13, 1, 1
    v_not_b32 v189, v13
    v_bfe_i32 v3, v14, 1, 1
    v_and_b32 v191, 0x3f803f80, v3
    v_xor_b32 v190, 0x3f803f80, v191
    v_and_b32 v17, v190, v189
    v_and_b32 v18, v191, v189
    v_accvgpr_write_b32 a168, v17
    v_accvgpr_write_b32 a172, v18
    v_accvgpr_write_b32 a132, v190
    v_accvgpr_write_b32 a136, v191
    v_accvgpr_write_b32 a169, v17
    v_accvgpr_write_b32 a173, v18
    v_accvgpr_write_b32 a133, v190
    s_cbranch_vccnz L_sk1
    s_mov_b32 m0, s51
    s_addk_i32 s51, 2176
    buffer_load_dwordx4 v253, s[4:7], s52 offen offset:0 nt lds
    s_addk_i32 s52, 15296
    buffer_load_dwordx4 v253, s[4:7], s52 offen offset:1088 nt lds
    s_add_i32 s52, s52, 17472
L_sk1:
    v_accvgpr_write_b32 a137, v191
    v_accvgpr_write_b32 a170, v17
    v_accvgpr_write_b32 a174, v18
    v_accvgpr_write_b32 a134, v190
    v_accvgpr_write_b32 a138, v191
    v_accvgpr_write_b32 a171, v17
    v_accvgpr_write_b32 a175, v18
    v_accvgpr_write_b32 a135, v190
    v_accvgpr_write_b32 a139, v191
    v_and_b32 v0, 1, v14
    v_lshlrev_b32 v0, 4, v0
    v_mov_b32 v1, 0x3e03
    v_mov_b32 v2, 0xb9d8
    v_lshlrev_b32 v1, v0, v1
    v_lshlrev_b32 v2, v0, v2
    v_and_b32 v4, v1, v3
    v_and_b32 v5, v2, v3
    v_xor_b32 v1, v1, v4
    v_xor_b32 v2, v2, v5
    v_accvgpr_write_b32 a156, v1
    v_accvgpr_write_b32 a157, v4
    v_accvgpr_write_b32 a158, v2
    v_accvgpr_write_b32 a159, v5
    v_mov_b32 v1, 0x3f80
    s_cbranch_vccnz L_sk2
    s_mov_b32 m0, s51
    s_add_i32 s51, s51, 2176
    buffer_load_dwordx4 v253, s[4:7], s52 offen offset:0 nt lds
    s_addk_i32 s52, 15296
    buffer_load_dwordx4 v253, s[4:7], s52 offen offset:1088 nt lds
    s_addk_i32 s52, 17472
L_sk2:
    v_lshlrev_b32 v1, v0, v1
    v_and_b32 v4, v1, v3
    v_xor_b32 v1, v1, v4
    v_bfe_i32 v3, v14, 2, 1
    v_and_b32 v2, v1, v3
    v_and_b32 v5, v4, v3
    v_xor_b32 v1, v1, v2
    v_xor_b32_e64 v4, v4, v5
    v_accvgpr_write_b32 a160, v1
    v_accvgpr_write_b32 a161, v4
    v_accvgpr_write_b32 a162, v2
    v_accvgpr_write_b32 a163, v5
    s_lshl_b64 s[46:47], -1, s44
    s_not_b32 s46, s46
    v_lshrrev_b32 v176, v188, s46
    s_mov_b32 s46, 0xffff
    v_or_b32_e64 v176, v176, v189
    v_bfe_i32 v177, v176, 0, 1
    v_bfe_i32 v178, v176, 1, 1
    v_bfe_i32 v179, v176, 16, 1
    v_bfe_i32 v180, v176, 17, 1
    v_bfe_i32 v181, v176, 4, 1
    v_bfe_i32 v182, v176, 5, 1
    v_bfe_i32 v183, v176, 20, 1
    s_cbranch_vccnz L_sk3
    s_mov_b32 m0, s51
    s_addk_i32 s51, 2176
    buffer_load_dwordx4 v253, s[4:7], s52 offen offset:0 nt lds
    s_addk_i32 s52, 15296
    buffer_load_dwordx4 v253, s[4:7], s52 offen offset:1088 nt lds
    s_add_i32 s52, s52, 17472
L_sk3:
    v_bfe_i32 v184, v176, 21, 1
    v_bfi_b32 v177, s46, v177, v178
    v_bfi_b32 v179, s46, v179, v180
    v_bfi_b32 v181, s46, v181, v182
    v_bfi_b32 v183, s46, v183, v184
    v_and_b32 v178, v177, v191
    v_and_b32 v177, v177, v190
    v_and_b32 v180, v179, v191
    v_and_b32 v179, v179, v190
    v_and_b32 v182, v181, v191
    v_and_b32 v181, v181, v190
    v_and_b32 v184, v183, v191
    v_and_b32 v183, v183, v190
    v_accvgpr_write_b32 a140, v177
    v_accvgpr_write_b32 a144, v178
    v_accvgpr_write_b32 a141, v179
    v_accvgpr_write_b32 a145, v180
    v_accvgpr_write_b32 a142, v181
    v_accvgpr_write_b32 a146, v182
    v_accvgpr_write_b32 a143, v183
    v_accvgpr_write_b32 a147, v184
    v_lshrrev_b32 v2, 4, v14
    v_bfe_u32 v4, v14, 1, 2
    v_mul_u32_u24 v4, 4384, v4
    v_and_b32 v5, 1, v14
    v_mul_u32_u24 v5, 1152, v5
    v_add_u32_e64 v4, v4, v5
    v_bfe_u32 v5, v14, 3, 1
    v_lshl_add_u32 v4, v5, 8, v4
    v_lshl_add_u32 v248, v2, 4, v4
    v_bfe_u32 v4, v14, 3, 2
    v_mul_u32_u24 v4, 4384, v4
    v_bfe_u32 v5, v14, 2, 1
    v_mul_u32_u24 v5, 1040, v5
    v_add_u32 v4, v4, v5
    v_lshrrev_b32 v5, 5, v14
    v_lshl_add_u32 v4, v5, 8, v4
    v_bfe_u32 v5, v14, 1, 1
    v_lshl_add_u32 v4, v5, 7, v4
    v_and_b32 v5, 1, v14
    v_lshl_add_u32 v249, v5, 3, v4
    v_and_b32 v5, 3, v14
    v_mul_u32_u24 v4, 1088, v5
    v_bfe_u32 v6, v14, 2, 2
    v_lshl_add_u32 v4, v6, 8, v4
    v_bfe_u32 v7, v14, 2, 1
    v_lshlrev_b32 v7, 1, v7
    v_xor_b32 v7, v7, v2
    v_lshl_add_u32 v4, v7, 4, v4
    v_add_u32_e64 v254, s50, v4
    v_mov_b64 v[224:225], 0
    v_mov_b64 v[226:227], 0
    v_mov_b64 v[228:229], 0
    v_mov_b64 v[230:231], 0
    v_mov_b64 v[232:233], 0
    v_mov_b64 v[234:235], 0
    v_mov_b64 v[236:237], 0
    v_mov_b64 v[238:239], 0
    v_mov_b64 v[240:241], 0
    v_mov_b64 v[242:243], 0
    v_mov_b64 v[244:245], 0
    v_mov_b64 v[246:247], 0
    s_mov_b32 s80, 35072
    s_mov_b32 s81, 0xfffeee00
    s_mov_b32 s79, 0x17000000
    s_mov_b64 s[64:65], 0
    s_mov_b32 s30, 0
    s_lshr_b32 s34, s72, 1
    s_sub_u32 s34, s34, 2
    s_mov_b32 s57, 0
    s_cbranch_vccz L_q3
    s_waitcnt vmcnt(0)
    s_mov_b32 m0, s51
    s_add_i32 s51, s51, 2176
    buffer_load_dwordx4 v253, s[4:7], s52 offen offset:0 nt lds
    s_addk_i32 s52, 15296
    buffer_load_dwordx4 v253, s[4:7], s52 offen offset:1088 nt lds
    s_addk_i32 s52, 17472
    s_cmp_eq_u32 s49, 2
    s_cbranch_scc1 L_q0b
    s_waitcnt vmcnt(0)
L_q0b:
    s_mov_b32 m0, s51
    s_addk_i32 s51, 2176
    buffer_load_dwordx4 v253, s[4:7], s52 offen offset:0 nt lds
    s_addk_i32 s52, 15296
    buffer_load_dwordx4 v253, s[4:7], s52 offen offset:1088 nt lds
    s_addk_i32 s52, 17472
    s_mov_b32 m0, s51
    s_addk_i32 s51, 2176
    buffer_load_dwordx4 v253, s[4:7], s52 offen offset:0 nt lds
    s_addk_i32 s52, 15296
    buffer_load_dwordx4 v253, s[4:7], s52 offen offset:1088 nt lds
    s_addk_i32 s52, 17472
    s_mov_b32 m0, s51
    s_addk_i32 s51, 2176
    buffer_load_dwordx4 v253, s[4:7], s52 offen offset:0 nt lds
    s_addk_i32 s52, 15296
    buffer_load_dwordx4 v253, s[4:7], s52 offen offset:1088 nt lds
    s_add_i32 s52, s52, 17472
L_q3:
    s_mov_b32 m0, s33
    s_nop 0
    buffer_load_dwordx4 v250, s[12:15], s22 offen offset:2176 lds
    buffer_load_dwordx4 v252, s[12:15], s22 offen offset:3216 lds
    s_add_u32 m0, s33, 17536
    s_mov_b32 s14, 0x13da880
    buffer_load_dwordx4 v250, s[12:15], s23 offen offset:2176 lds
    buffer_load_dwordx4 v252, s[12:15], s23 offen offset:3216 lds
    s_lshr_b32 s3, s2, 4
    s_cmp_lg_u32 s20, 0
    s_cbranch_scc1 L_tw1
    s_bitcmp0_b32 0x1801, s3
    s_cbranch_scc1 L_t0_first1p_3
    s_call_b64 s[62:63], P_first1p_3
L_t0_first1p_3:
    s_bitcmp0_b32 0x2, s3
    s_cbranch_scc1 L_t0_first1s_3
    s_call_b64 s[62:63], P_first1s_3
L_t0_first1s_3:
    s_bitcmp0_b32 0x20fc, s3
    s_cbranch_scc1 L_t0_first1p_4b
    s_call_b64 s[62:63], P_first1p_4b
L_t0_first1p_4b:
    s_bitcmp0_b32 0xc700, s3
    s_cbranch_scc1 L_t0_first1s_4
    s_call_b64 s[62:63], P_first1s_4
L_t0_first1s_4:
    s_branch L_tw4
L_tw1:
    s_cmp_lg_u32 s20, 1
    s_cbranch_scc1 L_tw2
    s_bitcmp0_b32 0xd807, s3
    s_cbranch_scc1 L_t1_loop_3
    s_call_b64 s[62:63], P_loop_3
L_t1_loop_3:
    s_bitcmp0_b32 0x20fc, s3
    s_cbranch_scc1 L_t1_first1p_4c
    s_call_b64 s[62:63], P_first1p_4c
L_t1_first1p_4c:
    s_bitcmp0_b32 0xc700, s3
    s_cbranch_scc1 L_t1_loop_4
    s_call_b64 s[62:63], P_loop_4
L_t1_loop_4:
    s_branch L_tw4
L_tw2:
    s_cmp_lg_u32 s20, 2
    s_cbranch_scc1 L_tw3
    s_bitcmp0_b32 0x1803, s3
    s_cbranch_scc1 L_t2_lastm_3
    s_call_b64 s[62:63], P_lastm_3
L_t2_lastm_3:
    s_bitcmp0_b32 0xe00c, s3
    s_cbranch_scc1 L_t2_lastm_4
    s_call_b64 s[62:63], P_lastm_4
L_t2_lastm_4:
    s_bitcmp0_b32 0xe00c, s3
    s_cbranch_scc1 L_t2_lq_4
    s_call_b64 s[62:63], P_lq_4
L_t2_lq_4:
    s_bitcmp0_b32 0x7f0, s3
    s_cbranch_scc1 L_t2_laste_4
    s_call_b64 s[62:63], P_laste_4
L_t2_laste_4:
    s_branch L_tw4
L_tw3:
    s_bitcmp0_b32 0x1801, s3
    s_cbranch_scc1 L_t3_first2s_3
    s_call_b64 s[62:63], P_first2s_3
L_t3_first2s_3:
    s_bitcmp0_b32 0xd805, s3
    s_cbranch_scc1 L_t3_laste_3
    s_call_b64 s[62:63], P_laste_3
L_t3_laste_3:
    s_bitcmp0_b32 0x200a, s3
    s_cbranch_scc1 L_t3_first2p_2
    s_call_b64 s[62:63], P_first2p_2
L_t3_first2p_2:
    s_bitcmp0_b32 0x200a, s3
    s_cbranch_scc1 L_t3_laste_2
    s_call_b64 s[62:63], P_laste_2
L_t3_laste_2:
    s_bitcmp0_b32 0xc004, s3
    s_cbranch_scc1 L_t3_first2p_3
    s_call_b64 s[62:63], P_first2p_3
L_t3_first2p_3:
L_tw4:
    s_mov_b32 s49, s20
    s_cmp_lg_u32 s54, 0
    s_cbranch_scc1 L_maxpass
L_go1:
    s_waitcnt vmcnt(8)
    s_barrier
    ds_read_b128 v[128:131], v254 offset:0
    ds_read_b128 v[132:135], v254 offset:64
    ds_read_b128 v[136:139], v254 offset:128
    ds_read_b128 v[140:143], v254 offset:192
    s_add_u32 m0, s50, 8704
    s_nop 0
    buffer_load_dwordx4 v253, s[4:7], s52 offen offset:0 nt lds
    ds_read_b128 a[0:3], v248 offset:0
    ds_read_b128 a[4:7], v248 offset:64
    s_addk_i32 s52, 15296
    buffer_load_dwordx4 v253, s[4:7], s52 offen offset:1088 nt lds
    ds_read_b128 a[8:11], v248 offset:128
    ds_read_b128 a[12:15], v248 offset:192
    s_waitcnt lgkmcnt(7)
    v_mfma_f32_4x4x4_16b_bf16 v[0:3], a[156:157], v[128:129], 0
    ds_read_b128 a[16:19], v248 offset:704
    v_mfma_f32_4x4x4_16b_bf16 v[4:7], a[156:157], v[130:131], 0
    ds_read_b128 a[20:23], v248 offset:640
    s_waitcnt lgkmcnt(8)
    v_mfma_f32_4x4x4_16b_bf16 v[8:11], a[156:157], v[132:133], 0
    ds_read_b128 a[24:27], v248 offset:576
    v_mfma_f32_4x4x4_16b_bf16 v[0:3], a[158:159], v[128:129], v[0:3]
    ds_read_b128 a[28:31], v248 offset:512
    s_addk_i32 s52, 15296
    buffer_load_dwordx4 v253, s[4:7], s52 offen offset:2176 nt lds
    v_mfma_f32_4x4x4_16b_bf16 v[12:15], a[156:157], v[134:135], 0
    ds_read_b128 a[32:35], v248 offset:17536
    v_mfma_f32_4x4x4_16b_bf16 v[4:7], a[158:159], v[130:131], v[4:7]
    ds_read_b128 a[36:39], v248 offset:17600
    s_waitcnt lgkmcnt(11)
    v_mfma_f32_4x4x4_16b_bf16 v[16:19], a[156:157], v[136:137], 0
    ds_read_b128 a[40:43], v248 offset:17664
    v_cvt_pk_bf16_f32 v128, v0, v1
    v_mfma_f32_4x4x4_16b_bf16 v[8:11], a[158:159], v[132:133], v[8:11]
    ds_read_b128 a[44:47], v248 offset:17728
    v_cvt_pk_bf16_f32 v129, v2, v3
    v_mfma_f32_4x4x4_16b_bf16 v[20:23], a[156:157], v[138:139], 0
    ds_read_b128 a[48:51], v248 offset:18240
    s_addk_i32 s52, 15296
    buffer_load_dwordx4 v253, s[4:7], s52 offen offset:3264 nt lds
    v_cvt_pk_bf16_f32 v130, v4, v5
    v_mfma_f32_4x4x4_16b_bf16 v[12:15], a[158:159], v[134:135], v[12:15]
    ds_read_b128 a[52:55], v248 offset:18176
    v_cvt_pk_bf16_f32 v131, v6, v7
    s_waitcnt lgkmcnt(14)
    v_mfma_f32_4x4x4_16b_bf16 v[24:27], a[156:157], v[140:141], 0
    ds_read_b128 a[56:59], v248 offset:18112
    v_cvt_pk_bf16_f32 v132, v8, v9
    v_mfma_f32_4x4x4_16b_bf16 v[16:19], a[158:159], v[136:137], v[16:19]
    ds_read_b128 a[60:63], v248 offset:18048
    v_cvt_pk_bf16_f32 v133, v10, v11
    v_mfma_f32_4x4x4_16b_bf16 v[28:31], a[156:157], v[142:143], 0
    v_cvt_pk_bf16_f32 v134, v12, v13
    v_mfma_f32_4x4x4_16b_bf16 v[20:23], a[158:159], v[138:139], v[20:23]
    v_cvt_pk_bf16_f32 v135, v14, v15
    v_mfma_f32_4x4x4_16b_bf16 v[24:27], a[158:159], v[140:141], v[24:27]
    v_cvt_pk_bf16_f32 v136, v16, v17
    v_mfma_f32_4x4x4_16b_bf16 v[28:31], a[158:159], v[142:143], v[28:31]
    v_cvt_pk_bf16_f32 v137, v18, v19
    v_cvt_pk_bf16_f32 v138, v20, v21
    v_cvt_pk_bf16_f32 v139, v22, v23
    v_cvt_pk_bf16_f32 v140, v24, v25
    v_cvt_pk_bf16_f32 v141, v26, v27
    v_cvt_pk_bf16_f32 v142, v28, v29
    v_cvt_pk_bf16_f32 v143, v30, v31
    s_cmp_eq_u32 s76, 8
    s_cbranch_scc1 L_first1s_4
    s_cmp_eq_u32 s76, 7
    s_cbranch_scc1 L_first1p_3
    s_cmp_eq_u32 s76, 6
    s_cbranch_scc1 L_first1s_3
L_first1p_4:
    s_waitcnt lgkmcnt(8)
    v_mfma_f32_16x16x32_bf16 v[192:195], a[0:3], v[128:131], v[224:227]
    s_lshr_b32 s3, s2, 4
    s_mov_b32 s56, 0
    s_cmp_eq_u32 s3, 0
    v_mfma_f32_16x16x32_bf16 v[192:195], a[4:7], v[132:135], v[192:195]
    s_cmov_b32 s56, 0x704751a0
    s_cmp_eq_u32 s3, 1
    s_cmov_b32 s56, 0x3830ac75
    v_mfma_f32_16x16x32_bf16 v[192:195], a[8:11], v[136:139], v[192:195]
    s_cmp_eq_u32 s3, 2
    s_cmov_b32 s56, 0x7a30ac75
    s_cmp_eq_u32 s3, 3
    v_mfma_f32_16x16x32_bf16 v[192:195], a[12:15], v[140:143], v[192:195]
    s_cmov_b32 s56, 0x133963e0
    s_cmp_eq_u32 s3, 11
    s_cmov_b32 s56, 0x71c751a0
    v_mfma_f32_16x16x32_bf16 v[196:199], a[16:19], v[140:143], v[224:227]
    s_add_u32 m0, s33, 87680
    s_addk_i32 s52, 19648
    s_cmp_eq_u32 s3, 12
    v_mfma_f32_16x16x32_bf16 v[196:199], a[20:23], v[136:139], v[196:199]
    s_cmov_b32 s56, 0x734751a0
    buffer_load_dwordx4 v253, s[4:7], s52 offen offset:0 nt lds
    s_cmp_eq_u32 s3, 13
    s_cmov_b32 s56, 0x3930ac75
    v_mfma_f32_16x16x32_bf16 v[196:199], a[24:27], v[132:135], v[196:199]
    s_waitcnt lgkmcnt(0)
    v_exp_f32 v192, v192
    v_mfma_f32_16x16x32_bf16 v[196:199], a[28:31], v[128:131], v[196:199]
    s_addk_i32 s52, 15296
    buffer_load_dwordx4 v253, s[4:7], s52 offen offset:1088 nt lds
    s_cmp_eq_u32 s3, 14
    s_cmov_b32 s56, 0x503963e0
    v_mfma_f32_16x16x32_bf16 v[200:203], a[32:35], v[128:131], v[224:227]
    s_branch L_first1p_4b
.p2align 12
.p2align 5
P_first1p_3:
    s_setpc_b64 s[62:63]
.fill 1, 4, 0xbf800000
L_first1p_3:
    s_waitcnt lgkmcnt(8)
    v_mfma_f32_16x16x32_bf16 v[192:195], a[0:3], v[128:131], v[224:227]
    s_lshr_b32 s3, s2, 4
    s_mov_b32 s56, 0
    s_cmp_eq_u32 s3, 0
    v_mfma_f32_16x16x32_bf16 v[192:195], a[4:7], v[132:135], v[192:195]
    s_cmov_b32 s56, 0x704751a0
    s_cmp_eq_u32 s3, 1
    s_cmov_b32 s56, 0x3830ac75
    v_mfma_f32_16x16x32_bf16 v[192:195], a[8:11], v[136:139], v[192:195]
    s_cmp_eq_u32 s3, 2
    s_cmov_b32 s56, 0x7a30ac75
    s_cmp_eq_u32 s3, 3
    v_mfma_f32_16x16x32_bf16 v[192:195], a[12:15], v[140:143], v[192:195]
    s_cmov_b32 s56, 0x133963e0
    s_cmp_eq_u32 s3, 11
    s_cmov_b32 s56, 0x71c751a0
    v_mfma_f32_16x16x32_bf16 v[196:199], a[16:19], v[140:143], v[224:227]
    s_mov_b32 s22, s24
    s_add_u32 s23, s24, s25
    v_mfma_f32_16x16x32_bf16 v[196:199], a[20:23], v[136:139], v[196:199]
    s_add_u32 s24, s23, s25
    v_exp_f32 v192, v192
    s_add_u32 m0, s33, 35072
    v_mfma_f32_16x16x32_bf16 v[196:199], a[24:27], v[132:135], v[196:199]
    s_waitcnt lgkmcnt(0)
    buffer_load_dwordx4 v250, s[8:11], s22 offen offset:0 lds
    s_cmp_eq_u32 s3, 12
    s_cmov_b32 s56, 0x734751a0
    v_mfma_f32_16x16x32_bf16 v[196:199], a[28:31], v[128:131], v[196:199]
    s_cmp_eq_u32 s3, 13
    v_exp_f32_e64 v193, v193
    v_mfma_f32_16x16x32_bf16 v[200:203], a[32:35], v[128:131], v[224:227]
    s_waitcnt vmcnt(9)
    ds_read_b128 v[144:147], v254 offset:4352
    ds_read_b128 v[148:151], v254 offset:4416
    buffer_load_dwordx4 v251, s[8:11], s22 offen offset:1152 lds
    s_cmov_b32 s56, 0x3930ac75
    v_mfma_f32_16x16x32_bf16 v[200:203], a[36:39], v[132:135], v[200:203]
    s_add_u32 m0, s33, 52608
    ds_read_b128 v[152:155], v254 offset:4480
    ds_read_b128 v[156:159], v254 offset:4544
    v_mfma_f32_16x16x32_bf16 v[200:203], a[40:43], v[136:139], v[200:203]
    s_cmp_eq_u32 s3, 14
    buffer_load_dwordx4 v250, s[8:11], s23 offen offset:0 lds
    s_cmov_b32 s56, 0x503963e0
    s_cmp_eq_u32 s3, 15
    v_mfma_f32_16x16x32_bf16 v[200:203], a[44:47], v[140:143], v[200:203]
    s_cmov_b32 s56, 0x51b963e0
    v_exp_f32_e64 v194, v194
    v_mfma_f32_16x16x32_bf16 v[204:207], a[48:51], v[140:143], v[224:227]
    s_and_b32 s40, s56, 0x1fff
    buffer_load_dwordx4 v251, s[8:11], s23 offen offset:1152 lds
    s_bfe_u32 s41, s56, 655373
    s_bfe_u32 s42, s56, 196635
    v_mfma_f32_16x16x32_bf16 v[204:207], a[52:55], v[136:139], v[204:207]
    s_lshl1_add_u32 s42, s42, s21
    v_cvt_pk_bf16_f32 v100, v192, v193
    v_exp_f32 v195, v195
    v_mfma_f32_16x16x32_bf16 v[204:207], a[56:59], v[132:135], v[204:207]
    s_and_b32 s42, s42, 15
    v_exp_f32 v196, v196
    v_mfma_f32_16x16x32_bf16 v[204:207], a[60:63], v[128:131], v[204:207]
    s_waitcnt lgkmcnt(0)
    v_cvt_pk_bf16_f32 v101, v194, v195
    v_exp_f32 v197, v197
    v_mfma_f32_4x4x4_16b_bf16 v[32:35], a[156:157], v[144:145], 0
    v_exp_f32 v198, v198
    v_mfma_f32_4x4x4_16b_bf16 v[36:39], a[156:157], v[146:147], 0
    v_cvt_pk_bf16_f32 v102, v196, v197
    v_mfma_f32_4x4x4_16b_bf16 v[40:43], a[156:157], v[148:149], 0
    v_exp_f32 v199, v199
    v_mfma_f32_4x4x4_16b_bf16 v[32:35], a[158:159], v[144:145], v[32:35]
    v_exp_f32_e64 v200, v200
    v_mfma_f32_4x4x4_16b_bf16 v[44:47], a[156:157], v[150:151], 0
    v_cvt_pk_bf16_f32 v103, v198, v199
    v_mfma_f32_4x4x4_16b_bf16 v[36:39], a[158:159], v[146:147], v[36:39]
    v_exp_f32_e64 v201, v201
    v_mfma_f32_4x4x4_16b_bf16 v[48:51], a[156:157], v[152:153], 0
    v_cvt_pk_bf16_f32 v144, v32, v33
    v_mfma_f32_4x4x4_16b_bf16 v[40:43], a[158:159], v[148:149], v[40:43]
    v_cvt_pk_bf16_f32 v145, v34, v35
    v_mfma_f32_4x4x4_16b_bf16 v[52:55], a[156:157], v[154:155], 0
    v_cvt_pk_bf16_f32 v146, v36, v37
    v_mfma_f32_4x4x4_16b_bf16 v[44:47], a[158:159], v[150:151], v[44:47]
    v_cvt_pk_bf16_f32 v147, v38, v39
    v_mfma_f32_4x4x4_16b_bf16 v[56:59], a[156:157], v[156:157], 0
    v_cvt_pk_bf16_f32 v148, v40, v41
    v_mfma_f32_4x4x4_16b_bf16 v[48:51], a[158:159], v[152:153], v[48:51]
    v_cvt_pk_bf16_f32 v149, v42, v43
    v_mfma_f32_4x4x4_16b_bf16 v[60:63], a[156:157], v[158:159], 0
    v_cvt_pk_bf16_f32 v150, v44, v45
    v_mfma_f32_4x4x4_16b_bf16 v[52:55], a[158:159], v[154:155], v[52:55]
    v_cvt_pk_bf16_f32 v151, v46, v47
    v_mfma_f32_4x4x4_16b_bf16 v[56:59], a[158:159], v[156:157], v[56:59]
    v_cvt_pk_bf16_f32 v152, v48, v49
    v_mfma_f32_4x4x4_16b_bf16 v[60:63], a[158:159], v[158:159], v[60:63]
    v_exp_f32 v202, v202
    v_cvt_pk_bf16_f32 v96, v200, v201
    v_exp_f32 v203, v203
    v_exp_f32_e64 v204, v204
    v_cvt_pk_bf16_f32 v97, v202, v203
    v_exp_f32 v205, v205
    v_exp_f32 v206, v206
    v_cvt_pk_bf16_f32 v98, v204, v205
    v_exp_f32_e64 v207, v207
    v_cvt_pk_bf16_f32 v153, v50, v51
    v_cvt_pk_bf16_f32 v99, v206, v207
    v_cvt_pk_bf16_f32 v154, v52, v53
    v_cvt_pk_bf16_f32 v155, v54, v55
    v_cvt_pk_bf16_f32 v156, v56, v57
    v_cvt_pk_bf16_f32 v157, v58, v59
    v_cvt_pk_bf16_f32 v158, v60, v61
    v_cvt_pk_bf16_f32 v159, v62, v63
    s_waitcnt vmcnt(8)
    s_barrier
    v_mfma_f32_16x16x32_bf16 v[192:195], a[0:3], v[144:147], v[228:231]
    s_add_u32 m0, s33, 35072
    ds_read_b64_tr_b16 a[64:65], v249 offset:2176
    ds_read_b64_tr_b16 a[66:67], v249 offset:2688
    v_mfma_f32_16x16x32_bf16 v[192:195], a[4:7], v[148:151], v[192:195]
    s_add_u32 s31, s30, s33
    ds_read_b64_tr_b16 a[68:69], v249 offset:19712
    ds_read_b64_tr_b16 a[70:71], v249 offset:20224
    buffer_load_dwordx4 v250, s[12:15], s22 offen offset:2176 lds
    s_lshl4_add_u32 s42, s40, s42
    s_lshl_b32 s26, s42, 8
    v_mfma_f32_16x16x32_bf16 v[192:195], a[8:11], v[152:155], v[192:195]
    s_add_u32 s30, s30, s80
    ds_read_b64_tr_b16 a[72:73], v249 offset:19728
    ds_read_b64_tr_b16 a[74:75], v249 offset:20240
    v_mfma_f32_16x16x32_bf16 v[192:195], a[12:15], v[156:159], v[192:195]
    s_cmp_eq_u32 s30, 105216
    ds_read_b64_tr_b16 a[76:77], v249 offset:2192
    ds_read_b64_tr_b16 a[78:79], v249 offset:2704
    buffer_load_dwordx4 v252, s[12:15], s22 offen offset:3216 lds
    v_mfma_f32_16x16x32_bf16 v[196:199], a[16:19], v[156:159], v[228:231]
    s_cmov_b32 s30, 0
    ds_read_b64_tr_b16 a[80:81], v249 offset:2208
    ds_read_b64_tr_b16 a[82:83], v249 offset:2720
    v_mfma_f32_16x16x32_bf16 v[196:199], a[20:23], v[152:155], v[196:199]
    s_cselect_b32 s35, s81, s80
    s_add_u32 m0, s33, 52608
    ds_read_b64_tr_b16 a[84:85], v249 offset:19744
    ds_read_b64_tr_b16 a[86:87], v249 offset:20256
    v_mfma_f32_16x16x32_bf16 v[196:199], a[24:27], v[148:151], v[196:199]
    s_sub_u32 s43, s41, 1
    ds_read_b64_tr_b16 a[88:89], v249 offset:19760
    ds_read_b64_tr_b16 a[90:91], v249 offset:20272
    buffer_load_dwordx4 v250, s[12:15], s23 offen offset:2176 lds
    s_and_b32 s44, s43, 31
    s_add_u32 s44, s44, 1
    v_mfma_f32_16x16x32_bf16 v[196:199], a[28:31], v[144:147], v[196:199]
    s_lshl_b64 s[46:47], -1, s44
    ds_read_b64_tr_b16 a[92:93], v249 offset:2224
    ds_read_b64_tr_b16 a[94:95], v249 offset:2736
    v_mfma_f32_16x16x32_bf16 v[200:203], a[32:35], v[144:147], v[228:231]
    s_not_b32 s46, s46
    ds_read_b64_tr_b16 a[96:97], v249 offset:2240
    ds_read_b64_tr_b16 a[98:99], v249 offset:2752
    buffer_load_dwordx4 v252, s[12:15], s23 offen offset:3216 lds
    v_mfma_f32_16x16x32_bf16 v[200:203], a[36:39], v[148:151], v[200:203]
    s_nop 0
    ds_read_b64_tr_b16 a[100:101], v249 offset:19776
    ds_read_b64_tr_b16 a[102:103], v249 offset:20288
    v_mfma_f32_16x16x32_bf16 v[200:203], a[40:43], v[152:155], v[200:203]
    ds_read_b64_tr_b16 a[104:105], v249 offset:19792
    ds_read_b64_tr_b16 a[106:107], v249 offset:20304
    v_mfma_f32_16x16x32_bf16 v[200:203], a[44:47], v[156:159], v[200:203]
    ds_read_b64_tr_b16 a[108:109], v249 offset:2256
    ds_read_b64_tr_b16 a[110:111], v249 offset:2768
    v_mfma_f32_16x16x32_bf16 v[204:207], a[48:51], v[156:159], v[228:231]
    ds_read_b64_tr_b16 a[112:113], v249 offset:2272
    ds_read_b64_tr_b16 a[114:115], v249 offset:2784
    v_mfma_f32_16x16x32_bf16 v[204:207], a[52:55], v[152:155], v[204:207]
    ds_read_b64_tr_b16 a[116:117], v249 offset:19808
    ds_read_b64_tr_b16 a[118:119], v249 offset:20320
    v_mfma_f32_16x16x32_bf16 v[204:207], a[56:59], v[148:151], v[204:207]
    ds_read_b64_tr_b16 a[120:121], v249 offset:19824
    ds_read_b64_tr_b16 a[122:123], v249 offset:20336
    v_mfma_f32_16x16x32_bf16 v[204:207], a[60:63], v[144:147], v[204:207]
    s_waitcnt lgkmcnt(15)
    ds_read_b64_tr_b16 a[124:125], v249 offset:2288
    ds_read_b64_tr_b16 a[126:127], v249 offset:2800
    v_mfma_f32_16x16x32_bf16 v[0:3], v[100:103], a[64:67], 0
    v_exp_f32 v192, v192
    v_mfma_f32_16x16x32_bf16 v[0:3], v[96:99], a[68:71], v[0:3]
    v_exp_f32_e64 v193, v193
    v_mfma_f32_16x16x32_bf16 v[4:7], v[96:99], a[72:75], 0
    v_exp_f32_e64 v194, v194
    v_mfma_f32_16x16x32_bf16 v[4:7], v[100:103], a[76:79], v[4:7]
    v_lshrrev_b32 v176, v188, s46
    v_cvt_pk_bf16_f32 v104, v192, v193
    v_mfma_f32_16x16x32_bf16 v[8:11], v[100:103], a[80:83], 0
    s_mov_b32 s46, 0xffff
    v_exp_f32 v195, v195
    v_mfma_f32_16x16x32_bf16 v[8:11], v[96:99], a[84:87], v[8:11]
    s_waitcnt lgkmcnt(15)
    v_exp_f32_e64 v196, v196
    v_mfma_f32_16x16x32_bf16 v[12:15], v[96:99], a[88:91], 0
    v_or_b32 v176, v176, v189
    v_cvt_pk_bf16_f32 v105, v194, v195
    v_mfma_f32_16x16x32_bf16 v[12:15], v[100:103], a[92:95], v[12:15]
    s_waitcnt lgkmcnt(12)
    v_exp_f32_e64 v197, v197
    v_mfma_f32_16x16x32_bf16 v[16:19], v[100:103], a[96:99], 0
    v_exp_f32_e64 v198, v198
    v_mfma_f32_16x16x32_bf16 v[16:19], v[96:99], a[100:103], v[16:19]
    s_waitcnt vmcnt(8)
    s_waitcnt lgkmcnt(8)
    ds_read_b128 v[160:163], v254 offset:8704
    ds_read_b128 v[164:167], v254 offset:8768
    v_mfma_f32_16x16x32_bf16 v[20:23], v[96:99], a[104:107], 0
    s_nop 0
    ds_read_b128 v[168:171], v254 offset:8832
    ds_read_b128 v[172:175], v254 offset:8896
    v_mfma_f32_16x16x32_bf16 v[20:23], v[100:103], a[108:111], v[20:23]
    s_waitcnt lgkmcnt(8)
    v_bfe_i32 v177, v176, 0, 1
    v_cvt_pk_bf16_f32 v106, v196, v197
    v_mfma_f32_16x16x32_bf16 v[24:27], v[100:103], a[112:115], 0
    v_exp_f32_e64 v199, v199
    v_mfma_f32_16x16x32_bf16 v[24:27], v[96:99], a[116:119], v[24:27]
    s_waitcnt lgkmcnt(1)
    v_exp_f32_e64 v200, v200
    v_mfma_f32_16x16x32_bf16 v[28:31], v[96:99], a[120:123], 0
    s_nop 0
    v_bfe_i32 v178, v176, 1, 1
    v_cvt_pk_bf16_f32 v107, v198, v199
    v_mfma_f32_16x16x32_bf16 v[28:31], v[100:103], a[124:127], v[28:31]
    v_exp_f32_e64 v201, v201
    v_smfmac_f32_16x16x64_bf16 v[240:243], a[140:143], v[96:103], v255
    s_waitcnt lgkmcnt(0)
    v_exp_f32 v202, v202
    v_mfma_f32_4x4x4_16b_bf16 v[64:67], a[156:157], v[160:161], 0
    v_cvt_pk_bf16_f32 v108, v200, v201
    v_mfma_f32_4x4x4_16b_bf16 v[68:71], a[156:157], v[162:163], 0
    v_exp_f32_e64 v203, v203
    v_mfma_f32_4x4x4_16b_bf16 v[72:75], a[156:157], v[164:165], 0
    v_exp_f32_e64 v204, v204
    v_mfma_f32_4x4x4_16b_bf16 v[64:67], a[158:159], v[160:161], v[64:67]
    v_cvt_pk_bf16_f32 v109, v202, v203
    v_mfma_f32_4x4x4_16b_bf16 v[76:79], a[156:157], v[166:167], 0
    v_exp_f32_e64 v205, v205
    v_mfma_f32_4x4x4_16b_bf16 v[68:71], a[158:159], v[162:163], v[68:71]
    v_exp_f32_e64 v206, v206
    v_mfma_f32_4x4x4_16b_bf16 v[80:83], a[156:157], v[168:169], 0
    v_cvt_pk_bf16_f32 v160, v64, v65
    v_mfma_f32_4x4x4_16b_bf16 v[72:75], a[158:159], v[164:165], v[72:75]
    v_cvt_pk_bf16_f32 v161, v66, v67
    v_mfma_f32_4x4x4_16b_bf16 v[84:87], a[156:157], v[170:171], 0
    v_cvt_pk_bf16_f32 v162, v68, v69
    v_mfma_f32_4x4x4_16b_bf16 v[76:79], a[158:159], v[166:167], v[76:79]
    v_cvt_pk_bf16_f32 v163, v70, v71
    v_mfma_f32_4x4x4_16b_bf16 v[88:91], a[156:157], v[172:173], 0
    v_cvt_pk_bf16_f32 v164, v72, v73
    v_mfma_f32_4x4x4_16b_bf16 v[80:83], a[158:159], v[168:169], v[80:83]
    v_cvt_pk_bf16_f32 v165, v74, v75
    v_mfma_f32_4x4x4_16b_bf16 v[92:95], a[156:157], v[174:175], 0
    v_cvt_pk_bf16_f32 v166, v76, v77
    v_mfma_f32_4x4x4_16b_bf16 v[84:87], a[158:159], v[170:171], v[84:87]
    v_cvt_pk_bf16_f32 v167, v78, v79
    v_mfma_f32_4x4x4_16b_bf16 v[88:91], a[158:159], v[172:173], v[88:91]
    v_cvt_pk_bf16_f32 v168, v80, v81
    v_mfma_f32_4x4x4_16b_bf16 v[92:95], a[158:159], v[174:175], v[92:95]
    v_cvt_pk_bf16_f32 v169, v82, v83
    v_cvt_pk_bf16_f32 v170, v84, v85
    v_cvt_pk_bf16_f32 v171, v86, v87
    v_cvt_pk_bf16_f32 v172, v88, v89
    v_cvt_pk_bf16_f32 v173, v90, v91
    v_cvt_pk_bf16_f32 v174, v92, v93
    v_cvt_pk_bf16_f32 v175, v94, v95
    v_mfma_f32_16x16x32_bf16 v[192:195], a[0:3], v[160:163], v[232:235]
    s_mov_b32 s22, s24
    v_cvt_pk_bf16_f32 v110, v204, v205
    s_add_u32 s23, s24, s25
    v_mfma_f32_16x16x32_bf16 v[192:195], a[4:7], v[164:167], v[192:195]
    s_add_u32 s24, s23, s25
    v_bfe_i32 v179, v176, 16, 1
    s_add_u32 m0, s33, 70144
    v_mfma_f32_16x16x32_bf16 v[192:195], a[8:11], v[168:171], v[192:195]
    s_nop 0
    buffer_load_dwordx4 v250, s[8:11], s22 offen offset:0 lds
    v_mfma_f32_16x16x32_bf16 v[192:195], a[12:15], v[172:175], v[192:195]
    v_exp_f32_e64 v207, v207
    v_mfma_f32_16x16x32_bf16 v[196:199], a[16:19], v[172:175], v[232:235]
    buffer_load_dwordx4 v251, s[8:11], s22 offen offset:1152 lds
    v_mfma_f32_16x16x32_bf16 v[196:199], a[20:23], v[168:171], v[196:199]
    v_bfe_i32 v180, v176, 17, 1
    v_cvt_pk_bf16_f32 v111, v206, v207
    v_mfma_f32_16x16x32_bf16 v[196:199], a[24:27], v[164:167], v[196:199]
    buffer_load_dwordx4 v250, s[12:15], s22 offen offset:2176 lds
    v_mfma_f32_16x16x32_bf16 v[196:199], a[28:31], v[160:163], v[196:199]
    v_exp_f32_e64 v192, v192
    v_mfma_f32_16x16x32_bf16 v[200:203], a[32:35], v[160:163], v[232:235]
    buffer_load_dwordx4 v252, s[12:15], s22 offen offset:3216 lds
    v_mfma_f32_16x16x32_bf16 v[200:203], a[36:39], v[164:167], v[200:203]
    v_exp_f32_e64 v193, v193
    v_mfma_f32_16x16x32_bf16 v[200:203], a[40:43], v[168:171], v[200:203]
    v_exp_f32 v194, v194
    v_mfma_f32_16x16x32_bf16 v[200:203], a[44:47], v[172:175], v[200:203]
    v_cvt_pk_bf16_f32 v116, v192, v193
    v_exp_f32 v195, v195
    v_mfma_f32_16x16x32_bf16 v[204:207], a[48:51], v[172:175], v[232:235]
    v_exp_f32 v196, v196
    v_mfma_f32_16x16x32_bf16 v[204:207], a[52:55], v[168:171], v[204:207]
    v_cvt_pk_bf16_f32 v117, v194, v195
    v_add_u32 v248, s35, v248
    v_mfma_f32_16x16x32_bf16 v[204:207], a[56:59], v[164:167], v[204:207]
    v_exp_f32 v197, v197
    v_mfma_f32_16x16x32_bf16 v[204:207], a[60:63], v[160:163], v[204:207]
    s_waitcnt vmcnt(8)
    v_exp_f32 v198, v198
    s_barrier
    v_mfma_f32_16x16x32_bf16 v[32:35], v[104:107], a[64:67], 0
    s_add_u32 m0, s33, 87680
    ds_read_b128 a[0:3], v248 offset:0
    v_cvt_pk_bf16_f32 v118, v196, v197
    v_mfma_f32_16x16x32_bf16 v[32:35], v[108:111], a[68:71], v[32:35]
    ds_read_b128 a[4:7], v248 offset:64
    buffer_load_dwordx4 v250, s[8:11], s23 offen offset:0 lds
    v_mfma_f32_16x16x32_bf16 v[36:39], v[108:111], a[72:75], 0
    ds_read_b128 a[8:11], v248 offset:128
    v_exp_f32_e64 v199, v199
    v_mfma_f32_16x16x32_bf16 v[36:39], v[104:107], a[76:79], v[36:39]
    ds_read_b128 a[12:15], v248 offset:192
    buffer_load_dwordx4 v251, s[8:11], s23 offen offset:1152 lds
    v_mfma_f32_16x16x32_bf16 v[40:43], v[104:107], a[80:83], 0
    ds_read_b128 a[16:19], v248 offset:704
    v_exp_f32_e64 v200, v200
    v_mfma_f32_16x16x32_bf16 v[40:43], v[108:111], a[84:87], v[40:43]
    ds_read_b128 a[20:23], v248 offset:640
    buffer_load_dwordx4 v250, s[12:15], s23 offen offset:2176 lds
    v_mfma_f32_16x16x32_bf16 v[44:47], v[108:111], a[88:91], 0
    ds_read_b128 a[24:27], v248 offset:576
    v_cvt_pk_bf16_f32 v119, v198, v199
    v_mfma_f32_16x16x32_bf16 v[44:47], v[104:107], a[92:95], v[44:47]
    ds_read_b128 a[28:31], v248 offset:512
    buffer_load_dwordx4 v252, s[12:15], s23 offen offset:3216 lds
    v_mfma_f32_16x16x32_bf16 v[48:51], v[104:107], a[96:99], 0
    ds_read_b128 a[32:35], v248 offset:17536
    v_exp_f32_e64 v201, v201
    v_mfma_f32_16x16x32_bf16 v[48:51], v[108:111], a[100:103], v[48:51]
    ds_read_b128 a[36:39], v248 offset:17600
    v_exp_f32_e64 v202, v202
    v_mfma_f32_16x16x32_bf16 v[52:55], v[108:111], a[104:107], 0
    ds_read_b128 a[40:43], v248 offset:17664
    v_cvt_pk_bf16_f32 v112, v200, v201
    v_mfma_f32_16x16x32_bf16 v[52:55], v[104:107], a[108:111], v[52:55]
    ds_read_b128 a[44:47], v248 offset:17728
    v_exp_f32 v203, v203
    v_mfma_f32_16x16x32_bf16 v[56:59], v[104:107], a[112:115], 0
    ds_read_b128 a[48:51], v248 offset:18240
    v_exp_f32 v204, v204
    v_mfma_f32_16x16x32_bf16 v[56:59], v[108:111], a[116:119], v[56:59]
    ds_read_b128 a[52:55], v248 offset:18176
    v_cvt_pk_bf16_f32 v113, v202, v203
    v_mfma_f32_16x16x32_bf16 v[60:63], v[108:111], a[120:123], 0
    ds_read_b128 a[56:59], v248 offset:18112
    v_exp_f32 v205, v205
    v_mfma_f32_16x16x32_bf16 v[60:63], v[104:107], a[124:127], v[60:63]
    ds_read_b128 a[60:63], v248 offset:18048
    v_exp_f32 v206, v206
    v_smfmac_f32_16x16x64_bf16 v[240:243], a[144:147], v[104:111], v255
    s_waitcnt lgkmcnt(12)
    v_cvt_pk_bf16_f32 v114, v204, v205
    v_mfma_f32_16x16x32_bf16 v[192:195], a[0:3], v[128:131], v[224:227]
    s_mov_b32 s22, s24
    v_bfe_i32 v181, v176, 4, 1
    s_add_u32 s23, s24, s25
    v_mfma_f32_16x16x32_bf16 v[192:195], a[4:7], v[132:135], v[192:195]
    s_add_u32 s24, s23, s25
    s_mov_b32 s32, s31
    v_add_u32 v249, s35, v249
    v_mfma_f32_16x16x32_bf16 v[192:195], a[8:11], v[136:139], v[192:195]
    s_mov_b32 m0, s31
    v_exp_f32 v207, v207
    v_mfma_f32_16x16x32_bf16 v[192:195], a[12:15], v[140:143], v[192:195]
    v_bfe_i32 v182, v176, 5, 1
    v_bfe_i32 v183, v176, 20, 1
    v_bfe_i32 v184, v176, 21, 1
    v_bfi_b32 v177, s46, v177, v178
    v_bfi_b32 v179, s46, v179, v180
    v_bfi_b32 v181, s46, v181, v182
    v_bfi_b32 v183, s46, v183, v184
    v_and_b32 v178, v177, v191
    v_and_b32 v177, v177, v190
    v_and_b32 v180, v179, v191
    v_and_b32 v179, v179, v190
    v_and_b32 v182, v181, v191
    v_and_b32 v181, v181, v190
    v_and_b32 v184, v183, v191
    v_and_b32 v183, v183, v190
    v_accvgpr_write_b32 a148, v177
    v_accvgpr_write_b32 a152, v178
    v_accvgpr_write_b32 a149, v179
    v_accvgpr_write_b32 a153, v180
    v_accvgpr_write_b32 a150, v181
    v_accvgpr_write_b32 a154, v182
    v_accvgpr_write_b32 a151, v183
    v_accvgpr_write_b32 a155, v184
    s_lshl_b32 s77, s44, 12
    s_add_u32 s42, s40, s44
    buffer_load_dwordx4 v250, s[8:11], s22 offen offset:0 lds
    s_lshl_b32 s42, s42, 12
    s_add_u32 s78, s42, 2176
    s_waitcnt lgkmcnt(11)
    v_mfma_f32_16x16x32_bf16 v[196:199], a[16:19], v[140:143], v[224:227]
    s_add_u32 s42, s40, s41
    v_cvt_pk_bf16_f32 v115, v206, v207
    s_lshl_b32 s38, s42, 12
    s_waitcnt lgkmcnt(10)
    v_mfma_f32_16x16x32_bf16 v[196:199], a[20:23], v[136:139], v[196:199]
    s_lshr_b32 s39, s56, 30
    buffer_load_dwordx4 v251, s[8:11], s22 offen offset:1152 lds
    s_add_u32 s39, s39, 2
    s_mul_i32 s42, s39, s20
    s_waitcnt lgkmcnt(9)
    v_mfma_f32_16x16x32_bf16 v[196:199], a[24:27], v[132:135], v[196:199]
    s_bfe_u32 s40, s56, 262167
    v_exp_f32 v192, v192
    s_waitcnt lgkmcnt(8)
    v_mfma_f32_16x16x32_bf16 v[196:199], a[28:31], v[128:131], v[196:199]
    s_waitcnt lgkmcnt(4)
    buffer_load_dwordx4 v250, s[12:15], s22 offen offset:2176 lds
    s_lshl2_add_u32 s42, s40, s42
    s_lshl_b32 s42, s42, 16
    v_mfma_f32_16x16x32_bf16 v[200:203], a[32:35], v[128:131], v[224:227]
    s_add_u32 s37, s26, s42
    v_exp_f32 v193, v193
    v_mfma_f32_16x16x32_bf16 v[200:203], a[36:39], v[132:135], v[200:203]
    s_lshr_b32 s36, s43, 5
    buffer_load_dwordx4 v252, s[12:15], s22 offen offset:3216 lds
    s_add_u32 s36, s36, 1
    s_and_b32 s40, s36, 1
    v_mfma_f32_16x16x32_bf16 v[200:203], a[40:43], v[136:139], v[200:203]
    s_add_i32 s32, s32, 17536
    v_exp_f32_e64 v194, v194
    s_mov_b32 m0, s32
    v_mfma_f32_16x16x32_bf16 v[200:203], a[44:47], v[140:143], v[200:203]
    s_lshl1_add_u32 s39, s39, s40
    s_waitcnt lgkmcnt(0)
    s_mov_b32 s14, 0x13da880
    v_mfma_f32_16x16x32_bf16 v[204:207], a[48:51], v[140:143], v[224:227]
    s_add_u32 s28, s26, s77
    buffer_load_dwordx4 v250, s[8:11], s23 offen offset:0 lds
    s_sub_u32 s40, s36, 2
    s_lshl_b32 s40, s40, 17
    v_mfma_f32_16x16x32_bf16 v[204:207], a[52:55], v[136:139], v[204:207]
    s_add_u32 s40, s40, s28
    v_exp_f32_e64 v195, v195
    v_mfma_f32_16x16x32_bf16 v[204:207], a[56:59], v[132:135], v[204:207]
    s_bitcmp1_b32 0x6800, s3
    buffer_load_dwordx4 v251, s[8:11], s23 offen offset:1152 lds
    s_cmov_b32 s28, s40
    s_cselect_b32 s29, 0xfffe0000, s25
    v_mfma_f32_16x16x32_bf16 v[204:207], a[60:63], v[128:131], v[204:207]
    s_add_u32 s40, s28, s29
    v_cvt_pk_bf16_f32 v100, v192, v193
    v_cvt_pk_bf16_f32 v101, v194, v195
    v_mfma_f32_16x16x32_bf16 v[64:67], v[116:119], a[64:67], 0
    s_bitcmp1_b32 s39, 0
    v_exp_f32 v196, v196
    v_mfma_f32_16x16x32_bf16 v[64:67], v[112:115], a[68:71], v[64:67]
    s_cselect_b32 s27, s28, 2.0
    v_exp_f32 v197, v197
    v_mfma_f32_16x16x32_bf16 v[68:71], v[112:115], a[72:75], 0
    s_cmov_b32 s28, s40
    v_exp_f32 v198, v198
    v_mfma_f32_16x16x32_bf16 v[68:71], v[116:119], a[76:79], v[68:71]
    s_lshr_b32 s41, s76, 3
    v_exp_f32_e64 v199, v199
    v_mfma_f32_16x16x32_bf16 v[72:75], v[116:119], a[80:83], 0
    s_and_b32 s40, s39, -2
    v_cvt_pk_bf16_f32 v102, v196, v197
    v_cvt_pk_bf16_f32 v103, v198, v199
    v_mfma_f32_16x16x32_bf16 v[72:75], v[112:115], a[84:87], v[72:75]
    s_lshr_b32 s40, s40, s41
    v_exp_f32 v200, v200
    v_mfma_f32_16x16x32_bf16 v[76:79], v[112:115], a[88:91], 0
    s_sub_u32 s53, s34, s40
    v_exp_f32_e64 v201, v201
    v_mfma_f32_16x16x32_bf16 v[76:79], v[116:119], a[92:95], v[76:79]
    s_min_u32 s40, s53, 2
    v_exp_f32_e64 v202, v202
    v_mfma_f32_16x16x32_bf16 v[80:83], v[116:119], a[96:99], 0
    s_sub_u32 s53, s53, s40
    v_exp_f32_e64 v203, v203
    v_mfma_f32_16x16x32_bf16 v[80:83], v[112:115], a[100:103], v[80:83]
    s_sub_u32 s3, s34, s40
    v_cvt_pk_bf16_f32 v96, v200, v201
    v_cvt_pk_bf16_f32 v97, v202, v203
    v_mfma_f32_16x16x32_bf16 v[84:87], v[112:115], a[104:107], 0
    s_cmp_eq_u32 s56, 0
    v_exp_f32 v204, v204
    v_mfma_f32_16x16x32_bf16 v[84:87], v[116:119], a[108:111], v[84:87]
    s_cmov_b32 s3, -1
    s_waitcnt vmcnt(14)
    s_barrier
    v_mfma_f32_16x16x32_bf16 v[88:91], v[116:119], a[112:115], 0
    s_cmov_b32 s39, 0
    ds_read_b64_tr_b16 a[64:65], v249 offset:2176
    ds_read_b64_tr_b16 a[66:67], v249 offset:2688
    ds_read_b64_tr_b16 a[68:69], v249 offset:19712
    ds_read_b64_tr_b16 a[70:71], v249 offset:20224
    v_mfma_f32_16x16x32_bf16 v[88:91], v[112:115], a[116:119], v[88:91]
    s_mov_b32 s51, s50
    ds_read_b64_tr_b16 a[72:73], v249 offset:19728
    ds_read_b64_tr_b16 a[74:75], v249 offset:20240
    ds_read_b64_tr_b16 a[76:77], v249 offset:2192
    ds_read_b64_tr_b16 a[78:79], v249 offset:2704
    v_mfma_f32_16x16x32_bf16 v[92:95], v[112:115], a[120:123], 0
    s_mov_b32 s52, s37
    ds_read_b64_tr_b16 a[80:81], v249 offset:2208
    ds_read_b64_tr_b16 a[82:83], v249 offset:2720
    ds_read_b64_tr_b16 a[84:85], v249 offset:19744
    ds_read_b64_tr_b16 a[86:87], v249 offset:20256
    v_mfma_f32_16x16x32_bf16 v[92:95], v[116:119], a[124:127], v[92:95]
    s_mov_b32 s6, s38
    ds_read_b64_tr_b16 a[88:89], v249 offset:19760
    ds_read_b64_tr_b16 a[90:91], v249 offset:20272
    ds_read_b64_tr_b16 a[92:93], v249 offset:2224
    ds_read_b64_tr_b16 a[94:95], v249 offset:2736
    v_smfmac_f32_16x16x64_bf16 v[244:247], a[140:143], v[112:119], v255
    s_cmov_b32 s26, 2.0
    s_cmov_b32 s27, 2.0
    s_cmov_b32 s28, 2.0
    s_branch L_loop_3
.p2align 12
.p2align 5
P_first1s_4:
    s_setpc_b64 s[62:63]
.fill 1, 4, 0xbf800000
L_first1s_4:
    s_waitcnt lgkmcnt(0)
    v_mfma_f32_16x16x32_bf16 v[192:195], a[0:3], v[128:131], v[224:227]
    s_waitcnt vmcnt(8)
    ds_read_b128 v[144:147], v254 offset:4352
    ds_read_b128 v[148:151], v254 offset:4416
    v_mfma_f32_16x16x32_bf16 v[192:195], a[4:7], v[132:135], v[192:195]
    s_lshr_b32 s3, s2, 4
    ds_read_b128 v[152:155], v254 offset:4480
    ds_read_b128 v[156:159], v254 offset:4544
    v_mfma_f32_16x16x32_bf16 v[192:195], a[8:11], v[136:139], v[192:195]
    s_add_u32 m0, s33, 87680
    v_mov_b32 v208, 0
    s_add_i32 s52, s52, 19648
    v_mfma_f32_16x16x32_bf16 v[192:195], a[12:15], v[140:143], v[192:195]
    s_mov_b32 s56, 0
    buffer_load_dwordx4 v253, s[4:7], s52 offen offset:0 nt lds
    s_cmp_eq_u32 s3, 0
    s_cmov_b32 s56, 0x704751a0
    v_mfma_f32_16x16x32_bf16 v[196:199], a[16:19], v[140:143], v[224:227]
    s_addk_i32 s52, 15296
    buffer_load_dwordx4 v253, s[4:7], s52 offen offset:1088 nt lds
    s_cmp_eq_u32 s3, 1
    s_cmov_b32 s56, 0x3830ac75
    v_mfma_f32_16x16x32_bf16 v[196:199], a[20:23], v[136:139], v[196:199]
    s_addk_i32 s52, 15296
    buffer_load_dwordx4 v253, s[4:7], s52 offen offset:2176 nt lds
    s_cmp_eq_u32 s3, 2
    s_cmov_b32 s56, 0x7a30ac75
    v_mfma_f32_16x16x32_bf16 v[196:199], a[24:27], v[132:135], v[196:199]
    s_addk_i32 s52, 15296
    buffer_load_dwordx4 v253, s[4:7], s52 offen offset:3264 nt lds
    s_cmp_eq_u32 s3, 3
    s_cmov_b32 s56, 0x133963e0
    v_mfma_f32_16x16x32_bf16 v[196:199], a[28:31], v[128:131], v[196:199]
    s_waitcnt lgkmcnt(0)
    v_mov_b32 v209, 0
    v_mov_b32 v210, 0
    v_mov_b32 v211, 0
    v_mfma_f32_4x4x4_16b_bf16 v[32:35], a[156:157], v[144:145], 0
    v_mov_b32 v220, 0
    v_mfma_f32_4x4x4_16b_bf16 v[36:39], a[156:157], v[146:147], 0
    v_mov_b32 v221, 0
    v_mfma_f32_4x4x4_16b_bf16 v[40:43], a[156:157], v[148:149], 0
    v_mov_b32_e64 v222, 0
    v_mfma_f32_4x4x4_16b_bf16 v[32:35], a[158:159], v[144:145], v[32:35]
    v_mov_b32 v223, 0
    v_mfma_f32_4x4x4_16b_bf16 v[44:47], a[156:157], v[150:151], 0
    v_exp_f32 v192, v192
    v_mfma_f32_4x4x4_16b_bf16 v[36:39], a[158:159], v[146:147], v[36:39]
    v_exp_f32_e64 v193, v193
    v_mfma_f32_4x4x4_16b_bf16 v[48:51], a[156:157], v[152:153], 0
    v_cvt_pk_bf16_f32 v144, v32, v33
    v_mfma_f32_4x4x4_16b_bf16 v[40:43], a[158:159], v[148:149], v[40:43]
    v_cvt_pk_bf16_f32 v145, v34, v35
    v_mfma_f32_4x4x4_16b_bf16 v[52:55], a[156:157], v[154:155], 0
    v_cvt_pk_bf16_f32 v146, v36, v37
    v_mfma_f32_4x4x4_16b_bf16 v[44:47], a[158:159], v[150:151], v[44:47]
    v_cvt_pk_bf16_f32 v147, v38, v39
    v_mfma_f32_4x4x4_16b_bf16 v[56:59], a[156:157], v[156:157], 0
    v_cvt_pk_bf16_f32 v148, v40, v41
    v_mfma_f32_4x4x4_16b_bf16 v[48:51], a[158:159], v[152:153], v[48:51]
    v_cvt_pk_bf16_f32 v149, v42, v43
    v_mfma_f32_4x4x4_16b_bf16 v[60:63], a[156:157], v[158:159], 0
    v_cvt_pk_bf16_f32 v150, v44, v45
    v_mfma_f32_4x4x4_16b_bf16 v[52:55], a[158:159], v[154:155], v[52:55]
    v_cvt_pk_bf16_f32 v151, v46, v47
    v_mfma_f32_4x4x4_16b_bf16 v[56:59], a[158:159], v[156:157], v[56:59]
    v_cvt_pk_bf16_f32 v152, v48, v49
    v_mfma_f32_4x4x4_16b_bf16 v[60:63], a[158:159], v[158:159], v[60:63]
    v_cvt_pk_bf16_f32 v153, v50, v51
    v_cvt_pk_bf16_f32 v154, v52, v53
    v_cvt_pk_bf16_f32 v155, v54, v55
    v_cvt_pk_bf16_f32 v156, v56, v57
    v_cvt_pk_bf16_f32 v157, v58, v59
    v_cvt_pk_bf16_f32 v158, v60, v61
    v_cvt_pk_bf16_f32 v159, v62, v63
    s_waitcnt vmcnt(8)
    s_barrier
    v_mfma_f32_16x16x32_bf16 v[200:203], a[0:3], v[144:147], v[228:231]
    s_mov_b32 s22, s24
    s_add_u32 s23, s24, s25
    ds_read_b64_tr_b16 a[64:65], v249 offset:2176
    ds_read_b64_tr_b16 a[66:67], v249 offset:2688
    v_mfma_f32_16x16x32_bf16 v[200:203], a[4:7], v[148:151], v[200:203]
    s_add_u32 s31, s30, s33
    v_exp_f32 v194, v194
    v_cvt_pk_bf16_f32 v212, v192, v193
    v_exp_f32 v195, v195
    v_exp_f32 v196, v196
    v_cvt_pk_bf16_f32 v213, v194, v195
    v_exp_f32_e64 v197, v197
    v_exp_f32_e64 v198, v198
    v_cvt_pk_bf16_f32 v214, v196, v197
    v_exp_f32 v199, v199
    s_add_u32 s24, s23, s25
    s_add_u32 m0, s33, 35072
    ds_read_b64_tr_b16 a[76:77], v249 offset:2192
    ds_read_b64_tr_b16 a[78:79], v249 offset:2704
    v_cvt_pk_bf16_f32 v215, v198, v199
    v_mfma_f32_16x16x32_bf16 v[200:203], a[8:11], v[152:155], v[200:203]
    s_add_u32 s30, s30, s80
    ds_read_b64_tr_b16 a[80:81], v249 offset:2208
    ds_read_b64_tr_b16 a[82:83], v249 offset:2720
    buffer_load_dwordx4 v250, s[8:11], s22 offen offset:0 lds
    s_cmp_eq_u32 s3, 11
    s_cmov_b32 s56, 0x71c751a0
    v_mfma_f32_16x16x32_bf16 v[200:203], a[12:15], v[156:159], v[200:203]
    s_cmp_eq_u32 s30, 105216
    ds_read_b64_tr_b16 a[92:93], v249 offset:2224
    ds_read_b64_tr_b16 a[94:95], v249 offset:2736
    buffer_load_dwordx4 v251, s[8:11], s22 offen offset:1152 lds
    v_mfma_f32_16x16x32_bf16 v[204:207], a[16:19], v[156:159], v[228:231]
    s_cmov_b32 s30, 0
    ds_read_b64_tr_b16 a[96:97], v249 offset:2240
    ds_read_b64_tr_b16 a[98:99], v249 offset:2752
    v_mfma_f32_16x16x32_bf16 v[204:207], a[20:23], v[152:155], v[204:207]
    s_cselect_b32 s35, s81, s80
    s_add_u32 m0, s33, 52608
    ds_read_b64_tr_b16 a[108:109], v249 offset:2256
    ds_read_b64_tr_b16 a[110:111], v249 offset:2768
    v_mfma_f32_16x16x32_bf16 v[204:207], a[24:27], v[148:151], v[204:207]
    s_cmp_eq_u32 s3, 12
    ds_read_b64_tr_b16 a[112:113], v249 offset:2272
    ds_read_b64_tr_b16 a[114:115], v249 offset:2784
    buffer_load_dwordx4 v250, s[8:11], s23 offen offset:0 lds
    s_cmov_b32 s56, 0x734751a0
    s_cmp_eq_u32 s3, 13
    v_mfma_f32_16x16x32_bf16 v[204:207], a[28:31], v[144:147], v[204:207]
    s_waitcnt lgkmcnt(10)
    ds_read_b64_tr_b16 a[124:125], v249 offset:2288
    ds_read_b64_tr_b16 a[126:127], v249 offset:2800
    buffer_load_dwordx4 v251, s[8:11], s23 offen offset:1152 lds
    s_cmov_b32 s56, 0x3930ac75
    s_cmp_eq_u32 s3, 14
    v_mfma_f32_16x16x32_bf16 v[0:3], v[212:215], a[64:67], 0
    s_cmov_b32 s56, 0x503963e0
    v_exp_f32_e64 v200, v200
    v_mfma_f32_16x16x32_bf16 v[4:7], v[212:215], a[76:79], 0
    s_waitcnt vmcnt(8)
    s_waitcnt lgkmcnt(8)
    ds_read_b128 v[160:163], v254 offset:8704
    ds_read_b128 v[164:167], v254 offset:8768
    v_mfma_f32_16x16x32_bf16 v[8:11], v[212:215], a[80:83], 0
    s_cmp_eq_u32 s3, 15
    ds_read_b128 v[168:171], v254 offset:8832
    ds_read_b128 v[172:175], v254 offset:8896
    v_mfma_f32_16x16x32_bf16 v[12:15], v[212:215], a[92:95], 0
    s_waitcnt lgkmcnt(8)
    v_exp_f32_e64 v201, v201
    v_mfma_f32_16x16x32_bf16 v[16:19], v[212:215], a[96:99], 0
    s_cmov_b32 s56, 0x51b963e0
    v_exp_f32_e64 v202, v202
    v_mfma_f32_16x16x32_bf16 v[20:23], v[212:215], a[108:111], 0
    s_waitcnt lgkmcnt(2)
    v_cvt_pk_bf16_f32 v216, v200, v201
    v_exp_f32 v203, v203
    v_mfma_f32_16x16x32_bf16 v[24:27], v[212:215], a[112:115], 0
    s_and_b32 s40, s56, 0x1fff
    v_exp_f32_e64 v204, v204
    v_mfma_f32_16x16x32_bf16 v[28:31], v[212:215], a[124:127], 0
    s_bfe_u32 s41, s56, 655373
    v_cvt_pk_bf16_f32 v217, v202, v203
    v_exp_f32 v205, v205
    v_smfmac_f32_16x16x64_bf16 v[240:243], a[140:143], v[208:215], v255
    s_bfe_u32 s42, s56, 196635
    s_waitcnt lgkmcnt(0)
    v_exp_f32 v206, v206
    v_mfma_f32_4x4x4_16b_bf16 v[64:67], a[156:157], v[160:161], 0
    v_cvt_pk_bf16_f32 v218, v204, v205
    v_mfma_f32_4x4x4_16b_bf16 v[68:71], a[156:157], v[162:163], 0
    s_lshl1_add_u32 s42, s42, s21
    v_mfma_f32_4x4x4_16b_bf16 v[72:75], a[156:157], v[164:165], 0
    s_and_b32 s42, s42, 15
    v_mfma_f32_4x4x4_16b_bf16 v[64:67], a[158:159], v[160:161], v[64:67]
    s_lshl4_add_u32 s42, s40, s42
    v_mfma_f32_4x4x4_16b_bf16 v[76:79], a[156:157], v[166:167], 0
    s_lshl_b32 s26, s42, 8
    v_mfma_f32_4x4x4_16b_bf16 v[68:71], a[158:159], v[162:163], v[68:71]
    s_sub_u32 s43, s41, 1
    v_mfma_f32_4x4x4_16b_bf16 v[80:83], a[156:157], v[168:169], 0
    v_cvt_pk_bf16_f32 v160, v64, v65
    v_mfma_f32_4x4x4_16b_bf16 v[72:75], a[158:159], v[164:165], v[72:75]
    v_cvt_pk_bf16_f32 v161, v66, v67
    v_mfma_f32_4x4x4_16b_bf16 v[84:87], a[156:157], v[170:171], 0
    v_cvt_pk_bf16_f32 v162, v68, v69
    v_mfma_f32_4x4x4_16b_bf16 v[76:79], a[158:159], v[166:167], v[76:79]
    v_cvt_pk_bf16_f32 v163, v70, v71
    v_mfma_f32_4x4x4_16b_bf16 v[88:91], a[156:157], v[172:173], 0
    v_cvt_pk_bf16_f32 v164, v72, v73
    v_mfma_f32_4x4x4_16b_bf16 v[80:83], a[158:159], v[168:169], v[80:83]
    v_cvt_pk_bf16_f32 v165, v74, v75
    v_mfma_f32_4x4x4_16b_bf16 v[92:95], a[156:157], v[174:175], 0
    v_cvt_pk_bf16_f32 v166, v76, v77
    v_mfma_f32_4x4x4_16b_bf16 v[84:87], a[158:159], v[170:171], v[84:87]
    v_cvt_pk_bf16_f32 v167, v78, v79
    v_mfma_f32_4x4x4_16b_bf16 v[88:91], a[158:159], v[172:173], v[88:91]
    v_cvt_pk_bf16_f32 v168, v80, v81
    v_mfma_f32_4x4x4_16b_bf16 v[92:95], a[158:159], v[174:175], v[92:95]
    v_cvt_pk_bf16_f32 v169, v82, v83
    v_cvt_pk_bf16_f32 v170, v84, v85
    v_cvt_pk_bf16_f32 v171, v86, v87
    v_cvt_pk_bf16_f32 v172, v88, v89
    v_cvt_pk_bf16_f32 v173, v90, v91
    v_cvt_pk_bf16_f32 v174, v92, v93
    v_cvt_pk_bf16_f32 v175, v94, v95
    v_mfma_f32_16x16x32_bf16 v[192:195], a[0:3], v[160:163], v[232:235]
    s_add_u32 m0, s33, 35072
    v_exp_f32_e64 v207, v207
    v_mfma_f32_16x16x32_bf16 v[192:195], a[4:7], v[164:167], v[192:195]
    s_and_b32 s44, s43, 31
    buffer_load_dwordx4 v250, s[12:15], s22 offen offset:2176 lds
    s_add_u32 s44, s44, 1
    s_lshl_b64 s[46:47], -1, s44
    v_mfma_f32_16x16x32_bf16 v[192:195], a[8:11], v[168:171], v[192:195]
    s_not_b32 s46, s46
    buffer_load_dwordx4 v252, s[12:15], s22 offen offset:3216 lds
    v_mfma_f32_16x16x32_bf16 v[192:195], a[12:15], v[172:175], v[192:195]
    s_add_u32 m0, s33, 52608
    v_lshrrev_b32 v176, v188, s46
    v_cvt_pk_bf16_f32 v219, v206, v207
    v_mfma_f32_16x16x32_bf16 v[196:199], a[16:19], v[172:175], v[232:235]
    s_mov_b32 s46, 0xffff
    buffer_load_dwordx4 v250, s[12:15], s23 offen offset:2176 lds
    v_mfma_f32_16x16x32_bf16 v[196:199], a[20:23], v[168:171], v[196:199]
    s_mulk_i32 s49, -8672
    v_or_b32 v176, v176, v189
    v_bfe_i32 v177, v176, 0, 1
    v_bfe_i32 v178, v176, 1, 1
    v_bfe_i32 v179, v176, 16, 1
    v_bfe_i32 v180, v176, 17, 1
    v_bfe_i32 v181, v176, 4, 1
    v_bfe_i32 v182, v176, 5, 1
    v_bfe_i32 v183, v176, 20, 1
    v_bfe_i32 v184, v176, 21, 1
    v_bfi_b32 v177, s46, v177, v178
    v_bfi_b32 v179, s46, v179, v180
    v_bfi_b32 v181, s46, v181, v182
    v_bfi_b32 v183, s46, v183, v184
    v_and_b32 v178, v177, v191
    v_and_b32 v177, v177, v190
    v_and_b32_e64 v180, v179, v191
    v_and_b32_e64 v179, v179, v190
    v_and_b32_e64 v182, v181, v191
    v_and_b32_e64 v181, v181, v190
    v_and_b32_e64 v184, v183, v191
    v_and_b32_e64 v183, v183, v190
    v_accvgpr_write_b32 a148, v177
    v_accvgpr_write_b32 a152, v178
    v_accvgpr_write_b32 a149, v179
    v_accvgpr_write_b32 a153, v180
    v_accvgpr_write_b32 a150, v181
    v_accvgpr_write_b32 a154, v182
    v_accvgpr_write_b32 a151, v183
    v_accvgpr_write_b32 a155, v184
    s_lshl_b32 s77, s44, 12
    s_add_u32 s49, s49, 0xffffbb80
    buffer_load_dwordx4 v252, s[12:15], s23 offen offset:3216 lds
    s_add_u32 s42, s40, s44
    s_lshl_b32 s42, s42, 12
    v_mfma_f32_16x16x32_bf16 v[196:199], a[24:27], v[164:167], v[196:199]
    s_add_u32 s78, s42, 2176
    v_add_u32_e64 v127, s49, v254
    s_add_u32 s42, s40, s41
    v_mfma_f32_16x16x32_bf16 v[196:199], a[28:31], v[160:163], v[196:199]
    s_lshl_b32 s38, s42, 12
    v_exp_f32 v192, v192
    v_mfma_f32_16x16x32_bf16 v[32:35], v[216:219], a[64:67], 0
    s_lshr_b32 s39, s56, 30
    v_exp_f32 v193, v193
    v_mfma_f32_16x16x32_bf16 v[36:39], v[216:219], a[76:79], 0
    s_waitcnt vmcnt(8)
    ds_read_b128 v[176:179], v127 offset:0
    ds_read_b128 v[180:183], v127 offset:64
    v_mfma_f32_16x16x32_bf16 v[40:43], v[216:219], a[80:83], 0
    s_add_u32 s39, s39, 2
    ds_read_b128 v[184:187], v127 offset:128
    ds_read_b128 v[188:191], v127 offset:192
    v_mfma_f32_16x16x32_bf16 v[44:47], v[216:219], a[92:95], 0
    s_mul_i32 s42, s39, s20
    v_exp_f32 v194, v194
    v_mfma_f32_16x16x32_bf16 v[48:51], v[216:219], a[96:99], 0
    s_bfe_u32 s40, s56, 262167
    v_cvt_pk_bf16_f32 v212, v192, v193
    s_lshl2_add_u32 s42, s40, s42
    v_mfma_f32_16x16x32_bf16 v[52:55], v[216:219], a[108:111], 0
    s_lshl_b32 s42, s42, 16
    v_exp_f32_e64 v195, v195
    v_mfma_f32_16x16x32_bf16 v[56:59], v[216:219], a[112:115], 0
    s_add_u32 s37, s26, s42
    v_exp_f32_e64 v196, v196
    v_mfma_f32_16x16x32_bf16 v[60:63], v[216:219], a[124:127], 0
    s_lshr_b32 s36, s43, 5
    v_cvt_pk_bf16_f32 v213, v194, v195
    v_exp_f32_e64 v197, v197
    v_smfmac_f32_16x16x64_bf16 v[240:243], a[144:147], v[216:223], v255
    s_add_u32 s36, s36, 1
    s_waitcnt lgkmcnt(0)
    v_exp_f32_e64 v198, v198
    v_mfma_f32_4x4x4_16b_bf16 v[96:99], a[156:157], v[176:177], 0
    v_cvt_pk_bf16_f32 v214, v196, v197
    v_mfma_f32_4x4x4_16b_bf16 v[100:103], a[156:157], v[178:179], 0
    v_exp_f32 v199, v199
    v_mfma_f32_4x4x4_16b_bf16 v[104:107], a[156:157], v[180:181], 0
    v_cvt_pk_bf16_f32 v215, v198, v199
    v_mfma_f32_4x4x4_16b_bf16 v[96:99], a[158:159], v[176:177], v[96:99]
    s_and_b32 s40, s36, 1
    v_mfma_f32_4x4x4_16b_bf16 v[108:111], a[156:157], v[182:183], 0
    s_lshl1_add_u32 s39, s39, s40
    v_mfma_f32_4x4x4_16b_bf16 v[100:103], a[158:159], v[178:179], v[100:103]
    s_add_u32 s28, s26, s77
    v_mfma_f32_4x4x4_16b_bf16 v[112:115], a[156:157], v[184:185], 0
    v_cvt_pk_bf16_f32 v176, v96, v97
    v_mfma_f32_4x4x4_16b_bf16 v[104:107], a[158:159], v[180:181], v[104:107]
    v_cvt_pk_bf16_f32 v177, v98, v99
    v_mfma_f32_4x4x4_16b_bf16 v[116:119], a[156:157], v[186:187], 0
    v_cvt_pk_bf16_f32 v178, v100, v101
    v_mfma_f32_4x4x4_16b_bf16 v[108:111], a[158:159], v[182:183], v[108:111]
    v_cvt_pk_bf16_f32 v179, v102, v103
    v_mfma_f32_4x4x4_16b_bf16 v[120:123], a[156:157], v[188:189], 0
    v_cvt_pk_bf16_f32 v180, v104, v105
    v_mfma_f32_4x4x4_16b_bf16 v[112:115], a[158:159], v[184:185], v[112:115]
    v_cvt_pk_bf16_f32 v181, v106, v107
    v_mfma_f32_4x4x4_16b_bf16 v[124:127], a[156:157], v[190:191], 0
    v_cvt_pk_bf16_f32 v182, v108, v109
    v_mfma_f32_4x4x4_16b_bf16 v[116:119], a[158:159], v[186:187], v[116:119]
    v_cvt_pk_bf16_f32 v183, v110, v111
    v_mfma_f32_4x4x4_16b_bf16 v[120:123], a[158:159], v[188:189], v[120:123]
    v_cvt_pk_bf16_f32 v184, v112, v113
    v_mfma_f32_4x4x4_16b_bf16 v[124:127], a[158:159], v[190:191], v[124:127]
    v_cvt_pk_bf16_f32 v185, v114, v115
    v_cvt_pk_bf16_f32 v186, v116, v117
    v_cvt_pk_bf16_f32 v187, v118, v119
    v_cvt_pk_bf16_f32 v188, v120, v121
    v_cvt_pk_bf16_f32 v189, v122, v123
    v_cvt_pk_bf16_f32 v190, v124, v125
    v_cvt_pk_bf16_f32 v191, v126, v127
    v_mfma_f32_16x16x32_bf16 v[200:203], a[0:3], v[176:179], v[236:239]
    s_sub_u32 s40, s36, 2
    s_mov_b32 s22, s24
    s_add_u32 s23, s24, s25
    v_mfma_f32_16x16x32_bf16 v[200:203], a[4:7], v[180:183], v[200:203]
    s_lshl_b32 s40, s40, 17
    s_add_u32 s24, s23, s25
    s_add_u32 m0, s33, 70144
    v_mfma_f32_16x16x32_bf16 v[200:203], a[8:11], v[184:187], v[200:203]
    s_add_u32 s40, s40, s28
    buffer_load_dwordx4 v250, s[8:11], s22 offen offset:0 lds
    s_bitcmp1_b32 0x6800, s3
    s_cmov_b32 s28, s40
    v_mfma_f32_16x16x32_bf16 v[200:203], a[12:15], v[188:191], v[200:203]
    s_cselect_b32 s29, 0xfffe0000, s25
    buffer_load_dwordx4 v251, s[8:11], s22 offen offset:1152 lds
    s_add_u32 s40, s28, s29
    s_bitcmp1_b32 s39, 0
    v_mfma_f32_16x16x32_bf16 v[204:207], a[16:19], v[188:191], v[236:239]
    s_cselect_b32 s27, s28, 2.0
    buffer_load_dwordx4 v250, s[12:15], s22 offen offset:2176 lds
    s_cmov_b32 s28, s40
    s_lshr_b32 s41, s76, 3
    v_mfma_f32_16x16x32_bf16 v[204:207], a[20:23], v[184:187], v[204:207]
    s_and_b32 s40, s39, -2
    buffer_load_dwordx4 v252, s[12:15], s22 offen offset:3216 lds
    s_lshr_b32 s40, s40, s41
    s_sub_u32 s53, s34, s40
    v_add_u32_e64 v248, s35, v248
    v_mfma_f32_16x16x32_bf16 v[204:207], a[24:27], v[180:183], v[204:207]
    s_min_u32 s40, s53, 2
    v_exp_f32_e64 v200, v200
    v_mfma_f32_16x16x32_bf16 v[204:207], a[28:31], v[176:179], v[204:207]
    s_waitcnt vmcnt(8)
    v_exp_f32_e64 v201, v201
    s_barrier
    v_mfma_f32_16x16x32_bf16 v[64:67], v[212:215], a[64:67], 0
    s_add_u32 m0, s33, 87680
    ds_read_b128 a[0:3], v248 offset:0
    ds_read_b128 a[4:7], v248 offset:64
    v_mfma_f32_16x16x32_bf16 v[68:71], v[212:215], a[76:79], 0
    s_sub_u32 s53, s53, s40
    ds_read_b128 a[8:11], v248 offset:128
    ds_read_b128 a[12:15], v248 offset:192
    buffer_load_dwordx4 v250, s[8:11], s23 offen offset:0 lds
    s_sub_u32 s3, s34, s40
    s_cmp_eq_u32 s56, 0
    v_mfma_f32_16x16x32_bf16 v[72:75], v[212:215], a[80:83], 0
    s_cmov_b32 s3, -1
    ds_read_b128 a[16:19], v248 offset:704
    ds_read_b128 a[20:23], v248 offset:640
    buffer_load_dwordx4 v251, s[8:11], s23 offen offset:1152 lds
    s_cmov_b32 s39, 0
    s_cmov_b32 s26, 2.0
    v_mfma_f32_16x16x32_bf16 v[76:79], v[212:215], a[92:95], 0
    s_cmov_b32 s27, 2.0
    ds_read_b128 a[24:27], v248 offset:576
    ds_read_b128 a[28:31], v248 offset:512
    buffer_load_dwordx4 v250, s[12:15], s23 offen offset:2176 lds
    s_cmov_b32 s28, 2.0
    v_mfma_f32_16x16x32_bf16 v[80:83], v[212:215], a[96:99], 0
    ds_read_b128 a[32:35], v248 offset:17536
    ds_read_b128 a[36:39], v248 offset:17600
    buffer_load_dwordx4 v252, s[12:15], s23 offen offset:3216 lds
    v_mfma_f32_16x16x32_bf16 v[84:87], v[212:215], a[108:111], 0
    s_mov_b32 s22, s24
    s_add_u32 s23, s24, s25
    ds_read_b128 a[40:43], v248 offset:17664
    ds_read_b128 a[44:47], v248 offset:17728
    v_mfma_f32_16x16x32_bf16 v[88:91], v[212:215], a[112:115], 0
    s_add_u32 s24, s23, s25
    s_mov_b32 s32, s31
    ds_read_b128 a[48:51], v248 offset:18240
    ds_read_b128 a[52:55], v248 offset:18176
    v_mfma_f32_16x16x32_bf16 v[92:95], v[212:215], a[124:127], 0
    s_mov_b32 m0, s31
    ds_read_b128 a[56:59], v248 offset:18112
    ds_read_b128 a[60:63], v248 offset:18048
    v_smfmac_f32_16x16x64_bf16 v[244:247], a[140:143], v[208:215], v255
    s_waitcnt lgkmcnt(14)
    buffer_load_dwordx4 v250, s[8:11], s22 offen offset:0 lds
    v_mfma_f32_16x16x32_bf16 v[192:195], a[0:3], v[128:131], v[224:227]
    v_exp_f32 v202, v202
    v_mfma_f32_16x16x32_bf16 v[192:195], a[4:7], v[132:135], v[192:195]
    s_waitcnt lgkmcnt(12)
    buffer_load_dwordx4 v251, s[8:11], s22 offen offset:1152 lds
    v_add_u32 v249, s35, v249
    v_mfma_f32_16x16x32_bf16 v[192:195], a[8:11], v[136:139], v[192:195]
    v_cvt_pk_bf16_f32 v216, v200, v201
    v_exp_f32 v203, v203
    v_mfma_f32_16x16x32_bf16 v[192:195], a[12:15], v[140:143], v[192:195]
    s_waitcnt lgkmcnt(10)
    buffer_load_dwordx4 v250, s[12:15], s22 offen offset:2176 lds
    v_mfma_f32_16x16x32_bf16 v[196:199], a[16:19], v[140:143], v[224:227]
    v_exp_f32 v204, v204
    v_mfma_f32_16x16x32_bf16 v[196:199], a[20:23], v[136:139], v[196:199]
    s_waitcnt lgkmcnt(8)
    buffer_load_dwordx4 v252, s[12:15], s22 offen offset:3216 lds
    v_mfma_f32_16x16x32_bf16 v[196:199], a[24:27], v[132:135], v[196:199]
    s_addk_i32 s32, 17536
    v_cvt_pk_bf16_f32 v217, v202, v203
    s_mov_b32 m0, s32
    v_mfma_f32_16x16x32_bf16 v[196:199], a[28:31], v[128:131], v[196:199]
    s_waitcnt lgkmcnt(6)
    v_exp_f32_e64 v205, v205
    s_mov_b32 s14, 0x13da880
    v_mfma_f32_16x16x32_bf16 v[200:203], a[32:35], v[128:131], v[224:227]
    buffer_load_dwordx4 v250, s[8:11], s23 offen offset:0 lds
    v_mfma_f32_16x16x32_bf16 v[200:203], a[36:39], v[132:135], v[200:203]
    s_waitcnt lgkmcnt(4)
    v_exp_f32 v206, v206
    v_mfma_f32_16x16x32_bf16 v[200:203], a[40:43], v[136:139], v[200:203]
    v_cvt_pk_bf16_f32 v218, v204, v205
    v_exp_f32_e64 v207, v207
    v_mfma_f32_16x16x32_bf16 v[200:203], a[44:47], v[140:143], v[200:203]
    s_waitcnt lgkmcnt(2)
    v_cvt_pk_bf16_f32 v219, v206, v207
    v_exp_f32 v192, v192
    v_mfma_f32_16x16x32_bf16 v[204:207], a[48:51], v[140:143], v[224:227]
    v_exp_f32 v193, v193
    v_mfma_f32_16x16x32_bf16 v[204:207], a[52:55], v[136:139], v[204:207]
    s_waitcnt lgkmcnt(0)
    v_exp_f32 v194, v194
    v_mfma_f32_16x16x32_bf16 v[204:207], a[56:59], v[132:135], v[204:207]
    v_exp_f32 v195, v195
    v_mfma_f32_16x16x32_bf16 v[204:207], a[60:63], v[128:131], v[204:207]
    v_cvt_pk_bf16_f32 v212, v192, v193
    v_cvt_pk_bf16_f32 v213, v194, v195
    v_mfma_f32_16x16x32_bf16 v[96:99], v[216:219], a[64:67], 0
    v_exp_f32 v196, v196
    v_mfma_f32_16x16x32_bf16 v[100:103], v[216:219], a[76:79], 0
    v_exp_f32 v197, v197
    v_mfma_f32_16x16x32_bf16 v[104:107], v[216:219], a[80:83], 0
    v_exp_f32_e64 v198, v198
    v_mfma_f32_16x16x32_bf16 v[108:111], v[216:219], a[92:95], 0
    s_waitcnt vmcnt(13)
    v_exp_f32_e64 v199, v199
    s_barrier
    v_mfma_f32_16x16x32_bf16 v[112:115], v[216:219], a[96:99], 0
    ds_read_b64_tr_b16 a[64:65], v249 offset:2176
    ds_read_b64_tr_b16 a[66:67], v249 offset:2688
    ds_read_b64_tr_b16 a[68:69], v249 offset:19712
    ds_read_b64_tr_b16 a[70:71], v249 offset:20224
    v_mfma_f32_16x16x32_bf16 v[116:119], v[216:219], a[108:111], 0
    s_mov_b32 s51, s50
    ds_read_b64_tr_b16 a[72:73], v249 offset:19728
    ds_read_b64_tr_b16 a[74:75], v249 offset:20240
    ds_read_b64_tr_b16 a[76:77], v249 offset:2192
    ds_read_b64_tr_b16 a[78:79], v249 offset:2704
    v_mfma_f32_16x16x32_bf16 v[120:123], v[216:219], a[112:115], 0
    s_mov_b32 s52, s37
    ds_read_b64_tr_b16 a[80:81], v249 offset:2208
    ds_read_b64_tr_b16 a[82:83], v249 offset:2720
    ds_read_b64_tr_b16 a[84:85], v249 offset:19744
    ds_read_b64_tr_b16 a[86:87], v249 offset:20256
    v_mfma_f32_16x16x32_bf16 v[124:127], v[216:219], a[124:127], 0
    s_mov_b32 s6, s38
    ds_read_b64_tr_b16 a[88:89], v249 offset:19760
    ds_read_b64_tr_b16 a[90:91], v249 offset:20272
    ds_read_b64_tr_b16 a[92:93], v249 offset:2224
    ds_read_b64_tr_b16 a[94:95], v249 offset:2736
    v_smfmac_f32_16x16x64_bf16 v[244:247], a[144:147], v[216:223], v255
    v_cvt_pk_bf16_f32 v214, v196, v197
    v_cvt_pk_bf16_f32 v215, v198, v199
    v_exp_f32 v200, v200
    v_exp_f32 v201, v201
    v_exp_f32 v202, v202
    v_exp_f32 v203, v203
    v_cvt_pk_bf16_f32 v208, v200, v201
    v_cvt_pk_bf16_f32 v209, v202, v203
    v_exp_f32 v204, v204
    v_exp_f32 v205, v205
    s_branch L_loop_4
.p2align 12
.p2align 5
P_first1p_4b:
    s_setpc_b64 s[62:63]
.fill 1, 4, 0xbf800000
L_first1p_4b:
    s_waitcnt vmcnt(10)
    ds_read_b128 v[144:147], v254 offset:4352
    ds_read_b128 v[148:151], v254 offset:4416
    v_mfma_f32_16x16x32_bf16 v[200:203], a[36:39], v[132:135], v[200:203]
    s_addk_i32 s52, 15296
    ds_read_b128 v[152:155], v254 offset:4480
    ds_read_b128 v[156:159], v254 offset:4544
    buffer_load_dwordx4 v253, s[4:7], s52 offen offset:2176 nt lds
    s_cmp_eq_u32 s3, 15
    s_cmov_b32 s56, 0x51b963e0
    v_mfma_f32_16x16x32_bf16 v[200:203], a[40:43], v[136:139], v[200:203]
    s_and_b32 s40, s56, 0x1fff
    v_exp_f32 v193, v193
    v_mfma_f32_16x16x32_bf16 v[200:203], a[44:47], v[140:143], v[200:203]
    s_add_i32 s52, s52, 15296
    buffer_load_dwordx4 v253, s[4:7], s52 offen offset:3264 nt lds
    s_bfe_u32 s41, s56, 655373
    s_bfe_u32 s42, s56, 196635
    v_mfma_f32_16x16x32_bf16 v[204:207], a[48:51], v[140:143], v[224:227]
    s_lshl1_add_u32 s42, s42, s21
    v_exp_f32 v194, v194
    v_mfma_f32_16x16x32_bf16 v[204:207], a[52:55], v[136:139], v[204:207]
    s_and_b32 s42, s42, 15
    v_cvt_pk_bf16_f32 v212, v192, v193
    v_exp_f32 v195, v195
    v_mfma_f32_16x16x32_bf16 v[204:207], a[56:59], v[132:135], v[204:207]
    s_lshl4_add_u32 s42, s40, s42
    v_exp_f32 v196, v196
    v_mfma_f32_16x16x32_bf16 v[204:207], a[60:63], v[128:131], v[204:207]
    s_waitcnt lgkmcnt(0)
    v_cvt_pk_bf16_f32 v213, v194, v195
    v_exp_f32 v197, v197
    v_mfma_f32_4x4x4_16b_bf16 v[32:35], a[156:157], v[144:145], 0
    v_exp_f32_e64 v198, v198
    v_mfma_f32_4x4x4_16b_bf16 v[36:39], a[156:157], v[146:147], 0
    v_cvt_pk_bf16_f32 v214, v196, v197
    v_mfma_f32_4x4x4_16b_bf16 v[40:43], a[156:157], v[148:149], 0
    v_exp_f32_e64 v199, v199
    v_mfma_f32_4x4x4_16b_bf16 v[32:35], a[158:159], v[144:145], v[32:35]
    v_exp_f32_e64 v200, v200
    v_mfma_f32_4x4x4_16b_bf16 v[44:47], a[156:157], v[150:151], 0
    v_cvt_pk_bf16_f32 v215, v198, v199
    v_mfma_f32_4x4x4_16b_bf16 v[36:39], a[158:159], v[146:147], v[36:39]
    v_exp_f32_e64 v201, v201
    v_mfma_f32_4x4x4_16b_bf16 v[48:51], a[156:157], v[152:153], 0
    v_cvt_pk_bf16_f32 v144, v32, v33
    v_mfma_f32_4x4x4_16b_bf16 v[40:43], a[158:159], v[148:149], v[40:43]
    v_cvt_pk_bf16_f32 v145, v34, v35
    v_mfma_f32_4x4x4_16b_bf16 v[52:55], a[156:157], v[154:155], 0
    v_cvt_pk_bf16_f32 v146, v36, v37
    v_mfma_f32_4x4x4_16b_bf16 v[44:47], a[158:159], v[150:151], v[44:47]
    v_cvt_pk_bf16_f32 v147, v38, v39
    v_mfma_f32_4x4x4_16b_bf16 v[56:59], a[156:157], v[156:157], 0
    v_cvt_pk_bf16_f32 v148, v40, v41
    v_mfma_f32_4x4x4_16b_bf16 v[48:51], a[158:159], v[152:153], v[48:51]
    v_cvt_pk_bf16_f32 v149, v42, v43
    v_mfma_f32_4x4x4_16b_bf16 v[60:63], a[156:157], v[158:159], 0
    v_cvt_pk_bf16_f32 v150, v44, v45
    v_mfma_f32_4x4x4_16b_bf16 v[52:55], a[158:159], v[154:155], v[52:55]
    v_cvt_pk_bf16_f32 v151, v46, v47
    v_mfma_f32_4x4x4_16b_bf16 v[56:59], a[158:159], v[156:157], v[56:59]
    v_cvt_pk_bf16_f32 v152, v48, v49
    v_mfma_f32_4x4x4_16b_bf16 v[60:63], a[158:159], v[158:159], v[60:63]
    v_cvt_pk_bf16_f32 v153, v50, v51
    v_cvt_pk_bf16_f32 v154, v52, v53
    v_cvt_pk_bf16_f32 v155, v54, v55
    v_cvt_pk_bf16_f32 v156, v56, v57
    v_cvt_pk_bf16_f32 v157, v58, v59
    v_cvt_pk_bf16_f32 v158, v60, v61
    v_cvt_pk_bf16_f32 v159, v62, v63
    s_waitcnt vmcnt(8)
    s_barrier
    v_mfma_f32_16x16x32_bf16 v[192:195], a[0:3], v[144:147], v[228:231]
    s_mov_b32 s22, s24
    s_add_u32 s23, s24, s25
    ds_read_b64_tr_b16 a[64:65], v249 offset:2176
    ds_read_b64_tr_b16 a[66:67], v249 offset:2688
    v_mfma_f32_16x16x32_bf16 v[192:195], a[4:7], v[148:151], v[192:195]
    s_add_u32 s31, s30, s33
    v_exp_f32 v202, v202
    v_cvt_pk_bf16_f32 v208, v200, v201
    v_exp_f32_e64 v203, v203
    v_exp_f32_e64 v204, v204
    v_cvt_pk_bf16_f32 v209, v202, v203
    v_exp_f32_e64 v205, v205
    v_exp_f32_e64 v206, v206
    v_cvt_pk_bf16_f32 v210, v204, v205
    v_exp_f32_e64 v207, v207
    s_add_u32 s24, s23, s25
    s_add_u32 m0, s33, 35072
    ds_read_b64_tr_b16 a[68:69], v249 offset:19712
    ds_read_b64_tr_b16 a[70:71], v249 offset:20224
    v_cvt_pk_bf16_f32 v211, v206, v207
    v_mfma_f32_16x16x32_bf16 v[192:195], a[8:11], v[152:155], v[192:195]
    s_add_u32 s30, s30, s80
    ds_read_b64_tr_b16 a[72:73], v249 offset:19728
    ds_read_b64_tr_b16 a[74:75], v249 offset:20240
    buffer_load_dwordx4 v250, s[8:11], s22 offen offset:0 lds
    s_lshl_b32 s26, s42, 8
    s_sub_u32 s43, s41, 1
    v_mfma_f32_16x16x32_bf16 v[192:195], a[12:15], v[156:159], v[192:195]
    s_cmp_eq_u32 s30, 105216
    ds_read_b64_tr_b16 a[76:77], v249 offset:2192
    ds_read_b64_tr_b16 a[78:79], v249 offset:2704
    v_mfma_f32_16x16x32_bf16 v[196:199], a[16:19], v[156:159], v[228:231]
    s_cmov_b32 s30, 0
    ds_read_b64_tr_b16 a[80:81], v249 offset:2208
    ds_read_b64_tr_b16 a[82:83], v249 offset:2720
    buffer_load_dwordx4 v251, s[8:11], s22 offen offset:1152 lds
    v_mfma_f32_16x16x32_bf16 v[196:199], a[20:23], v[152:155], v[196:199]
    s_cselect_b32 s35, s81, s80
    s_add_u32 m0, s33, 52608
    ds_read_b64_tr_b16 a[84:85], v249 offset:19744
    ds_read_b64_tr_b16 a[86:87], v249 offset:20256
    v_mfma_f32_16x16x32_bf16 v[196:199], a[24:27], v[148:151], v[196:199]
    s_and_b32 s44, s43, 31
    ds_read_b64_tr_b16 a[88:89], v249 offset:19760
    ds_read_b64_tr_b16 a[90:91], v249 offset:20272
    buffer_load_dwordx4 v250, s[8:11], s23 offen offset:0 lds
    s_add_u32 s44, s44, 1
    s_lshl_b64 s[46:47], -1, s44
    v_mfma_f32_16x16x32_bf16 v[196:199], a[28:31], v[144:147], v[196:199]
    s_not_b32 s46, s46
    ds_read_b64_tr_b16 a[92:93], v249 offset:2224
    ds_read_b64_tr_b16 a[94:95], v249 offset:2736
    v_mfma_f32_16x16x32_bf16 v[200:203], a[32:35], v[144:147], v[228:231]
    ds_read_b64_tr_b16 a[96:97], v249 offset:2240
    ds_read_b64_tr_b16 a[98:99], v249 offset:2752
    buffer_load_dwordx4 v251, s[8:11], s23 offen offset:1152 lds
    v_mfma_f32_16x16x32_bf16 v[200:203], a[36:39], v[148:151], v[200:203]
    ds_read_b64_tr_b16 a[100:101], v249 offset:19776
    ds_read_b64_tr_b16 a[102:103], v249 offset:20288
    v_mfma_f32_16x16x32_bf16 v[200:203], a[40:43], v[152:155], v[200:203]
    ds_read_b64_tr_b16 a[104:105], v249 offset:19792
    ds_read_b64_tr_b16 a[106:107], v249 offset:20304
    v_mfma_f32_16x16x32_bf16 v[200:203], a[44:47], v[156:159], v[200:203]
    ds_read_b64_tr_b16 a[108:109], v249 offset:2256
    ds_read_b64_tr_b16 a[110:111], v249 offset:2768
    v_mfma_f32_16x16x32_bf16 v[204:207], a[48:51], v[156:159], v[228:231]
    ds_read_b64_tr_b16 a[112:113], v249 offset:2272
    ds_read_b64_tr_b16 a[114:115], v249 offset:2784
    v_mfma_f32_16x16x32_bf16 v[204:207], a[52:55], v[152:155], v[204:207]
    ds_read_b64_tr_b16 a[116:117], v249 offset:19808
    ds_read_b64_tr_b16 a[118:119], v249 offset:20320
    v_mfma_f32_16x16x32_bf16 v[204:207], a[56:59], v[148:151], v[204:207]
    s_nop 0
    ds_read_b64_tr_b16 a[120:121], v249 offset:19824
    ds_read_b64_tr_b16 a[122:123], v249 offset:20336
    v_mfma_f32_16x16x32_bf16 v[204:207], a[60:63], v[144:147], v[204:207]
    s_waitcnt lgkmcnt(15)
    ds_read_b64_tr_b16 a[124:125], v249 offset:2288
    ds_read_b64_tr_b16 a[126:127], v249 offset:2800
    v_mfma_f32_16x16x32_bf16 v[0:3], v[212:215], a[64:67], 0
    v_exp_f32_e64 v192, v192
    v_mfma_f32_16x16x32_bf16 v[0:3], v[208:211], a[68:71], v[0:3]
    v_exp_f32_e64 v193, v193
    v_mfma_f32_16x16x32_bf16 v[4:7], v[208:211], a[72:75], 0
    v_exp_f32_e64 v194, v194
    v_mfma_f32_16x16x32_bf16 v[4:7], v[212:215], a[76:79], v[4:7]
    v_lshrrev_b32 v176, v188, s46
    v_cvt_pk_bf16_f32 v216, v192, v193
    v_mfma_f32_16x16x32_bf16 v[8:11], v[212:215], a[80:83], 0
    s_mov_b32 s46, 0xffff
    v_exp_f32 v195, v195
    v_mfma_f32_16x16x32_bf16 v[8:11], v[208:211], a[84:87], v[8:11]
    s_waitcnt lgkmcnt(15)
    v_exp_f32_e64 v196, v196
    v_mfma_f32_16x16x32_bf16 v[12:15], v[208:211], a[88:91], 0
    v_or_b32 v176, v176, v189
    v_cvt_pk_bf16_f32 v217, v194, v195
    v_mfma_f32_16x16x32_bf16 v[12:15], v[212:215], a[92:95], v[12:15]
    s_waitcnt lgkmcnt(12)
    v_exp_f32_e64 v197, v197
    v_mfma_f32_16x16x32_bf16 v[16:19], v[212:215], a[96:99], 0
    v_exp_f32_e64 v198, v198
    v_mfma_f32_16x16x32_bf16 v[16:19], v[208:211], a[100:103], v[16:19]
    s_waitcnt vmcnt(8)
    s_waitcnt lgkmcnt(8)
    ds_read_b128 v[160:163], v254 offset:8704
    ds_read_b128 v[164:167], v254 offset:8768
    v_mfma_f32_16x16x32_bf16 v[20:23], v[208:211], a[104:107], 0
    s_nop 0
    ds_read_b128 v[168:171], v254 offset:8832
    ds_read_b128 v[172:175], v254 offset:8896
    v_mfma_f32_16x16x32_bf16 v[20:23], v[212:215], a[108:111], v[20:23]
    s_waitcnt lgkmcnt(8)
    v_bfe_i32 v177, v176, 0, 1
    v_cvt_pk_bf16_f32 v218, v196, v197
    v_mfma_f32_16x16x32_bf16 v[24:27], v[212:215], a[112:115], 0
    v_exp_f32_e64 v199, v199
    v_mfma_f32_16x16x32_bf16 v[24:27], v[208:211], a[116:119], v[24:27]
    s_waitcnt lgkmcnt(1)
    v_exp_f32 v200, v200
    v_mfma_f32_16x16x32_bf16 v[28:31], v[208:211], a[120:123], 0
    v_bfe_i32 v178, v176, 1, 1
    v_cvt_pk_bf16_f32 v219, v198, v199
    v_mfma_f32_16x16x32_bf16 v[28:31], v[212:215], a[124:127], v[28:31]
    v_exp_f32 v201, v201
    v_smfmac_f32_16x16x64_bf16 v[240:243], a[140:143], v[208:215], v255
    s_waitcnt lgkmcnt(0)
    v_exp_f32 v202, v202
    v_mfma_f32_4x4x4_16b_bf16 v[64:67], a[156:157], v[160:161], 0
    v_cvt_pk_bf16_f32 v220, v200, v201
    v_mfma_f32_4x4x4_16b_bf16 v[68:71], a[156:157], v[162:163], 0
    v_exp_f32 v203, v203
    v_mfma_f32_4x4x4_16b_bf16 v[72:75], a[156:157], v[164:165], 0
    v_exp_f32_e64 v204, v204
    v_mfma_f32_4x4x4_16b_bf16 v[64:67], a[158:159], v[160:161], v[64:67]
    v_cvt_pk_bf16_f32 v221, v202, v203
    v_mfma_f32_4x4x4_16b_bf16 v[76:79], a[156:157], v[166:167], 0
    v_bfe_i32 v179, v176, 16, 1
    v_mfma_f32_4x4x4_16b_bf16 v[68:71], a[158:159], v[162:163], v[68:71]
    v_bfe_i32 v180, v176, 17, 1
    v_mfma_f32_4x4x4_16b_bf16 v[80:83], a[156:157], v[168:169], 0
    v_cvt_pk_bf16_f32 v160, v64, v65
    v_mfma_f32_4x4x4_16b_bf16 v[72:75], a[158:159], v[164:165], v[72:75]
    v_cvt_pk_bf16_f32 v161, v66, v67
    v_mfma_f32_4x4x4_16b_bf16 v[84:87], a[156:157], v[170:171], 0
    v_cvt_pk_bf16_f32 v162, v68, v69
    v_mfma_f32_4x4x4_16b_bf16 v[76:79], a[158:159], v[166:167], v[76:79]
    v_cvt_pk_bf16_f32 v163, v70, v71
    v_mfma_f32_4x4x4_16b_bf16 v[88:91], a[156:157], v[172:173], 0
    v_cvt_pk_bf16_f32 v164, v72, v73
    v_mfma_f32_4x4x4_16b_bf16 v[80:83], a[158:159], v[168:169], v[80:83]
    v_cvt_pk_bf16_f32 v165, v74, v75
    v_mfma_f32_4x4x4_16b_bf16 v[92:95], a[156:157], v[174:175], 0
    v_cvt_pk_bf16_f32 v166, v76, v77
    v_mfma_f32_4x4x4_16b_bf16 v[84:87], a[158:159], v[170:171], v[84:87]
    v_cvt_pk_bf16_f32 v167, v78, v79
    v_mfma_f32_4x4x4_16b_bf16 v[88:91], a[158:159], v[172:173], v[88:91]
    v_cvt_pk_bf16_f32 v168, v80, v81
    v_mfma_f32_4x4x4_16b_bf16 v[92:95], a[158:159], v[174:175], v[92:95]
    v_cvt_pk_bf16_f32 v169, v82, v83
    v_cvt_pk_bf16_f32 v170, v84, v85
    v_cvt_pk_bf16_f32 v171, v86, v87
    v_cvt_pk_bf16_f32 v172, v88, v89
    v_cvt_pk_bf16_f32 v173, v90, v91
    v_cvt_pk_bf16_f32 v174, v92, v93
    v_cvt_pk_bf16_f32 v175, v94, v95
    v_mfma_f32_16x16x32_bf16 v[192:195], a[0:3], v[160:163], v[232:235]
    s_add_u32 m0, s33, 35072
    v_exp_f32 v205, v205
    v_mfma_f32_16x16x32_bf16 v[192:195], a[4:7], v[164:167], v[192:195]
    buffer_load_dwordx4 v250, s[12:15], s22 offen offset:2176 lds
    v_mfma_f32_16x16x32_bf16 v[192:195], a[8:11], v[168:171], v[192:195]
    v_exp_f32 v206, v206
    v_mfma_f32_16x16x32_bf16 v[192:195], a[12:15], v[172:175], v[192:195]
    buffer_load_dwordx4 v252, s[12:15], s22 offen offset:3216 lds
    v_mfma_f32_16x16x32_bf16 v[196:199], a[16:19], v[172:175], v[232:235]
    s_add_u32 m0, s33, 52608
    v_bfe_i32 v181, v176, 4, 1
    v_cvt_pk_bf16_f32 v222, v204, v205
    v_mfma_f32_16x16x32_bf16 v[196:199], a[20:23], v[168:171], v[196:199]
    buffer_load_dwordx4 v250, s[12:15], s23 offen offset:2176 lds
    v_mfma_f32_16x16x32_bf16 v[196:199], a[24:27], v[164:167], v[196:199]
    v_exp_f32_e64 v207, v207
    v_mfma_f32_16x16x32_bf16 v[196:199], a[28:31], v[160:163], v[196:199]
    buffer_load_dwordx4 v252, s[12:15], s23 offen offset:3216 lds
    v_mfma_f32_16x16x32_bf16 v[200:203], a[32:35], v[160:163], v[232:235]
    v_bfe_i32 v182, v176, 5, 1
    v_cvt_pk_bf16_f32 v223, v206, v207
    v_mfma_f32_16x16x32_bf16 v[200:203], a[36:39], v[164:167], v[200:203]
    v_exp_f32 v192, v192
    v_mfma_f32_16x16x32_bf16 v[200:203], a[40:43], v[168:171], v[200:203]
    v_exp_f32 v193, v193
    v_mfma_f32_16x16x32_bf16 v[200:203], a[44:47], v[172:175], v[200:203]
    v_exp_f32_e64 v194, v194
    v_mfma_f32_16x16x32_bf16 v[204:207], a[48:51], v[172:175], v[232:235]
    v_bfe_i32 v183, v176, 20, 1
    v_cvt_pk_bf16_f32 v212, v192, v193
    v_mfma_f32_16x16x32_bf16 v[204:207], a[52:55], v[168:171], v[204:207]
    v_exp_f32 v195, v195
    v_mfma_f32_16x16x32_bf16 v[204:207], a[56:59], v[164:167], v[204:207]
    v_exp_f32 v196, v196
    v_mfma_f32_16x16x32_bf16 v[204:207], a[60:63], v[160:163], v[204:207]
    v_bfe_i32 v184, v176, 21, 1
    v_cvt_pk_bf16_f32 v213, v194, v195
    v_mfma_f32_16x16x32_bf16 v[32:35], v[216:219], a[64:67], 0
    v_exp_f32 v197, v197
    v_mfma_f32_16x16x32_bf16 v[32:35], v[220:223], a[68:71], v[32:35]
    v_exp_f32 v198, v198
    v_mfma_f32_16x16x32_bf16 v[36:39], v[220:223], a[72:75], 0
    v_bfi_b32 v177, s46, v177, v178
    v_cvt_pk_bf16_f32 v214, v196, v197
    v_mfma_f32_16x16x32_bf16 v[36:39], v[216:219], a[76:79], v[36:39]
    v_exp_f32 v199, v199
    v_mfma_f32_16x16x32_bf16 v[40:43], v[216:219], a[80:83], 0
    v_exp_f32_e64 v200, v200
    v_mfma_f32_16x16x32_bf16 v[40:43], v[220:223], a[84:87], v[40:43]
    s_mulk_i32 s49, -8672
    v_cvt_pk_bf16_f32 v215, v198, v199
    s_add_u32 s49, s49, 0xffffbb80
    v_mfma_f32_16x16x32_bf16 v[44:47], v[220:223], a[88:91], 0
    v_bfi_b32 v179, s46, v179, v180
    v_add_u32 v127, s49, v254
    v_mfma_f32_16x16x32_bf16 v[44:47], v[216:219], a[92:95], v[44:47]
    v_exp_f32 v201, v201
    v_mfma_f32_16x16x32_bf16 v[48:51], v[216:219], a[96:99], 0
    v_exp_f32_e64 v202, v202
    v_mfma_f32_16x16x32_bf16 v[48:51], v[220:223], a[100:103], v[48:51]
    s_waitcnt vmcnt(8)
    v_bfi_b32 v181, s46, v181, v182
    v_bfi_b32 v183, s46, v183, v184
    v_and_b32 v178, v177, v191
    v_and_b32 v177, v177, v190
    v_and_b32 v180, v179, v191
    v_and_b32 v179, v179, v190
    v_and_b32 v182, v181, v191
    v_and_b32_e64 v181, v181, v190
    v_and_b32_e64 v184, v183, v191
    v_and_b32_e64 v183, v183, v190
    v_accvgpr_write_b32 a148, v177
    v_accvgpr_write_b32 a152, v178
    v_accvgpr_write_b32 a149, v179
    v_accvgpr_write_b32 a153, v180
    v_accvgpr_write_b32 a150, v181
    v_accvgpr_write_b32 a154, v182
    v_accvgpr_write_b32 a151, v183
    v_accvgpr_write_b32 a155, v184
    s_lshl_b32 s77, s44, 12
    s_add_u32 s42, s40, s44
    ds_read_b128 v[176:179], v127 offset:0
    ds_read_b128 v[180:183], v127 offset:64
    v_mfma_f32_16x16x32_bf16 v[52:55], v[220:223], a[104:107], 0
    s_lshl_b32 s42, s42, 12
    ds_read_b128 v[184:187], v127 offset:128
    ds_read_b128 v[188:191], v127 offset:192
    v_mfma_f32_16x16x32_bf16 v[52:55], v[216:219], a[108:111], v[52:55]
    s_add_u32 s78, s42, 2176
    v_cvt_pk_bf16_f32 v208, v200, v201
    s_add_u32 s42, s40, s41
    v_mfma_f32_16x16x32_bf16 v[56:59], v[216:219], a[112:115], 0
    s_lshl_b32 s38, s42, 12
    v_exp_f32_e64 v203, v203
    v_mfma_f32_16x16x32_bf16 v[56:59], v[220:223], a[116:119], v[56:59]
    s_lshr_b32 s39, s56, 30
    v_exp_f32_e64 v204, v204
    v_mfma_f32_16x16x32_bf16 v[60:63], v[220:223], a[120:123], 0
    s_add_u32 s39, s39, 2
    v_cvt_pk_bf16_f32 v209, v202, v203
    s_mul_i32 s42, s39, s20
    v_mfma_f32_16x16x32_bf16 v[60:63], v[216:219], a[124:127], v[60:63]
    s_bfe_u32 s40, s56, 262167
    v_exp_f32_e64 v205, v205
    v_smfmac_f32_16x16x64_bf16 v[240:243], a[144:147], v[216:223], v255
    s_lshl2_add_u32 s42, s40, s42
    s_waitcnt lgkmcnt(0)
    v_exp_f32 v206, v206
    v_mfma_f32_4x4x4_16b_bf16 v[96:99], a[156:157], v[176:177], 0
    v_cvt_pk_bf16_f32 v210, v204, v205
    v_mfma_f32_4x4x4_16b_bf16 v[100:103], a[156:157], v[178:179], 0
    s_lshl_b32 s42, s42, 16
    v_mfma_f32_4x4x4_16b_bf16 v[104:107], a[156:157], v[180:181], 0
    s_add_u32 s37, s26, s42
    v_mfma_f32_4x4x4_16b_bf16 v[96:99], a[158:159], v[176:177], v[96:99]
    s_lshr_b32 s36, s43, 5
    v_mfma_f32_4x4x4_16b_bf16 v[108:111], a[156:157], v[182:183], 0
    s_add_u32 s36, s36, 1
    v_mfma_f32_4x4x4_16b_bf16 v[100:103], a[158:159], v[178:179], v[100:103]
    s_and_b32 s40, s36, 1
    v_mfma_f32_4x4x4_16b_bf16 v[112:115], a[156:157], v[184:185], 0
    v_cvt_pk_bf16_f32 v176, v96, v97
    v_mfma_f32_4x4x4_16b_bf16 v[104:107], a[158:159], v[180:181], v[104:107]
    v_cvt_pk_bf16_f32 v177, v98, v99
    v_mfma_f32_4x4x4_16b_bf16 v[116:119], a[156:157], v[186:187], 0
    v_cvt_pk_bf16_f32 v178, v100, v101
    v_mfma_f32_4x4x4_16b_bf16 v[108:111], a[158:159], v[182:183], v[108:111]
    v_cvt_pk_bf16_f32 v179, v102, v103
    v_mfma_f32_4x4x4_16b_bf16 v[120:123], a[156:157], v[188:189], 0
    v_cvt_pk_bf16_f32 v180, v104, v105
    v_mfma_f32_4x4x4_16b_bf16 v[112:115], a[158:159], v[184:185], v[112:115]
    v_cvt_pk_bf16_f32 v181, v106, v107
    v_mfma_f32_4x4x4_16b_bf16 v[124:127], a[156:157], v[190:191], 0
    v_cvt_pk_bf16_f32 v182, v108, v109
    v_mfma_f32_4x4x4_16b_bf16 v[116:119], a[158:159], v[186:187], v[116:119]
    v_cvt_pk_bf16_f32 v183, v110, v111
    v_mfma_f32_4x4x4_16b_bf16 v[120:123], a[158:159], v[188:189], v[120:123]
    v_cvt_pk_bf16_f32 v184, v112, v113
    v_mfma_f32_4x4x4_16b_bf16 v[124:127], a[158:159], v[190:191], v[124:127]
    v_cvt_pk_bf16_f32 v185, v114, v115
    v_cvt_pk_bf16_f32 v186, v116, v117
    v_cvt_pk_bf16_f32 v187, v118, v119
    v_cvt_pk_bf16_f32 v188, v120, v121
    v_cvt_pk_bf16_f32 v189, v122, v123
    v_cvt_pk_bf16_f32 v190, v124, v125
    v_cvt_pk_bf16_f32 v191, v126, v127
    v_mfma_f32_16x16x32_bf16 v[192:195], a[0:3], v[176:179], v[236:239]
    s_lshl1_add_u32 s39, s39, s40
    s_mov_b32 s22, s24
    s_add_u32 s23, s24, s25
    v_mfma_f32_16x16x32_bf16 v[192:195], a[4:7], v[180:183], v[192:195]
    s_add_u32 s28, s26, s77
    s_add_u32 s24, s23, s25
    s_add_u32 m0, s33, 70144
    v_mfma_f32_16x16x32_bf16 v[192:195], a[8:11], v[184:187], v[192:195]
    s_sub_u32 s40, s36, 2
    buffer_load_dwordx4 v250, s[8:11], s22 offen offset:0 lds
    s_lshl_b32 s40, s40, 17
    s_add_u32 s40, s40, s28
    v_mfma_f32_16x16x32_bf16 v[192:195], a[12:15], v[188:191], v[192:195]
    s_bitcmp1_b32 0x6800, s3
    v_exp_f32_e64 v207, v207
    v_mfma_f32_16x16x32_bf16 v[196:199], a[16:19], v[188:191], v[236:239]
    s_cmov_b32 s28, s40
    buffer_load_dwordx4 v251, s[8:11], s22 offen offset:1152 lds
    s_cselect_b32 s29, 0xfffe0000, s25
    s_add_u32 s40, s28, s29
    v_mfma_f32_16x16x32_bf16 v[196:199], a[20:23], v[184:187], v[196:199]
    s_bitcmp1_b32 s39, 0
    v_cvt_pk_bf16_f32 v211, v206, v207
    s_cselect_b32 s27, s28, 2.0
    v_mfma_f32_16x16x32_bf16 v[196:199], a[24:27], v[180:183], v[196:199]
    s_cmov_b32 s28, s40
    buffer_load_dwordx4 v250, s[12:15], s22 offen offset:2176 lds
    s_lshr_b32 s41, s76, 3
    s_and_b32 s40, s39, -2
    v_mfma_f32_16x16x32_bf16 v[196:199], a[28:31], v[176:179], v[196:199]
    s_lshr_b32 s40, s40, s41
    v_exp_f32 v192, v192
    v_mfma_f32_16x16x32_bf16 v[200:203], a[32:35], v[176:179], v[236:239]
    s_sub_u32 s53, s34, s40
    buffer_load_dwordx4 v252, s[12:15], s22 offen offset:3216 lds
    s_min_u32 s40, s53, 2
    s_sub_u32 s53, s53, s40
    v_mfma_f32_16x16x32_bf16 v[200:203], a[36:39], v[180:183], v[200:203]
    s_sub_u32 s3, s34, s40
    v_exp_f32 v193, v193
    v_mfma_f32_16x16x32_bf16 v[200:203], a[40:43], v[184:187], v[200:203]
    v_exp_f32_e64 v194, v194
    v_mfma_f32_16x16x32_bf16 v[200:203], a[44:47], v[188:191], v[200:203]
    v_cvt_pk_bf16_f32 v216, v192, v193
    v_exp_f32 v195, v195
    v_mfma_f32_16x16x32_bf16 v[204:207], a[48:51], v[188:191], v[236:239]
    v_exp_f32 v196, v196
    v_mfma_f32_16x16x32_bf16 v[204:207], a[52:55], v[184:187], v[204:207]
    v_cvt_pk_bf16_f32 v217, v194, v195
    v_add_u32 v248, s35, v248
    v_mfma_f32_16x16x32_bf16 v[204:207], a[56:59], v[180:183], v[204:207]
    v_exp_f32 v197, v197
    v_mfma_f32_16x16x32_bf16 v[204:207], a[60:63], v[176:179], v[204:207]
    s_branch L_first1p_4c
.p2align 12
.p2align 5
P_first1s_3:
    s_setpc_b64 s[62:63]
.fill 1, 4, 0xbf800000
L_first1s_3:
    s_waitcnt lgkmcnt(0)
    v_mfma_f32_16x16x32_bf16 v[200:203], a[0:3], v[128:131], v[224:227]
    s_waitcnt vmcnt(8)
    ds_read_b128 v[144:147], v254 offset:4352
    ds_read_b128 v[148:151], v254 offset:4416
    v_mfma_f32_16x16x32_bf16 v[200:203], a[4:7], v[132:135], v[200:203]
    s_lshr_b32 s3, s2, 4
    ds_read_b128 v[152:155], v254 offset:4480
    ds_read_b128 v[156:159], v254 offset:4544
    v_mfma_f32_16x16x32_bf16 v[200:203], a[8:11], v[136:139], v[200:203]
    s_mov_b32 s22, s24
    v_mov_b32 v96, 0
    s_add_u32 s23, s24, s25
    v_mfma_f32_16x16x32_bf16 v[200:203], a[12:15], v[140:143], v[200:203]
    s_add_u32 s24, s23, s25
    v_mov_b32_e64 v97, 0
    s_add_u32 m0, s33, 35072
    v_mfma_f32_16x16x32_bf16 v[204:207], a[16:19], v[140:143], v[224:227]
    s_mov_b32 s56, 0
    buffer_load_dwordx4 v250, s[8:11], s22 offen offset:0 lds
    s_cmp_eq_u32 s3, 0
    s_cmov_b32 s56, 0x704751a0
    v_mfma_f32_16x16x32_bf16 v[204:207], a[20:23], v[136:139], v[204:207]
    s_cmp_eq_u32 s3, 1
    buffer_load_dwordx4 v251, s[8:11], s22 offen offset:1152 lds
    s_cmov_b32 s56, 0x3830ac75
    v_mfma_f32_16x16x32_bf16 v[204:207], a[24:27], v[132:135], v[204:207]
    s_add_u32 m0, s33, 52608
    v_mov_b32 v98, 0
    v_mov_b32 v99, 0
    v_mfma_f32_16x16x32_bf16 v[204:207], a[28:31], v[128:131], v[204:207]
    s_waitcnt lgkmcnt(0)
    buffer_load_dwordx4 v250, s[8:11], s23 offen offset:0 lds
    s_cmp_eq_u32 s3, 2
    s_cmov_b32 s56, 0x7a30ac75
    v_mfma_f32_4x4x4_16b_bf16 v[32:35], a[156:157], v[144:145], 0
    v_mov_b32 v108, 0
    v_mfma_f32_4x4x4_16b_bf16 v[36:39], a[156:157], v[146:147], 0
    v_mov_b32 v109, 0
    v_mfma_f32_4x4x4_16b_bf16 v[40:43], a[156:157], v[148:149], 0
    v_mov_b32 v110, 0
    v_mfma_f32_4x4x4_16b_bf16 v[32:35], a[158:159], v[144:145], v[32:35]
    v_mov_b32 v111, 0
    v_mfma_f32_4x4x4_16b_bf16 v[44:47], a[156:157], v[150:151], 0
    v_mov_b32 v112, 0
    v_mfma_f32_4x4x4_16b_bf16 v[36:39], a[158:159], v[146:147], v[36:39]
    v_mov_b32 v113, 0
    v_mfma_f32_4x4x4_16b_bf16 v[48:51], a[156:157], v[152:153], 0
    v_cvt_pk_bf16_f32 v144, v32, v33
    v_mfma_f32_4x4x4_16b_bf16 v[40:43], a[158:159], v[148:149], v[40:43]
    v_cvt_pk_bf16_f32 v145, v34, v35
    v_mfma_f32_4x4x4_16b_bf16 v[52:55], a[156:157], v[154:155], 0
    v_cvt_pk_bf16_f32 v146, v36, v37
    v_mfma_f32_4x4x4_16b_bf16 v[44:47], a[158:159], v[150:151], v[44:47]
    v_cvt_pk_bf16_f32 v147, v38, v39
    v_mfma_f32_4x4x4_16b_bf16 v[56:59], a[156:157], v[156:157], 0
    v_cvt_pk_bf16_f32 v148, v40, v41
    v_mfma_f32_4x4x4_16b_bf16 v[48:51], a[158:159], v[152:153], v[48:51]
    v_cvt_pk_bf16_f32 v149, v42, v43
    v_mfma_f32_4x4x4_16b_bf16 v[60:63], a[156:157], v[158:159], 0
    v_cvt_pk_bf16_f32 v150, v44, v45
    v_mfma_f32_4x4x4_16b_bf16 v[52:55], a[158:159], v[154:155], v[52:55]
    v_cvt_pk_bf16_f32 v151, v46, v47
    v_mfma_f32_4x4x4_16b_bf16 v[56:59], a[158:159], v[156:157], v[56:59]
    v_cvt_pk_bf16_f32 v152, v48, v49
    v_mfma_f32_4x4x4_16b_bf16 v[60:63], a[158:159], v[158:159], v[60:63]
    v_mov_b32 v114, 0
    v_mov_b32 v115, 0
    v_exp_f32 v200, v200
    v_exp_f32 v201, v201
    v_exp_f32_e64 v202, v202
    v_cvt_pk_bf16_f32 v100, v200, v201
    v_exp_f32 v203, v203
    v_exp_f32 v204, v204
    v_cvt_pk_bf16_f32 v101, v202, v203
    v_exp_f32 v205, v205
    v_exp_f32 v206, v206
    v_cvt_pk_bf16_f32 v102, v204, v205
    v_exp_f32_e64 v207, v207
    v_cvt_pk_bf16_f32 v153, v50, v51
    v_cvt_pk_bf16_f32 v103, v206, v207
    v_cvt_pk_bf16_f32 v154, v52, v53
    v_cvt_pk_bf16_f32 v155, v54, v55
    v_cvt_pk_bf16_f32 v156, v56, v57
    v_cvt_pk_bf16_f32 v157, v58, v59
    v_cvt_pk_bf16_f32 v158, v60, v61
    v_cvt_pk_bf16_f32 v159, v62, v63
    s_waitcnt vmcnt(7)
    s_barrier
    v_mfma_f32_16x16x32_bf16 v[192:195], a[0:3], v[144:147], v[228:231]
    s_cmp_eq_u32 s3, 3
    ds_read_b64_tr_b16 a[64:65], v249 offset:2176
    ds_read_b64_tr_b16 a[66:67], v249 offset:2688
    buffer_load_dwordx4 v251, s[8:11], s23 offen offset:1152 lds
    s_cmov_b32 s56, 0x133963e0
    v_mfma_f32_16x16x32_bf16 v[192:195], a[4:7], v[148:151], v[192:195]
    s_add_u32 s31, s30, s33
    s_add_u32 m0, s33, 35072
    ds_read_b64_tr_b16 a[76:77], v249 offset:2192
    ds_read_b64_tr_b16 a[78:79], v249 offset:2704
    v_mfma_f32_16x16x32_bf16 v[192:195], a[8:11], v[152:155], v[192:195]
    s_add_u32 s30, s30, s80
    ds_read_b64_tr_b16 a[80:81], v249 offset:2208
    ds_read_b64_tr_b16 a[82:83], v249 offset:2720
    buffer_load_dwordx4 v250, s[12:15], s22 offen offset:2176 lds
    s_cmp_eq_u32 s3, 11
    s_cmov_b32 s56, 0x71c751a0
    v_mfma_f32_16x16x32_bf16 v[192:195], a[12:15], v[156:159], v[192:195]
    s_cmp_eq_u32 s30, 105216
    ds_read_b64_tr_b16 a[92:93], v249 offset:2224
    ds_read_b64_tr_b16 a[94:95], v249 offset:2736
    buffer_load_dwordx4 v252, s[12:15], s22 offen offset:3216 lds
    v_mfma_f32_16x16x32_bf16 v[196:199], a[16:19], v[156:159], v[228:231]
    s_cmov_b32 s30, 0
    ds_read_b64_tr_b16 a[96:97], v249 offset:2240
    ds_read_b64_tr_b16 a[98:99], v249 offset:2752
    v_mfma_f32_16x16x32_bf16 v[196:199], a[20:23], v[152:155], v[196:199]
    s_cselect_b32 s35, s81, s80
    s_add_u32 m0, s33, 52608
    ds_read_b64_tr_b16 a[108:109], v249 offset:2256
    ds_read_b64_tr_b16 a[110:111], v249 offset:2768
    v_mfma_f32_16x16x32_bf16 v[196:199], a[24:27], v[148:151], v[196:199]
    s_cmp_eq_u32 s3, 12
    ds_read_b64_tr_b16 a[112:113], v249 offset:2272
    ds_read_b64_tr_b16 a[114:115], v249 offset:2784
    buffer_load_dwordx4 v250, s[12:15], s23 offen offset:2176 lds
    s_cmov_b32 s56, 0x734751a0
    s_cmp_eq_u32 s3, 13
    v_mfma_f32_16x16x32_bf16 v[196:199], a[28:31], v[144:147], v[196:199]
    s_waitcnt lgkmcnt(10)
    ds_read_b64_tr_b16 a[124:125], v249 offset:2288
    ds_read_b64_tr_b16 a[126:127], v249 offset:2800
    buffer_load_dwordx4 v252, s[12:15], s23 offen offset:3216 lds
    s_cmov_b32 s56, 0x3930ac75
    s_cmp_eq_u32 s3, 14
    v_mfma_f32_16x16x32_bf16 v[0:3], v[100:103], a[64:67], 0
    s_cmov_b32 s56, 0x503963e0
    v_exp_f32 v192, v192
    v_mfma_f32_16x16x32_bf16 v[4:7], v[100:103], a[76:79], 0
    s_waitcnt vmcnt(8)
    s_waitcnt lgkmcnt(8)
    ds_read_b128 v[160:163], v254 offset:8704
    ds_read_b128 v[164:167], v254 offset:8768
    v_mfma_f32_16x16x32_bf16 v[8:11], v[100:103], a[80:83], 0
    s_cmp_eq_u32 s3, 15
    ds_read_b128 v[168:171], v254 offset:8832
    ds_read_b128 v[172:175], v254 offset:8896
    v_mfma_f32_16x16x32_bf16 v[12:15], v[100:103], a[92:95], 0
    s_waitcnt lgkmcnt(8)
    v_exp_f32 v193, v193
    v_mfma_f32_16x16x32_bf16 v[16:19], v[100:103], a[96:99], 0
    s_cmov_b32 s56, 0x51b963e0
    v_exp_f32 v194, v194
    v_mfma_f32_16x16x32_bf16 v[20:23], v[100:103], a[108:111], 0
    s_waitcnt lgkmcnt(2)
    v_cvt_pk_bf16_f32 v104, v192, v193
    v_exp_f32_e64 v195, v195
    v_mfma_f32_16x16x32_bf16 v[24:27], v[100:103], a[112:115], 0
    s_and_b32 s40, s56, 0x1fff
    v_exp_f32_e64 v196, v196
    v_mfma_f32_16x16x32_bf16 v[28:31], v[100:103], a[124:127], 0
    s_bfe_u32 s41, s56, 655373
    v_cvt_pk_bf16_f32 v105, v194, v195
    v_exp_f32 v197, v197
    v_smfmac_f32_16x16x64_bf16 v[240:243], a[140:143], v[96:103], v255
    s_bfe_u32 s42, s56, 196635
    s_waitcnt lgkmcnt(0)
    v_exp_f32_e64 v198, v198
    v_mfma_f32_4x4x4_16b_bf16 v[64:67], a[156:157], v[160:161], 0
    v_cvt_pk_bf16_f32 v106, v196, v197
    v_mfma_f32_4x4x4_16b_bf16 v[68:71], a[156:157], v[162:163], 0
    v_exp_f32 v199, v199
    v_mfma_f32_4x4x4_16b_bf16 v[72:75], a[156:157], v[164:165], 0
    v_cvt_pk_bf16_f32 v107, v198, v199
    v_mfma_f32_4x4x4_16b_bf16 v[64:67], a[158:159], v[160:161], v[64:67]
    s_lshl1_add_u32 s42, s42, s21
    v_mfma_f32_4x4x4_16b_bf16 v[76:79], a[156:157], v[166:167], 0
    s_and_b32 s42, s42, 15
    v_mfma_f32_4x4x4_16b_bf16 v[68:71], a[158:159], v[162:163], v[68:71]
    s_lshl4_add_u32 s42, s40, s42
    v_mfma_f32_4x4x4_16b_bf16 v[80:83], a[156:157], v[168:169], 0
    v_cvt_pk_bf16_f32 v160, v64, v65
    v_mfma_f32_4x4x4_16b_bf16 v[72:75], a[158:159], v[164:165], v[72:75]
    v_cvt_pk_bf16_f32 v161, v66, v67
    v_mfma_f32_4x4x4_16b_bf16 v[84:87], a[156:157], v[170:171], 0
    v_cvt_pk_bf16_f32 v162, v68, v69
    v_mfma_f32_4x4x4_16b_bf16 v[76:79], a[158:159], v[166:167], v[76:79]
    v_cvt_pk_bf16_f32 v163, v70, v71
    v_mfma_f32_4x4x4_16b_bf16 v[88:91], a[156:157], v[172:173], 0
    v_cvt_pk_bf16_f32 v164, v72, v73
    v_mfma_f32_4x4x4_16b_bf16 v[80:83], a[158:159], v[168:169], v[80:83]
    v_cvt_pk_bf16_f32 v165, v74, v75
    v_mfma_f32_4x4x4_16b_bf16 v[92:95], a[156:157], v[174:175], 0
    v_cvt_pk_bf16_f32 v166, v76, v77
    v_mfma_f32_4x4x4_16b_bf16 v[84:87], a[158:159], v[170:171], v[84:87]
    v_cvt_pk_bf16_f32 v167, v78, v79
    v_mfma_f32_4x4x4_16b_bf16 v[88:91], a[158:159], v[172:173], v[88:91]
    v_cvt_pk_bf16_f32 v168, v80, v81
    v_mfma_f32_4x4x4_16b_bf16 v[92:95], a[158:159], v[174:175], v[92:95]
    v_cvt_pk_bf16_f32 v169, v82, v83
    v_cvt_pk_bf16_f32 v170, v84, v85
    v_cvt_pk_bf16_f32 v171, v86, v87
    v_cvt_pk_bf16_f32 v172, v88, v89
    v_cvt_pk_bf16_f32 v173, v90, v91
    v_cvt_pk_bf16_f32 v174, v92, v93
    v_cvt_pk_bf16_f32 v175, v94, v95
    v_mfma_f32_16x16x32_bf16 v[200:203], a[0:3], v[160:163], v[232:235]
    s_lshl_b32 s26, s42, 8
    s_mov_b32 s22, s24
    s_add_u32 s23, s24, s25
    v_mfma_f32_16x16x32_bf16 v[200:203], a[4:7], v[164:167], v[200:203]
    s_sub_u32 s43, s41, 1
    s_add_u32 s24, s23, s25
    s_add_u32 m0, s33, 70144
    v_mfma_f32_16x16x32_bf16 v[200:203], a[8:11], v[168:171], v[200:203]
    s_and_b32 s44, s43, 31
    buffer_load_dwordx4 v250, s[8:11], s22 offen offset:0 lds
    s_add_u32 s44, s44, 1
    s_lshl_b64 s[46:47], -1, s44
    v_mfma_f32_16x16x32_bf16 v[200:203], a[12:15], v[172:175], v[200:203]
    s_not_b32 s46, s46
    buffer_load_dwordx4 v251, s[8:11], s22 offen offset:1152 lds
    v_lshrrev_b32 v176, v188, s46
    v_mfma_f32_16x16x32_bf16 v[204:207], a[16:19], v[172:175], v[232:235]
    s_mov_b32 s46, 0xffff
    v_or_b32 v176, v176, v189
    v_bfe_i32 v177, v176, 0, 1
    v_bfe_i32 v178, v176, 1, 1
    v_bfe_i32 v179, v176, 16, 1
    v_bfe_i32 v180, v176, 17, 1
    v_bfe_i32 v181, v176, 4, 1
    v_bfe_i32 v182, v176, 5, 1
    v_bfe_i32 v183, v176, 20, 1
    v_bfe_i32 v184, v176, 21, 1
    v_bfi_b32 v177, s46, v177, v178
    v_bfi_b32 v179, s46, v179, v180
    v_bfi_b32 v181, s46, v181, v182
    v_bfi_b32 v183, s46, v183, v184
    v_and_b32 v178, v177, v191
    v_and_b32 v177, v177, v190
    v_and_b32 v180, v179, v191
    v_and_b32 v179, v179, v190
    v_and_b32 v182, v181, v191
    v_and_b32 v181, v181, v190
    v_and_b32 v184, v183, v191
    v_and_b32 v183, v183, v190
    v_accvgpr_write_b32 a148, v177
    v_accvgpr_write_b32 a152, v178
    v_accvgpr_write_b32 a149, v179
    v_accvgpr_write_b32 a153, v180
    v_accvgpr_write_b32 a150, v181
    v_accvgpr_write_b32 a154, v182
    v_accvgpr_write_b32 a151, v183
    v_accvgpr_write_b32 a155, v184
    s_lshl_b32 s77, s44, 12
    s_add_u32 s42, s40, s44
    buffer_load_dwordx4 v250, s[12:15], s22 offen offset:2176 lds
    s_lshl_b32 s42, s42, 12
    s_add_u32 s78, s42, 2176
    v_mfma_f32_16x16x32_bf16 v[204:207], a[20:23], v[168:171], v[204:207]
    s_add_u32 s42, s40, s41
    buffer_load_dwordx4 v252, s[12:15], s22 offen offset:3216 lds
    s_lshl_b32 s38, s42, 12
    s_lshr_b32 s39, s56, 30
    v_add_u32_e64 v248, s35, v248
    v_mfma_f32_16x16x32_bf16 v[204:207], a[24:27], v[164:167], v[204:207]
    s_add_u32 s39, s39, 2
    v_exp_f32_e64 v200, v200
    v_mfma_f32_16x16x32_bf16 v[204:207], a[28:31], v[160:163], v[204:207]
    s_waitcnt vmcnt(8)
    v_exp_f32_e64 v201, v201
    s_barrier
    v_mfma_f32_16x16x32_bf16 v[32:35], v[104:107], a[64:67], 0
    s_add_u32 m0, s33, 87680
    ds_read_b128 a[0:3], v248 offset:0
    ds_read_b128 a[4:7], v248 offset:64
    v_mfma_f32_16x16x32_bf16 v[36:39], v[104:107], a[76:79], 0
    s_mul_i32 s42, s39, s20
    ds_read_b128 a[8:11], v248 offset:128
    ds_read_b128 a[12:15], v248 offset:192
    buffer_load_dwordx4 v250, s[8:11], s23 offen offset:0 lds
    s_bfe_u32 s40, s56, 262167
    s_lshl2_add_u32 s42, s40, s42
    v_mfma_f32_16x16x32_bf16 v[40:43], v[104:107], a[80:83], 0
    s_lshl_b32 s42, s42, 16
    ds_read_b128 a[16:19], v248 offset:704
    ds_read_b128 a[20:23], v248 offset:640
    buffer_load_dwordx4 v251, s[8:11], s23 offen offset:1152 lds
    s_add_u32 s37, s26, s42
    s_lshr_b32 s36, s43, 5
    v_mfma_f32_16x16x32_bf16 v[44:47], v[104:107], a[92:95], 0
    s_add_u32 s36, s36, 1
    ds_read_b128 a[24:27], v248 offset:576
    ds_read_b128 a[28:31], v248 offset:512
    buffer_load_dwordx4 v250, s[12:15], s23 offen offset:2176 lds
    s_and_b32 s40, s36, 1
    s_lshl1_add_u32 s39, s39, s40
    v_mfma_f32_16x16x32_bf16 v[48:51], v[104:107], a[96:99], 0
    s_add_u32 s28, s26, s77
    ds_read_b128 a[32:35], v248 offset:17536
    ds_read_b128 a[36:39], v248 offset:17600
    buffer_load_dwordx4 v252, s[12:15], s23 offen offset:3216 lds
    s_sub_u32 s40, s36, 2
    s_lshl_b32 s40, s40, 17
    v_mfma_f32_16x16x32_bf16 v[52:55], v[104:107], a[108:111], 0
    s_mov_b32 s22, s24
    s_add_u32 s23, s24, s25
    ds_read_b128 a[40:43], v248 offset:17664
    ds_read_b128 a[44:47], v248 offset:17728
    v_mfma_f32_16x16x32_bf16 v[56:59], v[104:107], a[112:115], 0
    s_add_u32 s24, s23, s25
    s_mov_b32 s32, s31
    ds_read_b128 a[48:51], v248 offset:18240
    ds_read_b128 a[52:55], v248 offset:18176
    v_mfma_f32_16x16x32_bf16 v[60:63], v[104:107], a[124:127], 0
    s_mov_b32 m0, s31
    ds_read_b128 a[56:59], v248 offset:18112
    ds_read_b128 a[60:63], v248 offset:18048
    v_smfmac_f32_16x16x64_bf16 v[240:243], a[144:147], v[104:111], v255
    s_add_u32 s40, s40, s28
    s_waitcnt lgkmcnt(14)
    buffer_load_dwordx4 v250, s[8:11], s22 offen offset:0 lds
    s_bitcmp1_b32 0x6800, s3
    s_cmov_b32 s28, s40
    v_mfma_f32_16x16x32_bf16 v[192:195], a[0:3], v[128:131], v[224:227]
    s_cselect_b32 s29, 0xfffe0000, s25
    v_exp_f32 v202, v202
    v_mfma_f32_16x16x32_bf16 v[192:195], a[4:7], v[132:135], v[192:195]
    s_waitcnt lgkmcnt(12)
    buffer_load_dwordx4 v251, s[8:11], s22 offen offset:1152 lds
    s_add_u32 s40, s28, s29
    s_bitcmp1_b32 s39, 0
    v_add_u32 v249, s35, v249
    v_mfma_f32_16x16x32_bf16 v[192:195], a[8:11], v[136:139], v[192:195]
    s_cselect_b32 s27, s28, 2.0
    v_cvt_pk_bf16_f32 v116, v200, v201
    v_exp_f32 v203, v203
    v_mfma_f32_16x16x32_bf16 v[192:195], a[12:15], v[140:143], v[192:195]
    s_waitcnt lgkmcnt(10)
    buffer_load_dwordx4 v250, s[12:15], s22 offen offset:2176 lds
    s_cmov_b32 s28, s40
    s_lshr_b32 s41, s76, 3
    v_mfma_f32_16x16x32_bf16 v[196:199], a[16:19], v[140:143], v[224:227]
    s_and_b32 s40, s39, -2
    v_exp_f32_e64 v204, v204
    v_mfma_f32_16x16x32_bf16 v[196:199], a[20:23], v[136:139], v[196:199]
    s_waitcnt lgkmcnt(8)
    buffer_load_dwordx4 v252, s[12:15], s22 offen offset:3216 lds
    s_lshr_b32 s40, s40, s41
    s_sub_u32 s53, s34, s40
    v_mfma_f32_16x16x32_bf16 v[196:199], a[24:27], v[132:135], v[196:199]
    s_add_i32 s32, s32, 17536
    v_cvt_pk_bf16_f32 v117, v202, v203
    s_mov_b32 m0, s32
    v_mfma_f32_16x16x32_bf16 v[196:199], a[28:31], v[128:131], v[196:199]
    s_waitcnt lgkmcnt(6)
    v_exp_f32_e64 v205, v205
    v_exp_f32_e64 v206, v206
    v_cvt_pk_bf16_f32 v118, v204, v205
    v_exp_f32_e64 v207, v207
    s_mov_b32 s14, 0x13da880
    v_cvt_pk_bf16_f32 v119, v206, v207
    v_mfma_f32_16x16x32_bf16 v[200:203], a[32:35], v[128:131], v[224:227]
    s_min_u32 s40, s53, 2
    buffer_load_dwordx4 v250, s[8:11], s23 offen offset:0 lds
    s_sub_u32 s53, s53, s40
    s_sub_u32 s3, s34, s40
    v_mfma_f32_16x16x32_bf16 v[200:203], a[36:39], v[132:135], v[200:203]
    s_waitcnt lgkmcnt(4)
    v_exp_f32 v192, v192
    v_mfma_f32_16x16x32_bf16 v[200:203], a[40:43], v[136:139], v[200:203]
    s_cmp_eq_u32 s56, 0
    buffer_load_dwordx4 v251, s[8:11], s23 offen offset:1152 lds
    s_cmov_b32 s3, -1
    s_cmov_b32 s39, 0
    v_mfma_f32_16x16x32_bf16 v[200:203], a[44:47], v[140:143], v[200:203]
    s_waitcnt lgkmcnt(2)
    v_exp_f32 v193, v193
    v_mfma_f32_16x16x32_bf16 v[204:207], a[48:51], v[140:143], v[224:227]
    s_cmov_b32 s26, 2.0
    v_exp_f32_e64 v194, v194
    v_mfma_f32_16x16x32_bf16 v[204:207], a[52:55], v[136:139], v[204:207]
    s_waitcnt lgkmcnt(0)
    v_exp_f32 v195, v195
    v_mfma_f32_16x16x32_bf16 v[204:207], a[56:59], v[132:135], v[204:207]
    s_cmov_b32 s27, 2.0
    v_cvt_pk_bf16_f32 v100, v192, v193
    v_cvt_pk_bf16_f32 v101, v194, v195
    v_mfma_f32_16x16x32_bf16 v[204:207], a[60:63], v[128:131], v[204:207]
    s_cmov_b32 s28, 2.0
    v_exp_f32 v196, v196
    v_mfma_f32_16x16x32_bf16 v[64:67], v[116:119], a[64:67], 0
    v_exp_f32_e64 v197, v197
    v_mfma_f32_16x16x32_bf16 v[68:71], v[116:119], a[76:79], 0
    v_exp_f32_e64 v198, v198
    v_mfma_f32_16x16x32_bf16 v[72:75], v[116:119], a[80:83], 0
    v_exp_f32_e64 v199, v199
    v_mfma_f32_16x16x32_bf16 v[76:79], v[116:119], a[92:95], 0
    s_waitcnt vmcnt(14)
    v_cvt_pk_bf16_f32 v102, v196, v197
    s_barrier
    v_mfma_f32_16x16x32_bf16 v[80:83], v[116:119], a[96:99], 0
    ds_read_b64_tr_b16 a[64:65], v249 offset:2176
    ds_read_b64_tr_b16 a[66:67], v249 offset:2688
    ds_read_b64_tr_b16 a[68:69], v249 offset:19712
    ds_read_b64_tr_b16 a[70:71], v249 offset:20224
    v_mfma_f32_16x16x32_bf16 v[84:87], v[116:119], a[108:111], 0
    s_mov_b32 s51, s50
    ds_read_b64_tr_b16 a[72:73], v249 offset:19728
    ds_read_b64_tr_b16 a[74:75], v249 offset:20240
    ds_read_b64_tr_b16 a[76:77], v249 offset:2192
    ds_read_b64_tr_b16 a[78:79], v249 offset:2704
    v_mfma_f32_16x16x32_bf16 v[88:91], v[116:119], a[112:115], 0
    s_mov_b32 s52, s37
    ds_read_b64_tr_b16 a[80:81], v249 offset:2208
    ds_read_b64_tr_b16 a[82:83], v249 offset:2720
    ds_read_b64_tr_b16 a[84:85], v249 offset:19744
    ds_read_b64_tr_b16 a[86:87], v249 offset:20256
    v_mfma_f32_16x16x32_bf16 v[92:95], v[116:119], a[124:127], 0
    s_mov_b32 s6, s38
    ds_read_b64_tr_b16 a[88:89], v249 offset:19760
    ds_read_b64_tr_b16 a[90:91], v249 offset:20272
    ds_read_b64_tr_b16 a[92:93], v249 offset:2224
    ds_read_b64_tr_b16 a[94:95], v249 offset:2736
    v_smfmac_f32_16x16x64_bf16 v[244:247], a[140:143], v[112:119], v255
    v_cvt_pk_bf16_f32 v103, v198, v199
    v_exp_f32 v200, v200
    v_exp_f32 v201, v201
    v_exp_f32 v202, v202
    v_exp_f32 v203, v203
    v_cvt_pk_bf16_f32 v96, v200, v201
    v_cvt_pk_bf16_f32 v97, v202, v203
    v_exp_f32 v204, v204
    s_branch L_loop_3
.p2align 12
.p2align 5
P_laste_4:
    s_setpc_b64 s[62:63]
.fill 1, 4, 0xbf800000
L_laste_4:
    v_exp_f32 v194, v194
    v_mfma_f32_16x16x32_bf16 v[200:203], a[0:3], v[144:147], v[228:231]
    v_exp_f32 v195, v195
    v_mfma_f32_16x16x32_bf16 v[200:203], a[4:7], v[148:151], v[200:203]
    v_cvt_pk_bf16_f32 v212, v192, v193
    v_cvt_pk_bf16_f32 v213, v194, v195
    v_mfma_f32_16x16x32_bf16 v[200:203], a[8:11], v[152:155], v[200:203]
    v_exp_f32_e64 v196, v196
    v_mfma_f32_16x16x32_bf16 v[200:203], a[12:15], v[156:159], v[200:203]
    v_exp_f32 v197, v197
    v_mfma_f32_16x16x32_bf16 v[204:207], a[16:19], v[156:159], v[228:231]
    v_exp_f32 v198, v198
    v_mfma_f32_16x16x32_bf16 v[204:207], a[20:23], v[152:155], v[204:207]
    v_exp_f32_e64 v199, v199
    v_mfma_f32_16x16x32_bf16 v[204:207], a[24:27], v[148:151], v[204:207]
    v_cvt_pk_bf16_f32 v214, v196, v197
    v_cvt_pk_bf16_f32 v215, v198, v199
    v_mfma_f32_16x16x32_bf16 v[204:207], a[28:31], v[144:147], v[204:207]
    v_exp_f32_e64 v200, v200
    v_mfma_f32_16x16x32_bf16 v[96:99], v[216:219], a[64:67], v[96:99]
    ds_read_b64_tr_b16 a[64:65], v249 offset:2176
    ds_read_b64_tr_b16 a[66:67], v249 offset:2688
    v_mfma_f32_16x16x32_bf16 v[96:99], v[220:223], a[68:71], v[96:99]
    v_exp_f32 v201, v201
    v_mfma_f32_16x16x32_bf16 v[100:103], v[220:223], a[72:75], v[100:103]
    v_exp_f32 v202, v202
    v_mfma_f32_16x16x32_bf16 v[100:103], v[216:219], a[76:79], v[100:103]
    ds_read_b64_tr_b16 a[76:77], v249 offset:2192
    ds_read_b64_tr_b16 a[78:79], v249 offset:2704
    v_mfma_f32_16x16x32_bf16 v[104:107], v[216:219], a[80:83], v[104:107]
    ds_read_b64_tr_b16 a[80:81], v249 offset:2208
    ds_read_b64_tr_b16 a[82:83], v249 offset:2720
    v_mfma_f32_16x16x32_bf16 v[104:107], v[220:223], a[84:87], v[104:107]
    v_exp_f32_e64 v203, v203
    v_mfma_f32_16x16x32_bf16 v[108:111], v[220:223], a[88:91], v[108:111]
    v_exp_f32_e64 v204, v204
    v_mfma_f32_16x16x32_bf16 v[108:111], v[216:219], a[92:95], v[108:111]
    ds_read_b64_tr_b16 a[92:93], v249 offset:2224
    ds_read_b64_tr_b16 a[94:95], v249 offset:2736
    v_mfma_f32_16x16x32_bf16 v[112:115], v[216:219], a[96:99], v[112:115]
    ds_read_b64_tr_b16 a[96:97], v249 offset:2240
    ds_read_b64_tr_b16 a[98:99], v249 offset:2752
    v_mfma_f32_16x16x32_bf16 v[112:115], v[220:223], a[100:103], v[112:115]
    v_exp_f32 v205, v205
    v_mfma_f32_16x16x32_bf16 v[116:119], v[220:223], a[104:107], v[116:119]
    v_exp_f32 v206, v206
    v_mfma_f32_16x16x32_bf16 v[116:119], v[216:219], a[108:111], v[116:119]
    ds_read_b64_tr_b16 a[108:109], v249 offset:2256
    ds_read_b64_tr_b16 a[110:111], v249 offset:2768
    v_mfma_f32_16x16x32_bf16 v[120:123], v[216:219], a[112:115], v[120:123]
    ds_read_b64_tr_b16 a[112:113], v249 offset:2272
    ds_read_b64_tr_b16 a[114:115], v249 offset:2784
    v_mfma_f32_16x16x32_bf16 v[120:123], v[220:223], a[116:119], v[120:123]
    v_exp_f32_e64 v207, v207
    v_mfma_f32_16x16x32_bf16 v[124:127], v[220:223], a[120:123], v[124:127]
    v_accvgpr_read_b32 v208, a164
    v_mfma_f32_16x16x32_bf16 v[124:127], v[216:219], a[124:127], v[124:127]
    ds_read_b64_tr_b16 a[124:125], v249 offset:2288
    ds_read_b64_tr_b16 a[126:127], v249 offset:2800
    v_smfmac_f32_16x16x64_bf16 v[244:247], a[136:139], v[216:223], v255
    s_mov_b32 s40, s73
    v_smfmac_f32_16x16x64_bf16 v[240:243], a[168:171], v[212:219], v255
    s_waitcnt lgkmcnt(4)
    v_mfma_f32_16x16x32_bf16 v[0:3], v[212:215], a[64:67], v[0:3]
    v_mfma_f32_16x16x32_bf16 v[4:7], v[212:215], a[76:79], v[4:7]
    v_add_f32_e64 v209, v240, v241
    v_subrev_u32 v210, 0x37800000, v209
    v_mfma_f32_16x16x32_bf16 v[8:11], v[212:215], a[80:83], v[8:11]
    v_rcp_f32_e64 v209, v209
    v_mfma_f32_16x16x32_bf16 v[12:15], v[212:215], a[92:95], v[12:15]
    v_cmp_lt_u32 s[66:67], s79, v210
    v_mov_b32_dpp v209, v209 row_ror:12 row_mask:0xa bank_mask:0xf
    v_mfma_f32_16x16x32_bf16 v[16:19], v[212:215], a[96:99], v[16:19]
    s_or_b64 s[64:65], s[64:65], s[66:67]
    v_mov_b32_dpp v209, v209 row_ror:8 row_mask:0xc bank_mask:0xf
    v_mfma_f32_16x16x32_bf16 v[20:23], v[212:215], a[108:111], v[20:23]
    s_waitcnt lgkmcnt(0)
    v_mov_b32_dpp v220, v209 row_newbcast:0 row_mask:0xf bank_mask:0xf
    v_mov_b32_dpp v221, v209 row_newbcast:1 row_mask:0xf bank_mask:0xf
    v_mfma_f32_16x16x32_bf16 v[24:27], v[212:215], a[112:115], v[24:27]
    v_mov_b32_dpp v222, v209 row_newbcast:2 row_mask:0xf bank_mask:0xf
    v_mov_b32_dpp v223, v209 row_newbcast:3 row_mask:0xf bank_mask:0xf
    v_mfma_f32_16x16x32_bf16 v[28:31], v[212:215], a[124:127], v[28:31]
    v_cvt_pk_bf16_f32 v216, v200, v201
    v_cvt_pk_bf16_f32 v217, v202, v203
    v_cvt_pk_bf16_f32 v218, v204, v205
    v_cvt_pk_bf16_f32 v219, v206, v207
    v_pk_mul_f32 v[0:1], v[0:1], v[220:221]
    v_pk_mul_f32 v[2:3], v[2:3], v[222:223]
    v_pk_mul_f32 v[4:5], v[4:5], v[220:221]
    v_pk_mul_f32 v[6:7], v[6:7], v[222:223]
    v_pk_mul_f32 v[8:9], v[8:9], v[220:221]
    v_pk_mul_f32 v[10:11], v[10:11], v[222:223]
    v_pk_mul_f32 v[12:13], v[12:13], v[220:221]
    v_pk_mul_f32 v[14:15], v[14:15], v[222:223]
    v_pk_mul_f32 v[16:17], v[16:17], v[220:221]
    v_pk_mul_f32 v[18:19], v[18:19], v[222:223]
    v_pk_mul_f32 v[20:21], v[20:21], v[220:221]
    v_pk_mul_f32 v[22:23], v[22:23], v[222:223]
    v_pk_mul_f32 v[24:25], v[24:25], v[220:221]
    v_pk_mul_f32 v[26:27], v[26:27], v[222:223]
    v_pk_mul_f32 v[28:29], v[28:29], v[220:221]
    v_pk_mul_f32 v[30:31], v[30:31], v[222:223]
    v_smfmac_f32_16x16x64_bf16 v[240:243], a[172:175], v[212:219], v255
    v_cvt_pk_bf16_f32 v0, v0, v4
    v_mfma_f32_16x16x32_bf16 v[32:35], v[216:219], a[64:67], v[32:35]
    v_cvt_pk_bf16_f32 v4, v1, v5
    v_cvt_pk_bf16_f32 v1, v8, v12
    v_mfma_f32_16x16x32_bf16 v[36:39], v[216:219], a[76:79], v[36:39]
    v_add_f32_e64 v209, v242, v243
    v_subrev_u32 v210, 0x37800000, v209
    v_mfma_f32_16x16x32_bf16 v[40:43], v[216:219], a[80:83], v[40:43]
    v_rcp_f32_e64 v209, v209
    v_mfma_f32_16x16x32_bf16 v[44:47], v[216:219], a[92:95], v[44:47]
    v_cmp_lt_u32 s[66:67], s79, v210
    v_mov_b32_dpp v209, v209 row_ror:12 row_mask:0xa bank_mask:0xf
    v_mfma_f32_16x16x32_bf16 v[48:51], v[216:219], a[96:99], v[48:51]
    s_or_b64 s[64:65], s[64:65], s[66:67]
    v_cvt_pk_bf16_f32 v5, v9, v13
    v_mov_b32_dpp v209, v209 row_ror:8 row_mask:0xc bank_mask:0xf
    v_mfma_f32_16x16x32_bf16 v[52:55], v[216:219], a[108:111], v[52:55]
    s_nop 0
    v_mov_b32_dpp v220, v209 row_newbcast:0 row_mask:0xf bank_mask:0xf
    v_mov_b32_dpp v221, v209 row_newbcast:1 row_mask:0xf bank_mask:0xf
    v_mfma_f32_16x16x32_bf16 v[56:59], v[216:219], a[112:115], v[56:59]
    v_mov_b32_dpp v222, v209 row_newbcast:2 row_mask:0xf bank_mask:0xf
    v_mov_b32_dpp v223, v209 row_newbcast:3 row_mask:0xf bank_mask:0xf
    v_mfma_f32_16x16x32_bf16 v[60:63], v[216:219], a[124:127], v[60:63]
    v_cvt_pk_bf16_f32 v8, v2, v6
    v_cvt_pk_bf16_f32 v12, v3, v7
    v_cvt_pk_bf16_f32 v9, v10, v14
    v_cvt_pk_bf16_f32 v13, v11, v15
    v_cvt_pk_bf16_f32 v2, v16, v20
    v_cvt_pk_bf16_f32 v6, v17, v21
    v_cvt_pk_bf16_f32 v10, v18, v22
    v_cvt_pk_bf16_f32 v14, v19, v23
    v_pk_mul_f32 v[32:33], v[32:33], v[220:221]
    v_mfma_f32_4x4x4_16b_bf16 v[16:19], v[0:1], a[160:161], 0 cbsz:1 abid:0
    v_cvt_pk_bf16_f32 v3, v24, v28
    v_mfma_f32_4x4x4_16b_bf16 v[20:23], v[0:1], a[160:161], 0 cbsz:1 abid:1
    v_cvt_pk_bf16_f32 v7, v25, v29
    v_cvt_pk_bf16_f32 v11, v26, v30
    v_mfma_f32_4x4x4_16b_bf16 v[16:19], v[2:3], a[162:163], v[16:19] cbsz:1 abid:0
    v_cvt_pk_bf16_f32 v15, v27, v31
    v_mfma_f32_4x4x4_16b_bf16 v[20:23], v[2:3], a[162:163], v[20:23] cbsz:1 abid:1
    v_mfma_f32_4x4x4_16b_bf16 v[24:27], v[4:5], a[160:161], 0 cbsz:1 abid:0
    v_mfma_f32_4x4x4_16b_bf16 v[28:31], v[4:5], a[160:161], 0 cbsz:1 abid:1
    v_cvt_pk_bf16_f32 v0, v16, v17
    v_mfma_f32_4x4x4_16b_bf16 v[24:27], v[6:7], a[162:163], v[24:27] cbsz:1 abid:0
    v_cvt_pk_bf16_f32 v1, v18, v19
    v_cvt_pk_bf16_f32 v2, v20, v21
    v_cvt_pk_bf16_f32 v3, v22, v23
    v_mfma_f32_4x4x4_16b_bf16 v[28:31], v[6:7], a[162:163], v[28:31] cbsz:1 abid:1
    buffer_store_dwordx4 v[0:3], v208, s[16:19], s40 offen sc1 nt
    s_add_i32 s40, s40, 0x4000
    v_pk_mul_f32 v[34:35], v[34:35], v[222:223]
    v_pk_mul_f32 v[36:37], v[36:37], v[220:221]
    v_mfma_f32_4x4x4_16b_bf16 v[16:19], v[8:9], a[160:161], 0 cbsz:1 abid:0
    v_cvt_pk_bf16_f32 v4, v24, v25
    v_mfma_f32_4x4x4_16b_bf16 v[20:23], v[8:9], a[160:161], 0 cbsz:1 abid:1
    v_cvt_pk_bf16_f32 v5, v26, v27
    v_mfma_f32_4x4x4_16b_bf16 v[16:19], v[10:11], a[162:163], v[16:19] cbsz:1 abid:0
    v_cvt_pk_bf16_f32 v6, v28, v29
    v_cvt_pk_bf16_f32 v7, v30, v31
    v_mfma_f32_4x4x4_16b_bf16 v[20:23], v[10:11], a[162:163], v[20:23] cbsz:1 abid:1
    buffer_store_dwordx4 v[4:7], v208, s[16:19], s40 offen sc1 nt
    s_add_i32 s40, s40, 0x4000
    v_pk_mul_f32 v[38:39], v[38:39], v[222:223]
    v_pk_mul_f32 v[40:41], v[40:41], v[220:221]
    v_mfma_f32_4x4x4_16b_bf16 v[24:27], v[12:13], a[160:161], 0 cbsz:1 abid:0
    v_cvt_pk_bf16_f32 v8, v16, v17
    v_mfma_f32_4x4x4_16b_bf16 v[28:31], v[12:13], a[160:161], 0 cbsz:1 abid:1
    v_cvt_pk_bf16_f32 v9, v18, v19
    v_mfma_f32_4x4x4_16b_bf16 v[24:27], v[14:15], a[162:163], v[24:27] cbsz:1 abid:0
    v_cvt_pk_bf16_f32 v10, v20, v21
    v_cvt_pk_bf16_f32 v11, v22, v23
    v_mfma_f32_4x4x4_16b_bf16 v[28:31], v[14:15], a[162:163], v[28:31] cbsz:1 abid:1
    buffer_store_dwordx4 v[8:11], v208, s[16:19], s40 offen sc1 nt
    s_add_i32 s40, s40, 0x4000
    v_pk_mul_f32 v[42:43], v[42:43], v[222:223]
    v_pk_mul_f32 v[44:45], v[44:45], v[220:221]
    v_pk_mul_f32 v[46:47], v[46:47], v[222:223]
    v_pk_mul_f32 v[48:49], v[48:49], v[220:221]
    v_pk_mul_f32 v[50:51], v[50:51], v[222:223]
    v_pk_mul_f32 v[52:53], v[52:53], v[220:221]
    v_pk_mul_f32 v[54:55], v[54:55], v[222:223]
    v_pk_mul_f32 v[56:57], v[56:57], v[220:221]
    v_pk_mul_f32 v[58:59], v[58:59], v[222:223]
    v_pk_mul_f32 v[60:61], v[60:61], v[220:221]
    v_pk_mul_f32 v[62:63], v[62:63], v[222:223]
    v_mfma_f32_16x16x32_bf16 v[192:195], a[0:3], v[160:163], v[232:235]
    v_cvt_pk_bf16_f32 v12, v24, v25
    v_cvt_pk_bf16_f32 v13, v26, v27
    v_mfma_f32_16x16x32_bf16 v[192:195], a[4:7], v[164:167], v[192:195]
    v_cvt_pk_bf16_f32 v14, v28, v29
    v_cvt_pk_bf16_f32 v15, v30, v31
    v_mfma_f32_16x16x32_bf16 v[192:195], a[8:11], v[168:171], v[192:195]
    buffer_store_dwordx4 v[12:15], v208, s[16:19], s40 offen sc1 nt
    s_add_i32 s40, s40, 0x4000
    v_cvt_pk_bf16_f32 v32, v32, v36
    v_mfma_f32_16x16x32_bf16 v[192:195], a[12:15], v[172:175], v[192:195]
    v_cvt_pk_bf16_f32 v36, v33, v37
    v_cvt_pk_bf16_f32 v33, v40, v44
    v_mfma_f32_16x16x32_bf16 v[196:199], a[16:19], v[172:175], v[232:235]
    v_cvt_pk_bf16_f32 v37, v41, v45
    v_cvt_pk_bf16_f32 v40, v34, v38
    v_mfma_f32_16x16x32_bf16 v[196:199], a[20:23], v[168:171], v[196:199]
    v_exp_f32 v192, v192
    v_mfma_f32_16x16x32_bf16 v[196:199], a[24:27], v[164:167], v[196:199]
    v_exp_f32 v193, v193
    v_mfma_f32_16x16x32_bf16 v[196:199], a[28:31], v[160:163], v[196:199]
    v_cvt_pk_bf16_f32 v44, v35, v39
    v_cvt_pk_bf16_f32 v41, v42, v46
    v_cvt_pk_bf16_f32 v45, v43, v47
    v_cvt_pk_bf16_f32 v34, v48, v52
    v_cvt_pk_bf16_f32 v38, v49, v53
    v_cvt_pk_bf16_f32 v42, v50, v54
    v_cvt_pk_bf16_f32 v46, v51, v55
    v_mfma_f32_4x4x4_16b_bf16 v[48:51], v[32:33], a[160:161], 0 cbsz:1 abid:0
    v_cvt_pk_bf16_f32 v35, v56, v60
    v_mfma_f32_4x4x4_16b_bf16 v[52:55], v[32:33], a[160:161], 0 cbsz:1 abid:1
    v_cvt_pk_bf16_f32 v39, v57, v61
    v_cvt_pk_bf16_f32 v43, v58, v62
    v_mfma_f32_4x4x4_16b_bf16 v[48:51], v[34:35], a[162:163], v[48:51] cbsz:1 abid:0
    v_cvt_pk_bf16_f32 v47, v59, v63
    v_mfma_f32_4x4x4_16b_bf16 v[52:55], v[34:35], a[162:163], v[52:55] cbsz:1 abid:1
    v_exp_f32_e64 v194, v194
    v_mfma_f32_4x4x4_16b_bf16 v[56:59], v[36:37], a[160:161], 0 cbsz:1 abid:0
    v_cvt_pk_bf16_f32 v212, v192, v193
    v_mfma_f32_4x4x4_16b_bf16 v[60:63], v[36:37], a[160:161], 0 cbsz:1 abid:1
    v_cvt_pk_bf16_f32 v32, v48, v49
    v_mfma_f32_4x4x4_16b_bf16 v[56:59], v[38:39], a[162:163], v[56:59] cbsz:1 abid:0
    v_cvt_pk_bf16_f32 v33, v50, v51
    v_cvt_pk_bf16_f32 v34, v52, v53
    v_cvt_pk_bf16_f32 v35, v54, v55
    v_mfma_f32_4x4x4_16b_bf16 v[60:63], v[38:39], a[162:163], v[60:63] cbsz:1 abid:1
    buffer_store_dwordx4 v[32:35], v208, s[16:19], s40 offen sc1 nt
    s_addk_i32 s40, 0x4000
    v_exp_f32 v195, v195
    v_mfma_f32_4x4x4_16b_bf16 v[48:51], v[40:41], a[160:161], 0 cbsz:1 abid:0
    v_cvt_pk_bf16_f32 v36, v56, v57
    v_mfma_f32_4x4x4_16b_bf16 v[52:55], v[40:41], a[160:161], 0 cbsz:1 abid:1
    v_cvt_pk_bf16_f32 v37, v58, v59
    v_mfma_f32_4x4x4_16b_bf16 v[48:51], v[42:43], a[162:163], v[48:51] cbsz:1 abid:0
    v_cvt_pk_bf16_f32 v38, v60, v61
    v_cvt_pk_bf16_f32 v39, v62, v63
    v_mfma_f32_4x4x4_16b_bf16 v[52:55], v[42:43], a[162:163], v[52:55] cbsz:1 abid:1
    buffer_store_dwordx4 v[36:39], v208, s[16:19], s40 offen sc1 nt
    s_addk_i32 s40, 0x4000
    v_exp_f32 v196, v196
    v_mfma_f32_4x4x4_16b_bf16 v[56:59], v[44:45], a[160:161], 0 cbsz:1 abid:0
    v_cvt_pk_bf16_f32 v40, v48, v49
    v_mfma_f32_4x4x4_16b_bf16 v[60:63], v[44:45], a[160:161], 0 cbsz:1 abid:1
    v_cvt_pk_bf16_f32 v41, v50, v51
    v_mfma_f32_4x4x4_16b_bf16 v[56:59], v[46:47], a[162:163], v[56:59] cbsz:1 abid:0
    v_cvt_pk_bf16_f32 v42, v52, v53
    v_cvt_pk_bf16_f32 v43, v54, v55
    v_mfma_f32_4x4x4_16b_bf16 v[60:63], v[46:47], a[162:163], v[60:63] cbsz:1 abid:1
    buffer_store_dwordx4 v[40:43], v208, s[16:19], s40 offen sc1 nt
    s_add_i32 s40, s40, 0x4000
    v_cvt_pk_bf16_f32 v213, v194, v195
    v_exp_f32_e64 v197, v197
    v_exp_f32_e64 v198, v198
    v_cvt_pk_bf16_f32 v214, v196, v197
    v_exp_f32_e64 v199, v199
    s_nop 0
    v_cvt_pk_bf16_f32 v215, v198, v199
    s_nop 1
    v_smfmac_f32_16x16x64_bf16 v[244:247], a[168:171], v[212:219], v255
    v_cvt_pk_bf16_f32 v44, v56, v57
    v_mfma_f32_16x16x32_bf16 v[64:67], v[212:215], a[64:67], v[64:67]
    v_cvt_pk_bf16_f32 v45, v58, v59
    v_cvt_pk_bf16_f32 v46, v60, v61
    v_mfma_f32_16x16x32_bf16 v[68:71], v[212:215], a[76:79], v[68:71]
    v_add_f32 v209, v244, v245
    v_subrev_u32 v210, 0x37800000, v209
    v_mfma_f32_16x16x32_bf16 v[72:75], v[212:215], a[80:83], v[72:75]
    v_rcp_f32 v209, v209
    v_mfma_f32_16x16x32_bf16 v[76:79], v[212:215], a[92:95], v[76:79]
    s_nop 0
    v_cmp_lt_u32 s[66:67], s79, v210
    v_mov_b32_dpp v209, v209 row_ror:12 row_mask:0xa bank_mask:0xf
    v_mfma_f32_16x16x32_bf16 v[80:83], v[212:215], a[96:99], v[80:83]
    s_or_b64 s[64:65], s[64:65], s[66:67]
    v_cvt_pk_bf16_f32 v47, v62, v63
    v_mov_b32_dpp v209, v209 row_ror:8 row_mask:0xc bank_mask:0xf
    v_mfma_f32_16x16x32_bf16 v[84:87], v[212:215], a[108:111], v[84:87]
    buffer_store_dwordx4 v[44:47], v208, s[16:19], s40 offen sc1 nt
    s_add_i32 s40, s40, 0x4000
    v_mov_b32_dpp v220, v209 row_newbcast:0 row_mask:0xf bank_mask:0xf
    v_mov_b32_dpp v221, v209 row_newbcast:1 row_mask:0xf bank_mask:0xf
    v_mfma_f32_16x16x32_bf16 v[88:91], v[212:215], a[112:115], v[88:91]
    v_mov_b32_dpp v222, v209 row_newbcast:2 row_mask:0xf bank_mask:0xf
    v_mov_b32_dpp v223, v209 row_newbcast:3 row_mask:0xf bank_mask:0xf
    v_mfma_f32_16x16x32_bf16 v[92:95], v[212:215], a[124:127], v[92:95]
    v_pk_mul_f32 v[64:65], v[64:65], v[220:221]
    v_pk_mul_f32 v[66:67], v[66:67], v[222:223]
    v_pk_mul_f32 v[68:69], v[68:69], v[220:221]
    v_pk_mul_f32 v[70:71], v[70:71], v[222:223]
    v_pk_mul_f32 v[72:73], v[72:73], v[220:221]
    v_pk_mul_f32 v[74:75], v[74:75], v[222:223]
    v_pk_mul_f32 v[76:77], v[76:77], v[220:221]
    v_pk_mul_f32 v[78:79], v[78:79], v[222:223]
    v_pk_mul_f32 v[80:81], v[80:81], v[220:221]
    v_pk_mul_f32 v[82:83], v[82:83], v[222:223]
    v_pk_mul_f32 v[84:85], v[84:85], v[220:221]
    v_pk_mul_f32 v[86:87], v[86:87], v[222:223]
    v_pk_mul_f32 v[88:89], v[88:89], v[220:221]
    v_pk_mul_f32 v[90:91], v[90:91], v[222:223]
    v_pk_mul_f32 v[92:93], v[92:93], v[220:221]
    v_pk_mul_f32 v[94:95], v[94:95], v[222:223]
    v_mfma_f32_16x16x32_bf16 v[200:203], a[0:3], v[176:179], v[236:239]
    v_cvt_pk_bf16_f32 v64, v64, v68
    v_cvt_pk_bf16_f32 v68, v65, v69
    v_mfma_f32_16x16x32_bf16 v[200:203], a[4:7], v[180:183], v[200:203]
    v_cvt_pk_bf16_f32 v65, v72, v76
    v_cvt_pk_bf16_f32 v69, v73, v77
    v_mfma_f32_16x16x32_bf16 v[200:203], a[8:11], v[184:187], v[200:203]
    v_cvt_pk_bf16_f32 v72, v66, v70
    v_cvt_pk_bf16_f32 v76, v67, v71
    v_mfma_f32_16x16x32_bf16 v[200:203], a[12:15], v[188:191], v[200:203]
    v_cvt_pk_bf16_f32 v73, v74, v78
    v_cvt_pk_bf16_f32 v77, v75, v79
    v_mfma_f32_16x16x32_bf16 v[204:207], a[16:19], v[188:191], v[236:239]
    v_cvt_pk_bf16_f32 v66, v80, v84
    v_cvt_pk_bf16_f32 v70, v81, v85
    v_mfma_f32_16x16x32_bf16 v[204:207], a[20:23], v[184:187], v[204:207]
    v_exp_f32_e64 v200, v200
    v_mfma_f32_16x16x32_bf16 v[204:207], a[24:27], v[180:183], v[204:207]
    v_exp_f32_e64 v201, v201
    v_mfma_f32_16x16x32_bf16 v[204:207], a[28:31], v[176:179], v[204:207]
    v_cvt_pk_bf16_f32 v74, v82, v86
    v_cvt_pk_bf16_f32 v78, v83, v87
    v_exp_f32_e64 v202, v202
    v_mfma_f32_4x4x4_16b_bf16 v[80:83], v[64:65], a[160:161], 0 cbsz:1 abid:0
    v_cvt_pk_bf16_f32 v67, v88, v92
    v_mfma_f32_4x4x4_16b_bf16 v[84:87], v[64:65], a[160:161], 0 cbsz:1 abid:1
    v_cvt_pk_bf16_f32 v71, v89, v93
    v_cvt_pk_bf16_f32 v75, v90, v94
    v_mfma_f32_4x4x4_16b_bf16 v[80:83], v[66:67], a[162:163], v[80:83] cbsz:1 abid:0
    v_cvt_pk_bf16_f32 v79, v91, v95
    v_mfma_f32_4x4x4_16b_bf16 v[84:87], v[66:67], a[162:163], v[84:87] cbsz:1 abid:1
    v_cvt_pk_bf16_f32 v216, v200, v201
    v_mfma_f32_4x4x4_16b_bf16 v[88:91], v[68:69], a[160:161], 0 cbsz:1 abid:0
    v_exp_f32_e64 v203, v203
    v_mfma_f32_4x4x4_16b_bf16 v[92:95], v[68:69], a[160:161], 0 cbsz:1 abid:1
    v_cvt_pk_bf16_f32 v64, v80, v81
    v_mfma_f32_4x4x4_16b_bf16 v[88:91], v[70:71], a[162:163], v[88:91] cbsz:1 abid:0
    v_cvt_pk_bf16_f32 v65, v82, v83
    v_cvt_pk_bf16_f32 v66, v84, v85
    v_cvt_pk_bf16_f32 v67, v86, v87
    v_mfma_f32_4x4x4_16b_bf16 v[92:95], v[70:71], a[162:163], v[92:95] cbsz:1 abid:1
    buffer_store_dwordx4 v[64:67], v208, s[16:19], s40 offen sc1 nt
    s_add_i32 s40, s40, 0x4000
    v_exp_f32_e64 v204, v204
    v_mfma_f32_4x4x4_16b_bf16 v[80:83], v[72:73], a[160:161], 0 cbsz:1 abid:0
    v_cvt_pk_bf16_f32 v68, v88, v89
    v_mfma_f32_4x4x4_16b_bf16 v[84:87], v[72:73], a[160:161], 0 cbsz:1 abid:1
    v_cvt_pk_bf16_f32 v69, v90, v91
    v_mfma_f32_4x4x4_16b_bf16 v[80:83], v[74:75], a[162:163], v[80:83] cbsz:1 abid:0
    v_cvt_pk_bf16_f32 v70, v92, v93
    v_cvt_pk_bf16_f32 v71, v94, v95
    v_mfma_f32_4x4x4_16b_bf16 v[84:87], v[74:75], a[162:163], v[84:87] cbsz:1 abid:1
    buffer_store_dwordx4 v[68:71], v208, s[16:19], s40 offen sc1 nt
    s_add_i32 s40, s40, 0x4000
    v_cvt_pk_bf16_f32 v217, v202, v203
    v_mfma_f32_4x4x4_16b_bf16 v[88:91], v[76:77], a[160:161], 0 cbsz:1 abid:0
    v_cvt_pk_bf16_f32 v72, v80, v81
    v_mfma_f32_4x4x4_16b_bf16 v[92:95], v[76:77], a[160:161], 0 cbsz:1 abid:1
    v_cvt_pk_bf16_f32 v73, v82, v83
    v_mfma_f32_4x4x4_16b_bf16 v[88:91], v[78:79], a[162:163], v[88:91] cbsz:1 abid:0
    v_cvt_pk_bf16_f32 v74, v84, v85
    v_cvt_pk_bf16_f32 v75, v86, v87
    v_exp_f32_e64 v205, v205
    v_mfma_f32_4x4x4_16b_bf16 v[92:95], v[78:79], a[162:163], v[92:95] cbsz:1 abid:1
    buffer_store_dwordx4 v[72:75], v208, s[16:19], s40 offen sc1 nt
    s_add_i32 s40, s40, 0x4000
    v_exp_f32_e64 v206, v206
    v_cvt_pk_bf16_f32 v218, v204, v205
    v_exp_f32_e64 v207, v207
    s_nop 0
    v_cvt_pk_bf16_f32 v219, v206, v207
    s_nop 1
    v_smfmac_f32_16x16x64_bf16 v[244:247], a[172:175], v[212:219], v255
    v_cvt_pk_bf16_f32 v76, v88, v89
    v_mfma_f32_16x16x32_bf16 v[96:99], v[216:219], a[64:67], v[96:99]
    v_cvt_pk_bf16_f32 v77, v90, v91
    v_cvt_pk_bf16_f32 v78, v92, v93
    v_mfma_f32_16x16x32_bf16 v[100:103], v[216:219], a[76:79], v[100:103]
    v_add_f32 v209, v246, v247
    v_subrev_u32 v210, 0x37800000, v209
    v_mfma_f32_16x16x32_bf16 v[104:107], v[216:219], a[80:83], v[104:107]
    v_rcp_f32 v209, v209
    v_mfma_f32_16x16x32_bf16 v[108:111], v[216:219], a[92:95], v[108:111]
    s_nop 0
    v_cmp_lt_u32 s[66:67], s79, v210
    v_mov_b32_dpp v209, v209 row_ror:12 row_mask:0xa bank_mask:0xf
    v_mfma_f32_16x16x32_bf16 v[112:115], v[216:219], a[96:99], v[112:115]
    s_or_b64 s[64:65], s[64:65], s[66:67]
    v_cvt_pk_bf16_f32 v79, v94, v95
    v_mov_b32_dpp v209, v209 row_ror:8 row_mask:0xc bank_mask:0xf
    v_mfma_f32_16x16x32_bf16 v[116:119], v[216:219], a[108:111], v[116:119]
    buffer_store_dwordx4 v[76:79], v208, s[16:19], s40 offen sc1 nt
    s_add_i32 s40, s40, 0x4000
    v_mov_b32_dpp v220, v209 row_newbcast:0 row_mask:0xf bank_mask:0xf
    v_mov_b32_dpp v221, v209 row_newbcast:1 row_mask:0xf bank_mask:0xf
    v_mfma_f32_16x16x32_bf16 v[120:123], v[216:219], a[112:115], v[120:123]
    v_mov_b32_dpp v222, v209 row_newbcast:2 row_mask:0xf bank_mask:0xf
    v_mov_b32_dpp v223, v209 row_newbcast:3 row_mask:0xf bank_mask:0xf
    v_mfma_f32_16x16x32_bf16 v[124:127], v[216:219], a[124:127], v[124:127]
    v_pk_mul_f32 v[96:97], v[96:97], v[220:221]
    v_pk_mul_f32 v[98:99], v[98:99], v[222:223]
    v_pk_mul_f32 v[100:101], v[100:101], v[220:221]
    v_cvt_pk_bf16_f32 v96, v96, v100
    v_cvt_pk_bf16_f32 v100, v97, v101
    v_pk_mul_f32 v[102:103], v[102:103], v[222:223]
    v_pk_mul_f32 v[104:105], v[104:105], v[220:221]
    v_pk_mul_f32 v[106:107], v[106:107], v[222:223]
    v_pk_mul_f32 v[108:109], v[108:109], v[220:221]
    v_cvt_pk_bf16_f32 v97, v104, v108
    v_cvt_pk_bf16_f32 v101, v105, v109
    v_cvt_pk_bf16_f32 v104, v98, v102
    v_cvt_pk_bf16_f32 v108, v99, v103
    v_pk_mul_f32 v[110:111], v[110:111], v[222:223]
    v_cvt_pk_bf16_f32 v105, v106, v110
    v_cvt_pk_bf16_f32 v109, v107, v111
    v_pk_mul_f32 v[112:113], v[112:113], v[220:221]
    v_pk_mul_f32 v[114:115], v[114:115], v[222:223]
    v_pk_mul_f32 v[116:117], v[116:117], v[220:221]
    v_cvt_pk_bf16_f32 v98, v112, v116
    v_cvt_pk_bf16_f32 v102, v113, v117
    v_pk_mul_f32 v[118:119], v[118:119], v[222:223]
    v_cvt_pk_bf16_f32 v106, v114, v118
    v_cvt_pk_bf16_f32 v110, v115, v119
    v_pk_mul_f32 v[120:121], v[120:121], v[220:221]
    v_pk_mul_f32 v[122:123], v[122:123], v[222:223]
    v_pk_mul_f32 v[124:125], v[124:125], v[220:221]
    v_pk_mul_f32 v[126:127], v[126:127], v[222:223]
    v_mfma_f32_4x4x4_16b_bf16 v[112:115], v[96:97], a[160:161], 0 cbsz:1 abid:0
    v_cvt_pk_bf16_f32 v99, v120, v124
    v_mfma_f32_4x4x4_16b_bf16 v[116:119], v[96:97], a[160:161], 0 cbsz:1 abid:1
    v_cvt_pk_bf16_f32 v103, v121, v125
    v_cvt_pk_bf16_f32 v107, v122, v126
    v_mfma_f32_4x4x4_16b_bf16 v[112:115], v[98:99], a[162:163], v[112:115] cbsz:1 abid:0
    v_cvt_pk_bf16_f32 v111, v123, v127
    v_mfma_f32_4x4x4_16b_bf16 v[116:119], v[98:99], a[162:163], v[116:119] cbsz:1 abid:1
    v_mfma_f32_4x4x4_16b_bf16 v[120:123], v[100:101], a[160:161], 0 cbsz:1 abid:0
    v_mfma_f32_4x4x4_16b_bf16 v[124:127], v[100:101], a[160:161], 0 cbsz:1 abid:1
    v_cvt_pk_bf16_f32 v96, v112, v113
    v_mfma_f32_4x4x4_16b_bf16 v[120:123], v[102:103], a[162:163], v[120:123] cbsz:1 abid:0
    v_cvt_pk_bf16_f32 v97, v114, v115
    v_cvt_pk_bf16_f32 v98, v116, v117
    v_cvt_pk_bf16_f32 v99, v118, v119
    v_mfma_f32_4x4x4_16b_bf16 v[124:127], v[102:103], a[162:163], v[124:127] cbsz:1 abid:1
    buffer_store_dwordx4 v[96:99], v208, s[16:19], s40 offen sc1 nt
    s_add_i32 s40, s40, 0x4000
    v_mfma_f32_4x4x4_16b_bf16 v[112:115], v[104:105], a[160:161], 0 cbsz:1 abid:0
    v_cvt_pk_bf16_f32 v100, v120, v121
    v_mfma_f32_4x4x4_16b_bf16 v[116:119], v[104:105], a[160:161], 0 cbsz:1 abid:1
    v_cvt_pk_bf16_f32 v101, v122, v123
    v_mfma_f32_4x4x4_16b_bf16 v[112:115], v[106:107], a[162:163], v[112:115] cbsz:1 abid:0
    v_cvt_pk_bf16_f32 v102, v124, v125
    v_cvt_pk_bf16_f32 v103, v126, v127
    v_mfma_f32_4x4x4_16b_bf16 v[116:119], v[106:107], a[162:163], v[116:119] cbsz:1 abid:1
    buffer_store_dwordx4 v[100:103], v208, s[16:19], s40 offen sc1 nt
    s_add_i32 s40, s40, 0x4000
    v_mfma_f32_4x4x4_16b_bf16 v[120:123], v[108:109], a[160:161], 0 cbsz:1 abid:0
    v_cvt_pk_bf16_f32 v104, v112, v113
    v_mfma_f32_4x4x4_16b_bf16 v[124:127], v[108:109], a[160:161], 0 cbsz:1 abid:1
    v_cvt_pk_bf16_f32 v105, v114, v115
    v_mfma_f32_4x4x4_16b_bf16 v[120:123], v[110:111], a[162:163], v[120:123] cbsz:1 abid:0
    v_cvt_pk_bf16_f32 v106, v116, v117
    v_cvt_pk_bf16_f32 v107, v118, v119
    v_mfma_f32_4x4x4_16b_bf16 v[124:127], v[110:111], a[162:163], v[124:127] cbsz:1 abid:1
    buffer_store_dwordx4 v[104:107], v208, s[16:19], s40 offen sc1 nt
    s_addk_i32 s40, 0x4000
    v_cvt_pk_bf16_f32 v108, v120, v121
    v_cvt_pk_bf16_f32 v109, v122, v123
    s_nop 0
    v_cvt_pk_bf16_f32 v110, v124, v125
    v_cvt_pk_bf16_f32 v111, v126, v127
    buffer_store_dwordx4 v[108:111], v208, s[16:19], s40 offen sc1 nt
L_fin_4:
    s_lshl_b32 s41, s20, 2
    s_add_u32 s41, s41, 157440
    s_cmp_lg_u64 s[64:65], 0
    s_cselect_b32 s40, 1, 0
    v_mov_b32 v192, s40
    v_mov_b32 v193, s41
    ds_write_b32 v193, v192
    v_mov_b32 v193, 157440
    s_waitcnt lgkmcnt(0)
    s_barrier
    ds_read_b128 v[196:199], v193
    s_waitcnt lgkmcnt(0)
    v_or3_b32 v192, v196, v197, v198
    v_or_b32 v192, v192, v199
    s_nop 0
    v_readfirstlane_b32 s40, v192
    s_nop 0
    s_andn2_b32 s40, s40, s54
    s_cbranch_scc1 L_redo
    s_endpgm
.p2align 12
.p2align 5
P_lastm_3:
    s_setpc_b64 s[62:63]
.fill 1, 4, 0xbf800000
L_lastm_3:
    v_exp_f32 v194, v194
    v_mfma_f32_16x16x32_bf16 v[200:203], a[0:3], v[144:147], v[228:231]
    s_waitcnt vmcnt(5)
    v_exp_f32 v195, v195
    v_mfma_f32_16x16x32_bf16 v[200:203], a[4:7], v[148:151], v[200:203]
    buffer_load_dwordx4 v252, s[12:15], s22 offen offset:3216 lds
    v_mfma_f32_16x16x32_bf16 v[200:203], a[8:11], v[152:155], v[200:203]
    s_addk_i32 s32, 17536
    v_cvt_pk_bf16_f32 v100, v192, v193
    s_mov_b32 m0, s32
    v_mfma_f32_16x16x32_bf16 v[200:203], a[12:15], v[156:159], v[200:203]
    s_mov_b32 s14, 0x13da880
    v_cvt_pk_bf16_f32 v101, v194, v195
    v_exp_f32 v196, v196
    v_mfma_f32_16x16x32_bf16 v[204:207], a[16:19], v[156:159], v[228:231]
    ds_read_b128 v[156:159], v254 offset:4544
    buffer_load_dwordx4 v250, s[8:11], s23 offen offset:0 lds
    v_mfma_f32_16x16x32_bf16 v[204:207], a[20:23], v[152:155], v[204:207]
    ds_read_b128 v[152:155], v254 offset:4480
    v_exp_f32_e64 v197, v197
    v_mfma_f32_16x16x32_bf16 v[204:207], a[24:27], v[148:151], v[204:207]
    ds_read_b128 v[148:151], v254 offset:4416
    buffer_load_dwordx4 v251, s[8:11], s23 offen offset:1152 lds
    v_mfma_f32_16x16x32_bf16 v[204:207], a[28:31], v[144:147], v[204:207]
    ds_read_b128 v[144:147], v254 offset:4352
    v_exp_f32_e64 v198, v198
    v_mfma_f32_16x16x32_bf16 v[64:67], v[116:119], a[64:67], v[64:67]
    ds_read_b64_tr_b16 a[64:65], v249 offset:2176
    ds_read_b64_tr_b16 a[66:67], v249 offset:2688
    v_mfma_f32_16x16x32_bf16 v[64:67], v[112:115], a[68:71], v[64:67]
    buffer_load_dwordx4 v250, s[12:15], s23 offen offset:2176 lds
    v_mfma_f32_16x16x32_bf16 v[68:71], v[112:115], a[72:75], v[68:71]
    v_exp_f32_e64 v199, v199
    v_mfma_f32_16x16x32_bf16 v[68:71], v[116:119], a[76:79], v[68:71]
    ds_read_b64_tr_b16 a[76:77], v249 offset:2192
    ds_read_b64_tr_b16 a[78:79], v249 offset:2704
    v_mfma_f32_16x16x32_bf16 v[72:75], v[116:119], a[80:83], v[72:75]
    ds_read_b64_tr_b16 a[80:81], v249 offset:2208
    ds_read_b64_tr_b16 a[82:83], v249 offset:2720
    v_mfma_f32_16x16x32_bf16 v[72:75], v[112:115], a[84:87], v[72:75]
    buffer_load_dwordx4 v252, s[12:15], s23 offen offset:3216 lds
    v_mfma_f32_16x16x32_bf16 v[76:79], v[112:115], a[88:91], v[76:79]
    v_cvt_pk_bf16_f32 v102, v196, v197
    v_cvt_pk_bf16_f32 v103, v198, v199
    v_mfma_f32_16x16x32_bf16 v[76:79], v[116:119], a[92:95], v[76:79]
    ds_read_b64_tr_b16 a[92:93], v249 offset:2224
    ds_read_b64_tr_b16 a[94:95], v249 offset:2736
    v_mfma_f32_16x16x32_bf16 v[80:83], v[116:119], a[96:99], v[80:83]
    ds_read_b64_tr_b16 a[96:97], v249 offset:2240
    ds_read_b64_tr_b16 a[98:99], v249 offset:2752
    v_mfma_f32_16x16x32_bf16 v[80:83], v[112:115], a[100:103], v[80:83]
    ds_read_b128 v[128:131], v254 offset:0
    v_exp_f32_e64 v200, v200
    v_mfma_f32_16x16x32_bf16 v[84:87], v[112:115], a[104:107], v[84:87]
    ds_read_b128 v[132:135], v254 offset:64
    v_exp_f32_e64 v201, v201
    v_mfma_f32_16x16x32_bf16 v[84:87], v[116:119], a[108:111], v[84:87]
    ds_read_b64_tr_b16 a[108:109], v249 offset:2256
    ds_read_b64_tr_b16 a[110:111], v249 offset:2768
    v_mfma_f32_16x16x32_bf16 v[88:91], v[116:119], a[112:115], v[88:91]
    ds_read_b64_tr_b16 a[112:113], v249 offset:2272
    ds_read_b64_tr_b16 a[114:115], v249 offset:2784
    v_mfma_f32_16x16x32_bf16 v[88:91], v[112:115], a[116:119], v[88:91]
    ds_read_b128 v[136:139], v254 offset:128
    v_exp_f32_e64 v202, v202
    v_mfma_f32_16x16x32_bf16 v[92:95], v[112:115], a[120:123], v[92:95]
    ds_read_b128 v[140:143], v254 offset:192
    v_exp_f32_e64 v203, v203
    v_mfma_f32_16x16x32_bf16 v[92:95], v[116:119], a[124:127], v[92:95]
    ds_read_b64_tr_b16 a[124:125], v249 offset:2288
    ds_read_b64_tr_b16 a[126:127], v249 offset:2800
    v_smfmac_f32_16x16x64_bf16 v[244:247], a[132:135], v[112:119], v255
    s_mov_b32 s40, s73
    v_exp_f32 v204, v204
    v_smfmac_f32_16x16x64_bf16 v[240:243], a[168:171], v[100:107], v255
    s_waitcnt lgkmcnt(6)
    v_exp_f32 v205, v205
    v_mfma_f32_16x16x32_bf16 v[0:3], v[100:103], a[64:67], v[0:3]
    s_add_u32 s31, s30, s33
    v_exp_f32 v206, v206
    v_mfma_f32_16x16x32_bf16 v[4:7], v[100:103], a[76:79], v[4:7]
    s_add_u32 s30, s30, s80
    v_exp_f32 v207, v207
    v_mfma_f32_16x16x32_bf16 v[8:11], v[100:103], a[80:83], v[8:11]
    s_cmp_eq_u32 s30, 105216
    v_accvgpr_read_b32 v208, a164
    v_mov_b32 v112, 0
    v_mfma_f32_16x16x32_bf16 v[12:15], v[100:103], a[92:95], v[12:15]
    s_cmov_b32 s30, 0
    v_mov_b32 v113, 0
    v_mov_b32 v114, 0
    v_mfma_f32_16x16x32_bf16 v[16:19], v[100:103], a[96:99], v[16:19]
    s_cselect_b32 s35, s81, s80
    v_mov_b32_e64 v115, 0
    v_add_f32_e64 v209, v240, v241
    v_mfma_f32_16x16x32_bf16 v[20:23], v[100:103], a[108:111], v[20:23]
    s_waitcnt lgkmcnt(0)
    v_subrev_u32 v210, 0x37800000, v209
    v_rcp_f32_e64 v209, v209
    v_cmp_lt_u32 s[66:67], s79, v210
    v_add_u32_e64 v248, s35, v248
    v_mov_b32_dpp v209, v209 row_ror:12 row_mask:0xa bank_mask:0xf
    v_add_u32 v249, s35, v249
    v_mfma_f32_16x16x32_bf16 v[24:27], v[100:103], a[112:115], v[24:27]
    s_or_b64 s[64:65], s[64:65], s[66:67]
    v_mov_b32_dpp v209, v209 row_ror:8 row_mask:0xc bank_mask:0xf
    s_waitcnt vmcnt(8)
    v_mfma_f32_16x16x32_bf16 v[28:31], v[100:103], a[124:127], v[28:31]
    s_barrier
    v_mov_b32_dpp v220, v209 row_newbcast:0 row_mask:0xf bank_mask:0xf
    v_mov_b32_dpp v221, v209 row_newbcast:1 row_mask:0xf bank_mask:0xf
    v_mov_b32_dpp v222, v209 row_newbcast:2 row_mask:0xf bank_mask:0xf
    v_mov_b32_dpp v223, v209 row_newbcast:3 row_mask:0xf bank_mask:0xf
    v_cvt_pk_bf16_f32 v104, v200, v201
    v_cvt_pk_bf16_f32 v105, v202, v203
    v_cvt_pk_bf16_f32 v106, v204, v205
    v_cvt_pk_bf16_f32 v107, v206, v207
    v_pk_mul_f32 v[0:1], v[0:1], v[220:221]
    v_pk_mul_f32 v[2:3], v[2:3], v[222:223]
    v_pk_mul_f32 v[4:5], v[4:5], v[220:221]
    v_pk_mul_f32 v[6:7], v[6:7], v[222:223]
    v_pk_mul_f32 v[8:9], v[8:9], v[220:221]
    v_pk_mul_f32 v[10:11], v[10:11], v[222:223]
    v_pk_mul_f32 v[12:13], v[12:13], v[220:221]
    v_pk_mul_f32 v[14:15], v[14:15], v[222:223]
    v_pk_mul_f32 v[16:17], v[16:17], v[220:221]
    v_pk_mul_f32 v[18:19], v[18:19], v[222:223]
    v_pk_mul_f32 v[20:21], v[20:21], v[220:221]
    v_pk_mul_f32 v[22:23], v[22:23], v[222:223]
    v_pk_mul_f32 v[24:25], v[24:25], v[220:221]
    v_pk_mul_f32 v[26:27], v[26:27], v[222:223]
    v_pk_mul_f32 v[28:29], v[28:29], v[220:221]
    v_pk_mul_f32 v[30:31], v[30:31], v[222:223]
    v_smfmac_f32_16x16x64_bf16 v[240:243], a[172:175], v[100:107], v255
    ds_read_b128 a[32:35], v248 offset:17536
    ds_read_b128 a[36:39], v248 offset:17600
    v_mfma_f32_16x16x32_bf16 v[32:35], v[104:107], a[64:67], v[32:35]
    ds_read_b128 a[40:43], v248 offset:17664
    ds_read_b128 a[44:47], v248 offset:17728
    v_mfma_f32_16x16x32_bf16 v[36:39], v[104:107], a[76:79], v[36:39]
    ds_read_b128 a[48:51], v248 offset:18240
    ds_read_b128 a[52:55], v248 offset:18176
    v_mfma_f32_16x16x32_bf16 v[40:43], v[104:107], a[80:83], v[40:43]
    ds_read_b128 a[56:59], v248 offset:18112
    ds_read_b128 a[60:63], v248 offset:18048
    v_mfma_f32_16x16x32_bf16 v[44:47], v[104:107], a[92:95], v[44:47]
    v_add_f32_e64 v209, v242, v243
    v_subrev_u32 v210, 0x37800000, v209
    v_mfma_f32_16x16x32_bf16 v[48:51], v[104:107], a[96:99], v[48:51]
    v_rcp_f32_e64 v209, v209
    v_mfma_f32_16x16x32_bf16 v[52:55], v[104:107], a[108:111], v[52:55]
    s_nop 0
    v_cmp_lt_u32 s[66:67], s79, v210
    v_mov_b32_dpp v209, v209 row_ror:12 row_mask:0xa bank_mask:0xf
    v_mfma_f32_16x16x32_bf16 v[56:59], v[104:107], a[112:115], v[56:59]
    s_or_b64 s[64:65], s[64:65], s[66:67]
    v_cvt_pk_bf16_f32 v0, v0, v4
    v_mov_b32_dpp v209, v209 row_ror:8 row_mask:0xc bank_mask:0xf
    v_mfma_f32_16x16x32_bf16 v[60:63], v[104:107], a[124:127], v[60:63]
    v_cvt_pk_bf16_f32 v4, v1, v5
    v_cvt_pk_bf16_f32 v1, v8, v12
    v_cvt_pk_bf16_f32 v5, v9, v13
    v_cvt_pk_bf16_f32 v8, v2, v6
    v_cvt_pk_bf16_f32 v12, v3, v7
    v_cvt_pk_bf16_f32 v9, v10, v14
    v_cvt_pk_bf16_f32 v13, v11, v15
    v_cvt_pk_bf16_f32 v2, v16, v20
    v_cvt_pk_bf16_f32 v6, v17, v21
    v_cvt_pk_bf16_f32 v10, v18, v22
    v_cvt_pk_bf16_f32 v14, v19, v23
    v_mfma_f32_4x4x4_16b_bf16 v[16:19], v[0:1], a[160:161], 0 cbsz:1 abid:0
    v_cvt_pk_bf16_f32 v3, v24, v28
    v_mfma_f32_4x4x4_16b_bf16 v[20:23], v[0:1], a[160:161], 0 cbsz:1 abid:1
    v_cvt_pk_bf16_f32 v7, v25, v29
    v_cvt_pk_bf16_f32 v11, v26, v30
    v_mfma_f32_4x4x4_16b_bf16 v[16:19], v[2:3], a[162:163], v[16:19] cbsz:1 abid:0
    v_cvt_pk_bf16_f32 v15, v27, v31
    v_mfma_f32_4x4x4_16b_bf16 v[20:23], v[2:3], a[162:163], v[20:23] cbsz:1 abid:1
    v_mov_b32_dpp v220, v209 row_newbcast:0 row_mask:0xf bank_mask:0xf
    v_mfma_f32_4x4x4_16b_bf16 v[24:27], v[4:5], a[160:161], 0 cbsz:1 abid:0
    v_mov_b32_dpp v221, v209 row_newbcast:1 row_mask:0xf bank_mask:0xf
    v_mfma_f32_4x4x4_16b_bf16 v[28:31], v[4:5], a[160:161], 0 cbsz:1 abid:1
    v_cvt_pk_bf16_f32 v0, v16, v17
    v_mfma_f32_4x4x4_16b_bf16 v[24:27], v[6:7], a[162:163], v[24:27] cbsz:1 abid:0
    v_cvt_pk_bf16_f32 v1, v18, v19
    v_cvt_pk_bf16_f32 v2, v20, v21
    v_cvt_pk_bf16_f32 v3, v22, v23
    v_mfma_f32_4x4x4_16b_bf16 v[28:31], v[6:7], a[162:163], v[28:31] cbsz:1 abid:1
    buffer_store_dwordx4 v[0:3], v208, s[16:19], s40 offen sc1 nt
    s_add_i32 s40, s40, 0x4000
    v_mov_b32_dpp v222, v209 row_newbcast:2 row_mask:0xf bank_mask:0xf
    v_mfma_f32_4x4x4_16b_bf16 v[16:19], v[8:9], a[160:161], 0 cbsz:1 abid:0
    v_cvt_pk_bf16_f32 v4, v24, v25
    v_mfma_f32_4x4x4_16b_bf16 v[20:23], v[8:9], a[160:161], 0 cbsz:1 abid:1
    v_cvt_pk_bf16_f32 v5, v26, v27
    v_mfma_f32_4x4x4_16b_bf16 v[16:19], v[10:11], a[162:163], v[16:19] cbsz:1 abid:0
    v_cvt_pk_bf16_f32 v6, v28, v29
    v_cvt_pk_bf16_f32 v7, v30, v31
    v_mov_b32_dpp v223, v209 row_newbcast:3 row_mask:0xf bank_mask:0xf
    v_mfma_f32_4x4x4_16b_bf16 v[20:23], v[10:11], a[162:163], v[20:23] cbsz:1 abid:1
    buffer_store_dwordx4 v[4:7], v208, s[16:19], s40 offen sc1 nt
    s_add_i32 s40, s40, 0x4000
    v_pk_mul_f32 v[32:33], v[32:33], v[220:221]
    v_pk_mul_f32 v[34:35], v[34:35], v[222:223]
    v_mfma_f32_4x4x4_16b_bf16 v[24:27], v[12:13], a[160:161], 0 cbsz:1 abid:0
    v_cvt_pk_bf16_f32 v8, v16, v17
    v_mfma_f32_4x4x4_16b_bf16 v[28:31], v[12:13], a[160:161], 0 cbsz:1 abid:1
    v_cvt_pk_bf16_f32 v9, v18, v19
    v_mfma_f32_4x4x4_16b_bf16 v[24:27], v[14:15], a[162:163], v[24:27] cbsz:1 abid:0
    v_cvt_pk_bf16_f32 v10, v20, v21
    v_cvt_pk_bf16_f32 v11, v22, v23
    v_mfma_f32_4x4x4_16b_bf16 v[28:31], v[14:15], a[162:163], v[28:31] cbsz:1 abid:1
    buffer_store_dwordx4 v[8:11], v208, s[16:19], s40 offen sc1 nt
    s_add_i32 s40, s40, 0x4000
    v_pk_mul_f32 v[36:37], v[36:37], v[220:221]
    v_pk_mul_f32 v[38:39], v[38:39], v[222:223]
    v_pk_mul_f32 v[40:41], v[40:41], v[220:221]
    v_pk_mul_f32 v[42:43], v[42:43], v[222:223]
    v_pk_mul_f32 v[44:45], v[44:45], v[220:221]
    v_pk_mul_f32 v[46:47], v[46:47], v[222:223]
    v_pk_mul_f32 v[48:49], v[48:49], v[220:221]
    v_pk_mul_f32 v[50:51], v[50:51], v[222:223]
    v_pk_mul_f32 v[52:53], v[52:53], v[220:221]
    v_pk_mul_f32 v[54:55], v[54:55], v[222:223]
    v_pk_mul_f32 v[56:57], v[56:57], v[220:221]
    v_pk_mul_f32 v[58:59], v[58:59], v[222:223]
    v_pk_mul_f32 v[60:61], v[60:61], v[220:221]
    v_pk_mul_f32 v[62:63], v[62:63], v[222:223]
    v_mfma_f32_16x16x32_bf16 v[192:195], a[0:3], v[160:163], v[232:235]
    v_cvt_pk_bf16_f32 v12, v24, v25
    v_cvt_pk_bf16_f32 v13, v26, v27
    v_mfma_f32_16x16x32_bf16 v[192:195], a[4:7], v[164:167], v[192:195]
    v_cvt_pk_bf16_f32 v14, v28, v29
    v_cvt_pk_bf16_f32 v15, v30, v31
    v_mfma_f32_16x16x32_bf16 v[192:195], a[8:11], v[168:171], v[192:195]
    buffer_store_dwordx4 v[12:15], v208, s[16:19], s40 offen sc1 nt
    s_add_i32 s40, s40, 0x4000
    v_cvt_pk_bf16_f32 v32, v32, v36
    v_mfma_f32_16x16x32_bf16 v[192:195], a[12:15], v[172:175], v[192:195]
    v_cvt_pk_bf16_f32 v36, v33, v37
    v_cvt_pk_bf16_f32 v33, v40, v44
    v_mfma_f32_16x16x32_bf16 v[196:199], a[16:19], v[172:175], v[232:235]
    ds_read_b128 v[172:175], v254 offset:8896
    v_cvt_pk_bf16_f32 v37, v41, v45
    v_mfma_f32_16x16x32_bf16 v[196:199], a[20:23], v[168:171], v[196:199]
    v_cvt_pk_bf16_f32 v40, v34, v38
    v_cvt_pk_bf16_f32 v44, v35, v39
    v_cvt_pk_bf16_f32 v41, v42, v46
    v_cvt_pk_bf16_f32 v45, v43, v47
    v_cvt_pk_bf16_f32 v34, v48, v52
    v_cvt_pk_bf16_f32 v38, v49, v53
    v_cvt_pk_bf16_f32 v42, v50, v54
    v_cvt_pk_bf16_f32 v46, v51, v55
    v_mfma_f32_4x4x4_16b_bf16 v[48:51], v[32:33], a[160:161], 0 cbsz:1 abid:0
    v_cvt_pk_bf16_f32 v35, v56, v60
    v_mfma_f32_4x4x4_16b_bf16 v[52:55], v[32:33], a[160:161], 0 cbsz:1 abid:1
    v_cvt_pk_bf16_f32 v39, v57, v61
    v_cvt_pk_bf16_f32 v43, v58, v62
    v_mfma_f32_4x4x4_16b_bf16 v[48:51], v[34:35], a[162:163], v[48:51] cbsz:1 abid:0
    v_cvt_pk_bf16_f32 v47, v59, v63
    v_mfma_f32_4x4x4_16b_bf16 v[52:55], v[34:35], a[162:163], v[52:55] cbsz:1 abid:1
    ds_read_b128 v[168:171], v254 offset:8832
    v_mfma_f32_4x4x4_16b_bf16 v[56:59], v[36:37], a[160:161], 0 cbsz:1 abid:0
    v_exp_f32_e64 v192, v192
    v_mfma_f32_4x4x4_16b_bf16 v[60:63], v[36:37], a[160:161], 0 cbsz:1 abid:1
    v_cvt_pk_bf16_f32 v32, v48, v49
    v_mfma_f32_4x4x4_16b_bf16 v[56:59], v[38:39], a[162:163], v[56:59] cbsz:1 abid:0
    v_cvt_pk_bf16_f32 v33, v50, v51
    v_cvt_pk_bf16_f32 v34, v52, v53
    v_mfma_f32_16x16x32_bf16 v[196:199], a[24:27], v[164:167], v[196:199]
    ds_read_b128 v[164:167], v254 offset:8768
    v_exp_f32_e64 v193, v193
    v_mfma_f32_16x16x32_bf16 v[196:199], a[28:31], v[160:163], v[196:199]
    ds_read_b128 v[160:163], v254 offset:8704
    v_cvt_pk_bf16_f32 v35, v54, v55
    v_exp_f32_e64 v194, v194
    v_mfma_f32_4x4x4_16b_bf16 v[60:63], v[38:39], a[162:163], v[60:63] cbsz:1 abid:1
    buffer_store_dwordx4 v[32:35], v208, s[16:19], s40 offen sc1 nt
    s_add_i32 s40, s40, 0x4000
    v_cvt_pk_bf16_f32 v116, v192, v193
    v_mfma_f32_4x4x4_16b_bf16 v[48:51], v[40:41], a[160:161], 0 cbsz:1 abid:0
    v_cvt_pk_bf16_f32 v36, v56, v57
    v_mfma_f32_4x4x4_16b_bf16 v[52:55], v[40:41], a[160:161], 0 cbsz:1 abid:1
    v_cvt_pk_bf16_f32 v37, v58, v59
    v_mfma_f32_4x4x4_16b_bf16 v[48:51], v[42:43], a[162:163], v[48:51] cbsz:1 abid:0
    v_cvt_pk_bf16_f32 v38, v60, v61
    v_cvt_pk_bf16_f32 v39, v62, v63
    v_exp_f32_e64 v195, v195
    v_mfma_f32_4x4x4_16b_bf16 v[52:55], v[42:43], a[162:163], v[52:55] cbsz:1 abid:1
    buffer_store_dwordx4 v[36:39], v208, s[16:19], s40 offen sc1 nt
    s_add_i32 s40, s40, 0x4000
    v_exp_f32_e64 v196, v196
    v_mfma_f32_4x4x4_16b_bf16 v[56:59], v[44:45], a[160:161], 0 cbsz:1 abid:0
    v_cvt_pk_bf16_f32 v40, v48, v49
    v_mfma_f32_4x4x4_16b_bf16 v[60:63], v[44:45], a[160:161], 0 cbsz:1 abid:1
    v_cvt_pk_bf16_f32 v41, v50, v51
    v_mfma_f32_4x4x4_16b_bf16 v[56:59], v[46:47], a[162:163], v[56:59] cbsz:1 abid:0
    v_cvt_pk_bf16_f32 v42, v52, v53
    v_cvt_pk_bf16_f32 v43, v54, v55
    v_mfma_f32_4x4x4_16b_bf16 v[60:63], v[46:47], a[162:163], v[60:63] cbsz:1 abid:1
    buffer_store_dwordx4 v[40:43], v208, s[16:19], s40 offen sc1 nt
    s_add_i32 s40, s40, 0x4000
    v_cvt_pk_bf16_f32 v117, v194, v195
    v_exp_f32_e64 v197, v197
    v_exp_f32 v198, v198
    v_cvt_pk_bf16_f32 v118, v196, v197
    v_exp_f32_e64 v199, v199
    s_nop 0
    v_cvt_pk_bf16_f32 v119, v198, v199
    s_nop 1
    v_smfmac_f32_16x16x64_bf16 v[244:247], a[132:135], v[112:119], v255
    s_nop 0
    v_cvt_pk_bf16_f32 v44, v56, v57
    v_mfma_f32_16x16x32_bf16 v[64:67], v[116:119], a[64:67], v[64:67]
    s_nop 0
    ds_read_b128 a[0:3], v248 offset:0
    v_cvt_pk_bf16_f32 v45, v58, v59
    v_mfma_f32_16x16x32_bf16 v[68:71], v[116:119], a[76:79], v[68:71]
    s_mov_b32 s32, s31
    ds_read_b128 a[4:7], v248 offset:64
    v_add_f32 v209, v244, v245
    v_mfma_f32_16x16x32_bf16 v[72:75], v[116:119], a[80:83], v[72:75]
    s_mov_b32 m0, s31
    ds_read_b128 a[8:11], v248 offset:128
    v_subrev_u32 v210, 0x37800000, v209
    v_mfma_f32_16x16x32_bf16 v[76:79], v[116:119], a[92:95], v[76:79]
    s_mov_b32 s22, s24
    ds_read_b128 a[12:15], v248 offset:192
    v_rcp_f32 v209, v209
    v_mfma_f32_16x16x32_bf16 v[80:83], v[116:119], a[96:99], v[80:83]
    s_add_u32 s23, s24, s25
    ds_read_b128 a[16:19], v248 offset:704
    v_cmp_lt_u32 s[66:67], s79, v210
    v_mfma_f32_16x16x32_bf16 v[84:87], v[116:119], a[108:111], v[84:87]
    s_add_u32 s24, s23, s25
    ds_read_b128 a[20:23], v248 offset:640
    v_mov_b32_dpp v209, v209 row_ror:12 row_mask:0xa bank_mask:0xf
    v_mfma_f32_16x16x32_bf16 v[88:91], v[116:119], a[112:115], v[88:91]
    s_or_b64 s[64:65], s[64:65], s[66:67]
    ds_read_b128 a[24:27], v248 offset:576
    v_mov_b32_dpp v209, v209 row_ror:8 row_mask:0xc bank_mask:0xf
    v_mfma_f32_16x16x32_bf16 v[92:95], v[116:119], a[124:127], v[92:95]
    s_nop 0
    ds_read_b128 a[28:31], v248 offset:512
    v_mov_b32_dpp v220, v209 row_newbcast:0 row_mask:0xf bank_mask:0xf
    v_mov_b32_dpp v221, v209 row_newbcast:1 row_mask:0xf bank_mask:0xf
    v_mov_b32_dpp v222, v209 row_newbcast:2 row_mask:0xf bank_mask:0xf
    v_mov_b32_dpp v223, v209 row_newbcast:3 row_mask:0xf bank_mask:0xf
    v_pk_mul_f32 v[64:65], v[64:65], v[220:221]
    v_pk_mul_f32 v[66:67], v[66:67], v[222:223]
    v_pk_mul_f32 v[68:69], v[68:69], v[220:221]
    v_pk_mul_f32 v[70:71], v[70:71], v[222:223]
    v_pk_mul_f32 v[72:73], v[72:73], v[220:221]
    v_pk_mul_f32 v[74:75], v[74:75], v[222:223]
    v_pk_mul_f32 v[76:77], v[76:77], v[220:221]
    v_pk_mul_f32 v[78:79], v[78:79], v[222:223]
    v_pk_mul_f32 v[80:81], v[80:81], v[220:221]
    v_pk_mul_f32 v[82:83], v[82:83], v[222:223]
    v_pk_mul_f32 v[84:85], v[84:85], v[220:221]
    v_pk_mul_f32 v[86:87], v[86:87], v[222:223]
    v_pk_mul_f32 v[88:89], v[88:89], v[220:221]
    v_pk_mul_f32 v[90:91], v[90:91], v[222:223]
    v_pk_mul_f32 v[92:93], v[92:93], v[220:221]
    v_pk_mul_f32 v[94:95], v[94:95], v[222:223]
    v_mfma_f32_4x4x4_16b_bf16 v[0:3], a[156:157], v[128:129], 0
    buffer_load_dwordx4 v250, s[8:11], s22 offen offset:0 lds
    v_mfma_f32_4x4x4_16b_bf16 v[4:7], a[156:157], v[130:131], 0
    v_cvt_pk_bf16_f32 v46, v60, v61
    v_cvt_pk_bf16_f32 v47, v62, v63
    v_mfma_f32_4x4x4_16b_bf16 v[8:11], a[156:157], v[132:133], 0
    buffer_store_dwordx4 v[44:47], v208, s[16:19], s40 offen sc1 nt
    s_add_i32 s40, s40, 0x4000
    v_cvt_pk_bf16_f32 v64, v64, v68
    v_mfma_f32_4x4x4_16b_bf16 v[0:3], a[158:159], v[128:129], v[0:3]
    v_cvt_pk_bf16_f32 v68, v65, v69
    v_mfma_f32_4x4x4_16b_bf16 v[12:15], a[156:157], v[134:135], 0
    v_cvt_pk_bf16_f32 v65, v72, v76
    v_mfma_f32_4x4x4_16b_bf16 v[4:7], a[158:159], v[130:131], v[4:7]
    v_cvt_pk_bf16_f32 v69, v73, v77
    v_mfma_f32_4x4x4_16b_bf16 v[16:19], a[156:157], v[136:137], 0
    v_cvt_pk_bf16_f32 v72, v66, v70
    v_cvt_pk_bf16_f32 v76, v67, v71
    v_cvt_pk_bf16_f32 v73, v74, v78
    v_cvt_pk_bf16_f32 v77, v75, v79
    v_cvt_pk_bf16_f32 v66, v80, v84
    v_cvt_pk_bf16_f32 v70, v81, v85
    v_cvt_pk_bf16_f32 v74, v82, v86
    v_cvt_pk_bf16_f32 v78, v83, v87
    v_mfma_f32_4x4x4_16b_bf16 v[80:83], v[64:65], a[160:161], 0 cbsz:1 abid:0
    v_cvt_pk_bf16_f32 v67, v88, v92
    v_mfma_f32_4x4x4_16b_bf16 v[84:87], v[64:65], a[160:161], 0 cbsz:1 abid:1
    v_cvt_pk_bf16_f32 v71, v89, v93
    v_cvt_pk_bf16_f32 v75, v90, v94
    v_mfma_f32_4x4x4_16b_bf16 v[80:83], v[66:67], a[162:163], v[80:83] cbsz:1 abid:0
    v_cvt_pk_bf16_f32 v79, v91, v95
    v_mfma_f32_4x4x4_16b_bf16 v[84:87], v[66:67], a[162:163], v[84:87] cbsz:1 abid:1
    v_cvt_pk_bf16_f32 v128, v0, v1
    v_mfma_f32_4x4x4_16b_bf16 v[88:91], v[68:69], a[160:161], 0 cbsz:1 abid:0
    v_mfma_f32_4x4x4_16b_bf16 v[92:95], v[68:69], a[160:161], 0 cbsz:1 abid:1
    v_cvt_pk_bf16_f32 v64, v80, v81
    v_mfma_f32_4x4x4_16b_bf16 v[88:91], v[70:71], a[162:163], v[88:91] cbsz:1 abid:0
    v_cvt_pk_bf16_f32 v65, v82, v83
    v_mfma_f32_4x4x4_16b_bf16 v[8:11], a[158:159], v[132:133], v[8:11]
    v_cvt_pk_bf16_f32 v66, v84, v85
    v_cvt_pk_bf16_f32 v67, v86, v87
    v_mfma_f32_4x4x4_16b_bf16 v[92:95], v[70:71], a[162:163], v[92:95] cbsz:1 abid:1
    buffer_store_dwordx4 v[64:67], v208, s[16:19], s40 offen sc1 nt
    s_addk_i32 s40, 0x4000
    s_mov_b32 s76, s39
    s_mov_b32 s39, 0
    s_mov_b32 s73, s37
    v_cvt_pk_bf16_f32 v129, v2, v3
    v_mfma_f32_4x4x4_16b_bf16 v[80:83], v[72:73], a[160:161], 0 cbsz:1 abid:0
    v_cvt_pk_bf16_f32 v68, v88, v89
    v_mfma_f32_4x4x4_16b_bf16 v[84:87], v[72:73], a[160:161], 0 cbsz:1 abid:1
    v_cvt_pk_bf16_f32 v69, v90, v91
    v_mfma_f32_4x4x4_16b_bf16 v[80:83], v[74:75], a[162:163], v[80:83] cbsz:1 abid:0
    v_cvt_pk_bf16_f32 v70, v92, v93
    v_mfma_f32_4x4x4_16b_bf16 v[20:23], a[156:157], v[138:139], 0
    v_cvt_pk_bf16_f32 v71, v94, v95
    v_mfma_f32_4x4x4_16b_bf16 v[84:87], v[74:75], a[162:163], v[84:87] cbsz:1 abid:1
    v_cvt_pk_bf16_f32 v130, v4, v5
    v_mfma_f32_4x4x4_16b_bf16 v[12:15], a[158:159], v[134:135], v[12:15]
    v_cvt_pk_bf16_f32 v131, v6, v7
    v_mfma_f32_4x4x4_16b_bf16 v[24:27], a[156:157], v[140:141], 0
    buffer_load_dwordx4 v251, s[8:11], s22 offen offset:1152 lds
    buffer_store_dwordx4 v[68:71], v208, s[16:19], s40 offen sc1 nt
    s_addk_i32 s40, 0x4000
    s_mov_b32 s74, s26
    s_lshr_b32 s34, s36, 1
    s_sub_u32 s34, s34, 2
    v_cvt_pk_bf16_f32 v132, v8, v9
    v_mfma_f32_4x4x4_16b_bf16 v[88:91], v[76:77], a[160:161], 0 cbsz:1 abid:0
    v_cvt_pk_bf16_f32 v72, v80, v81
    v_mfma_f32_4x4x4_16b_bf16 v[92:95], v[76:77], a[160:161], 0 cbsz:1 abid:1
    v_cvt_pk_bf16_f32 v73, v82, v83
    v_mfma_f32_4x4x4_16b_bf16 v[88:91], v[78:79], a[162:163], v[88:91] cbsz:1 abid:0
    v_cvt_pk_bf16_f32 v74, v84, v85
    v_mfma_f32_4x4x4_16b_bf16 v[16:19], a[158:159], v[136:137], v[16:19]
    v_cvt_pk_bf16_f32 v75, v86, v87
    v_mfma_f32_4x4x4_16b_bf16 v[92:95], v[78:79], a[162:163], v[92:95] cbsz:1 abid:1
    v_cvt_pk_bf16_f32 v133, v10, v11
    v_mfma_f32_4x4x4_16b_bf16 v[28:31], a[156:157], v[142:143], 0
    v_cvt_pk_bf16_f32 v134, v12, v13
    v_mfma_f32_4x4x4_16b_bf16 v[20:23], a[158:159], v[138:139], v[20:23]
    v_cvt_pk_bf16_f32 v135, v14, v15
    v_mfma_f32_4x4x4_16b_bf16 v[96:99], a[156:157], v[144:145], 0
    v_cvt_pk_bf16_f32 v136, v16, v17
    v_mfma_f32_4x4x4_16b_bf16 v[24:27], a[158:159], v[140:141], v[24:27]
    v_cvt_pk_bf16_f32 v137, v18, v19
    v_mfma_f32_4x4x4_16b_bf16 v[100:103], a[156:157], v[146:147], 0
    v_cvt_pk_bf16_f32 v138, v20, v21
    v_mfma_f32_4x4x4_16b_bf16 v[28:31], a[158:159], v[142:143], v[28:31]
    buffer_load_dwordx4 v250, s[12:15], s22 offen offset:2176 lds
    buffer_store_dwordx4 v[72:75], v208, s[16:19], s40 offen sc1 nt
    s_add_i32 s40, s40, 0x4000
    s_mov_b32 s26, 2.0
    s_mov_b32 s27, 2.0
    s_mov_b32 s28, 2.0
    v_cvt_pk_bf16_f32 v139, v22, v23
    v_mfma_f32_4x4x4_16b_bf16 v[104:107], a[156:157], v[148:149], 0
    v_cvt_pk_bf16_f32 v140, v24, v25
    v_mfma_f32_4x4x4_16b_bf16 v[96:99], a[158:159], v[144:145], v[96:99]
    v_cvt_pk_bf16_f32 v76, v88, v89
    v_cvt_pk_bf16_f32 v77, v90, v91
    v_cvt_pk_bf16_f32 v78, v92, v93
    v_cvt_pk_bf16_f32 v79, v94, v95
    buffer_store_dwordx4 v[76:79], v208, s[16:19], s40 offen sc1 nt
    s_mov_b32 s18, s38
    s_cmp_lg_u32 s54, 0
    s_waitcnt lgkmcnt(0)
    v_cvt_pk_bf16_f32 v141, v26, v27
    v_mfma_f32_4x4x4_16b_bf16 v[108:111], a[156:157], v[150:151], 0
    v_cvt_pk_bf16_f32 v142, v28, v29
    v_mfma_f32_4x4x4_16b_bf16 v[100:103], a[158:159], v[146:147], v[100:103]
    v_cvt_pk_bf16_f32 v143, v30, v31
    v_mfma_f32_4x4x4_16b_bf16 v[112:115], a[156:157], v[152:153], 0
    v_cvt_pk_bf16_f32 v144, v96, v97
    v_mfma_f32_4x4x4_16b_bf16 v[104:107], a[158:159], v[148:149], v[104:107]
    v_cvt_pk_bf16_f32 v145, v98, v99
    v_mfma_f32_4x4x4_16b_bf16 v[116:119], a[156:157], v[154:155], 0
    buffer_load_dwordx4 v252, s[12:15], s22 offen offset:3216 lds
    v_cvt_pk_bf16_f32 v146, v100, v101
    v_mfma_f32_4x4x4_16b_bf16 v[108:111], a[158:159], v[150:151], v[108:111]
    v_cvt_pk_bf16_f32 v147, v102, v103
    v_mfma_f32_4x4x4_16b_bf16 v[120:123], a[156:157], v[156:157], 0
    v_cvt_pk_bf16_f32 v148, v104, v105
    v_mfma_f32_4x4x4_16b_bf16 v[112:115], a[158:159], v[152:153], v[112:115]
    v_cvt_pk_bf16_f32 v149, v106, v107
    v_mfma_f32_4x4x4_16b_bf16 v[124:127], a[156:157], v[158:159], 0
    v_cvt_pk_bf16_f32 v150, v108, v109
    v_mfma_f32_4x4x4_16b_bf16 v[116:119], a[158:159], v[154:155], v[116:119]
    v_cvt_pk_bf16_f32 v151, v110, v111
    v_mfma_f32_4x4x4_16b_bf16 v[120:123], a[158:159], v[156:157], v[120:123]
    v_cvt_pk_bf16_f32 v152, v112, v113
    v_mfma_f32_4x4x4_16b_bf16 v[124:127], a[158:159], v[158:159], v[124:127]
    v_cvt_pk_bf16_f32 v153, v114, v115
    v_cvt_pk_bf16_f32 v154, v116, v117
    v_cvt_pk_bf16_f32 v155, v118, v119
    v_cvt_pk_bf16_f32 v156, v120, v121
    v_cvt_pk_bf16_f32 v157, v122, v123
    v_cvt_pk_bf16_f32 v158, v124, v125
    v_cvt_pk_bf16_f32 v159, v126, v127
    s_cbranch_scc1 L_maxpass2
    s_cmp_eq_u32 s76, 5
    s_cbranch_scc1 L_first2p_2
    s_branch L_first2s_3
.p2align 12
.p2align 5
P_lastm_4:
    s_setpc_b64 s[62:63]
.fill 1, 4, 0xbf800000
L_lastm_4:
    ds_read_b128 a[40:43], v248 offset:17664
    ds_read_b128 a[44:47], v248 offset:17728
    v_mfma_f32_16x16x32_bf16 v[36:39], v[216:219], a[76:79], v[36:39]
    s_nop 0
    ds_read_b128 a[48:51], v248 offset:18240
    ds_read_b128 a[52:55], v248 offset:18176
    v_mfma_f32_16x16x32_bf16 v[40:43], v[216:219], a[80:83], v[40:43]
    s_nop 0
    ds_read_b128 a[56:59], v248 offset:18112
    ds_read_b128 a[60:63], v248 offset:18048
    v_mfma_f32_16x16x32_bf16 v[44:47], v[216:219], a[92:95], v[44:47]
    v_add_f32_e64 v209, v242, v243
    v_subrev_u32 v210, 0x37800000, v209
    v_mfma_f32_16x16x32_bf16 v[48:51], v[216:219], a[96:99], v[48:51]
    v_rcp_f32_e64 v209, v209
    v_mfma_f32_16x16x32_bf16 v[52:55], v[216:219], a[108:111], v[52:55]
    s_nop 0
    v_cmp_lt_u32 s[66:67], s79, v210
    v_mov_b32_dpp v209, v209 row_ror:12 row_mask:0xa bank_mask:0xf
    v_mfma_f32_16x16x32_bf16 v[56:59], v[216:219], a[112:115], v[56:59]
    s_or_b64 s[64:65], s[64:65], s[66:67]
    v_cvt_pk_bf16_f32 v0, v0, v4
    v_mov_b32_dpp v209, v209 row_ror:8 row_mask:0xc bank_mask:0xf
    v_mfma_f32_16x16x32_bf16 v[60:63], v[216:219], a[124:127], v[60:63]
    v_cvt_pk_bf16_f32 v4, v1, v5
    v_cvt_pk_bf16_f32 v1, v8, v12
    v_cvt_pk_bf16_f32 v5, v9, v13
    v_cvt_pk_bf16_f32 v8, v2, v6
    v_cvt_pk_bf16_f32 v12, v3, v7
    v_cvt_pk_bf16_f32 v9, v10, v14
    v_cvt_pk_bf16_f32 v13, v11, v15
    v_cvt_pk_bf16_f32 v2, v16, v20
    v_cvt_pk_bf16_f32 v6, v17, v21
    v_cvt_pk_bf16_f32 v10, v18, v22
    v_cvt_pk_bf16_f32 v14, v19, v23
    v_mfma_f32_4x4x4_16b_bf16 v[16:19], v[0:1], a[160:161], 0 cbsz:1 abid:0
    v_cvt_pk_bf16_f32 v3, v24, v28
    v_mfma_f32_4x4x4_16b_bf16 v[20:23], v[0:1], a[160:161], 0 cbsz:1 abid:1
    v_cvt_pk_bf16_f32 v7, v25, v29
    v_cvt_pk_bf16_f32 v11, v26, v30
    v_mfma_f32_4x4x4_16b_bf16 v[16:19], v[2:3], a[162:163], v[16:19] cbsz:1 abid:0
    v_cvt_pk_bf16_f32 v15, v27, v31
    v_mfma_f32_4x4x4_16b_bf16 v[20:23], v[2:3], a[162:163], v[20:23] cbsz:1 abid:1
    v_mov_b32_dpp v220, v209 row_newbcast:0 row_mask:0xf bank_mask:0xf
    v_mfma_f32_4x4x4_16b_bf16 v[24:27], v[4:5], a[160:161], 0 cbsz:1 abid:0
    v_mov_b32_dpp v221, v209 row_newbcast:1 row_mask:0xf bank_mask:0xf
    v_mfma_f32_4x4x4_16b_bf16 v[28:31], v[4:5], a[160:161], 0 cbsz:1 abid:1
    v_cvt_pk_bf16_f32 v0, v16, v17
    v_mfma_f32_4x4x4_16b_bf16 v[24:27], v[6:7], a[162:163], v[24:27] cbsz:1 abid:0
    v_cvt_pk_bf16_f32 v1, v18, v19
    v_cvt_pk_bf16_f32 v2, v20, v21
    v_cvt_pk_bf16_f32 v3, v22, v23
    v_mfma_f32_4x4x4_16b_bf16 v[28:31], v[6:7], a[162:163], v[28:31] cbsz:1 abid:1
    buffer_store_dwordx4 v[0:3], v208, s[16:19], s40 offen sc1 nt
    s_add_i32 s40, s40, 0x4000
    v_mov_b32_dpp v222, v209 row_newbcast:2 row_mask:0xf bank_mask:0xf
    v_mfma_f32_4x4x4_16b_bf16 v[16:19], v[8:9], a[160:161], 0 cbsz:1 abid:0
    v_cvt_pk_bf16_f32 v4, v24, v25
    v_mfma_f32_4x4x4_16b_bf16 v[20:23], v[8:9], a[160:161], 0 cbsz:1 abid:1
    v_cvt_pk_bf16_f32 v5, v26, v27
    v_mfma_f32_4x4x4_16b_bf16 v[16:19], v[10:11], a[162:163], v[16:19] cbsz:1 abid:0
    v_cvt_pk_bf16_f32 v6, v28, v29
    v_cvt_pk_bf16_f32 v7, v30, v31
    v_mov_b32_dpp v223, v209 row_newbcast:3 row_mask:0xf bank_mask:0xf
    v_mfma_f32_4x4x4_16b_bf16 v[20:23], v[10:11], a[162:163], v[20:23] cbsz:1 abid:1
    buffer_store_dwordx4 v[4:7], v208, s[16:19], s40 offen sc1 nt
    s_add_i32 s40, s40, 0x4000
    v_pk_mul_f32 v[32:33], v[32:33], v[220:221]
    v_pk_mul_f32 v[34:35], v[34:35], v[222:223]
    v_mfma_f32_4x4x4_16b_bf16 v[24:27], v[12:13], a[160:161], 0 cbsz:1 abid:0
    v_cvt_pk_bf16_f32 v8, v16, v17
    v_mfma_f32_4x4x4_16b_bf16 v[28:31], v[12:13], a[160:161], 0 cbsz:1 abid:1
    v_cvt_pk_bf16_f32 v9, v18, v19
    v_mfma_f32_4x4x4_16b_bf16 v[24:27], v[14:15], a[162:163], v[24:27] cbsz:1 abid:0
    v_cvt_pk_bf16_f32 v10, v20, v21
    v_cvt_pk_bf16_f32 v11, v22, v23
    v_mfma_f32_4x4x4_16b_bf16 v[28:31], v[14:15], a[162:163], v[28:31] cbsz:1 abid:1
    buffer_store_dwordx4 v[8:11], v208, s[16:19], s40 offen sc1 nt
    s_add_i32 s40, s40, 0x4000
    v_pk_mul_f32 v[36:37], v[36:37], v[220:221]
    v_pk_mul_f32 v[38:39], v[38:39], v[222:223]
    v_pk_mul_f32 v[40:41], v[40:41], v[220:221]
    v_pk_mul_f32 v[42:43], v[42:43], v[222:223]
    v_pk_mul_f32 v[44:45], v[44:45], v[220:221]
    v_pk_mul_f32 v[46:47], v[46:47], v[222:223]
    v_pk_mul_f32 v[48:49], v[48:49], v[220:221]
    v_pk_mul_f32 v[50:51], v[50:51], v[222:223]
    v_pk_mul_f32 v[52:53], v[52:53], v[220:221]
    v_pk_mul_f32 v[54:55], v[54:55], v[222:223]
    v_pk_mul_f32 v[56:57], v[56:57], v[220:221]
    v_pk_mul_f32 v[58:59], v[58:59], v[222:223]
    v_pk_mul_f32 v[60:61], v[60:61], v[220:221]
    v_pk_mul_f32 v[62:63], v[62:63], v[222:223]
    v_mfma_f32_16x16x32_bf16 v[192:195], a[0:3], v[160:163], v[232:235]
    v_cvt_pk_bf16_f32 v12, v24, v25
    v_cvt_pk_bf16_f32 v13, v26, v27
    v_mfma_f32_16x16x32_bf16 v[192:195], a[4:7], v[164:167], v[192:195]
    v_cvt_pk_bf16_f32 v14, v28, v29
    v_cvt_pk_bf16_f32 v15, v30, v31
    v_mfma_f32_16x16x32_bf16 v[192:195], a[8:11], v[168:171], v[192:195]
    buffer_store_dwordx4 v[12:15], v208, s[16:19], s40 offen sc1 nt
    s_add_i32 s40, s40, 0x4000
    v_cvt_pk_bf16_f32 v32, v32, v36
    v_mfma_f32_16x16x32_bf16 v[192:195], a[12:15], v[172:175], v[192:195]
    v_cvt_pk_bf16_f32 v36, v33, v37
    v_cvt_pk_bf16_f32 v33, v40, v44
    v_mfma_f32_16x16x32_bf16 v[196:199], a[16:19], v[172:175], v[232:235]
    ds_read_b128 v[172:175], v254 offset:8896
    v_cvt_pk_bf16_f32 v37, v41, v45
    v_mfma_f32_16x16x32_bf16 v[196:199], a[20:23], v[168:171], v[196:199]
    v_cvt_pk_bf16_f32 v40, v34, v38
    v_cvt_pk_bf16_f32 v44, v35, v39
    v_cvt_pk_bf16_f32 v41, v42, v46
    v_cvt_pk_bf16_f32 v45, v43, v47
    v_cvt_pk_bf16_f32 v34, v48, v52
    v_cvt_pk_bf16_f32 v38, v49, v53
    v_cvt_pk_bf16_f32 v42, v50, v54
    v_cvt_pk_bf16_f32 v46, v51, v55
    v_mfma_f32_4x4x4_16b_bf16 v[48:51], v[32:33], a[160:161], 0 cbsz:1 abid:0
    v_cvt_pk_bf16_f32 v35, v56, v60
    v_mfma_f32_4x4x4_16b_bf16 v[52:55], v[32:33], a[160:161], 0 cbsz:1 abid:1
    v_cvt_pk_bf16_f32 v39, v57, v61
    v_cvt_pk_bf16_f32 v43, v58, v62
    v_mfma_f32_4x4x4_16b_bf16 v[48:51], v[34:35], a[162:163], v[48:51] cbsz:1 abid:0
    v_cvt_pk_bf16_f32 v47, v59, v63
    v_mfma_f32_4x4x4_16b_bf16 v[52:55], v[34:35], a[162:163], v[52:55] cbsz:1 abid:1
    ds_read_b128 v[168:171], v254 offset:8832
    v_mfma_f32_4x4x4_16b_bf16 v[56:59], v[36:37], a[160:161], 0 cbsz:1 abid:0
    v_exp_f32_e64 v192, v192
    v_mfma_f32_4x4x4_16b_bf16 v[60:63], v[36:37], a[160:161], 0 cbsz:1 abid:1
    v_cvt_pk_bf16_f32 v32, v48, v49
    v_mfma_f32_4x4x4_16b_bf16 v[56:59], v[38:39], a[162:163], v[56:59] cbsz:1 abid:0
    v_cvt_pk_bf16_f32 v33, v50, v51
    v_cvt_pk_bf16_f32 v34, v52, v53
    v_mfma_f32_16x16x32_bf16 v[196:199], a[24:27], v[164:167], v[196:199]
    ds_read_b128 v[164:167], v254 offset:8768
    v_exp_f32_e64 v193, v193
    v_mfma_f32_16x16x32_bf16 v[196:199], a[28:31], v[160:163], v[196:199]
    ds_read_b128 v[160:163], v254 offset:8704
    v_cvt_pk_bf16_f32 v35, v54, v55
    v_exp_f32_e64 v194, v194
    v_mfma_f32_4x4x4_16b_bf16 v[60:63], v[38:39], a[162:163], v[60:63] cbsz:1 abid:1
    buffer_store_dwordx4 v[32:35], v208, s[16:19], s40 offen sc1 nt
    s_add_i32 s40, s40, 0x4000
    v_cvt_pk_bf16_f32 v212, v192, v193
    v_mfma_f32_4x4x4_16b_bf16 v[48:51], v[40:41], a[160:161], 0 cbsz:1 abid:0
    v_cvt_pk_bf16_f32 v36, v56, v57
    v_mfma_f32_4x4x4_16b_bf16 v[52:55], v[40:41], a[160:161], 0 cbsz:1 abid:1
    v_cvt_pk_bf16_f32 v37, v58, v59
    v_mfma_f32_4x4x4_16b_bf16 v[48:51], v[42:43], a[162:163], v[48:51] cbsz:1 abid:0
    v_cvt_pk_bf16_f32 v38, v60, v61
    v_cvt_pk_bf16_f32 v39, v62, v63
    v_exp_f32_e64 v195, v195
    v_mfma_f32_4x4x4_16b_bf16 v[52:55], v[42:43], a[162:163], v[52:55] cbsz:1 abid:1
    buffer_store_dwordx4 v[36:39], v208, s[16:19], s40 offen sc1 nt
    s_addk_i32 s40, 0x4000
    v_exp_f32 v196, v196
    v_mfma_f32_4x4x4_16b_bf16 v[56:59], v[44:45], a[160:161], 0 cbsz:1 abid:0
    v_cvt_pk_bf16_f32 v40, v48, v49
    v_mfma_f32_4x4x4_16b_bf16 v[60:63], v[44:45], a[160:161], 0 cbsz:1 abid:1
    v_cvt_pk_bf16_f32 v41, v50, v51
    v_mfma_f32_4x4x4_16b_bf16 v[56:59], v[46:47], a[162:163], v[56:59] cbsz:1 abid:0
    v_cvt_pk_bf16_f32 v42, v52, v53
    v_cvt_pk_bf16_f32 v43, v54, v55
    v_mfma_f32_4x4x4_16b_bf16 v[60:63], v[46:47], a[162:163], v[60:63] cbsz:1 abid:1
    buffer_store_dwordx4 v[40:43], v208, s[16:19], s40 offen sc1 nt
    s_addk_i32 s40, 0x4000
    v_cvt_pk_bf16_f32 v213, v194, v195
    v_exp_f32 v197, v197
    v_exp_f32 v198, v198
    v_cvt_pk_bf16_f32 v214, v196, v197
    v_exp_f32 v199, v199
    s_nop 0
    v_cvt_pk_bf16_f32 v215, v198, v199
    s_nop 1
    v_smfmac_f32_16x16x64_bf16 v[244:247], a[168:171], v[212:219], v255
    v_cvt_pk_bf16_f32 v44, v56, v57
    v_mfma_f32_16x16x32_bf16 v[64:67], v[212:215], a[64:67], v[64:67]
    v_cvt_pk_bf16_f32 v45, v58, v59
    v_cvt_pk_bf16_f32 v46, v60, v61
    v_mfma_f32_16x16x32_bf16 v[68:71], v[212:215], a[76:79], v[68:71]
    v_add_f32 v209, v244, v245
    v_subrev_u32 v210, 0x37800000, v209
    v_mfma_f32_16x16x32_bf16 v[72:75], v[212:215], a[80:83], v[72:75]
    v_rcp_f32 v209, v209
    v_mfma_f32_16x16x32_bf16 v[76:79], v[212:215], a[92:95], v[76:79]
    s_nop 0
    v_cmp_lt_u32 s[66:67], s79, v210
    v_mov_b32_dpp v209, v209 row_ror:12 row_mask:0xa bank_mask:0xf
    v_mfma_f32_16x16x32_bf16 v[80:83], v[212:215], a[96:99], v[80:83]
    s_or_b64 s[64:65], s[64:65], s[66:67]
    v_cvt_pk_bf16_f32 v47, v62, v63
    v_mov_b32_dpp v209, v209 row_ror:8 row_mask:0xc bank_mask:0xf
    v_mfma_f32_16x16x32_bf16 v[84:87], v[212:215], a[108:111], v[84:87]
    buffer_store_dwordx4 v[44:47], v208, s[16:19], s40 offen sc1 nt
    s_add_i32 s40, s40, 0x4000
    v_mov_b32_dpp v220, v209 row_newbcast:0 row_mask:0xf bank_mask:0xf
    v_mov_b32_dpp v221, v209 row_newbcast:1 row_mask:0xf bank_mask:0xf
    v_mfma_f32_16x16x32_bf16 v[88:91], v[212:215], a[112:115], v[88:91]
    v_mov_b32_dpp v222, v209 row_newbcast:2 row_mask:0xf bank_mask:0xf
    v_mov_b32_dpp v223, v209 row_newbcast:3 row_mask:0xf bank_mask:0xf
    v_mfma_f32_16x16x32_bf16 v[92:95], v[212:215], a[124:127], v[92:95]
    v_pk_mul_f32 v[64:65], v[64:65], v[220:221]
    v_pk_mul_f32 v[66:67], v[66:67], v[222:223]
    v_pk_mul_f32 v[68:69], v[68:69], v[220:221]
    v_pk_mul_f32 v[70:71], v[70:71], v[222:223]
    v_pk_mul_f32 v[72:73], v[72:73], v[220:221]
    v_pk_mul_f32 v[74:75], v[74:75], v[222:223]
    v_pk_mul_f32 v[76:77], v[76:77], v[220:221]
    v_pk_mul_f32 v[78:79], v[78:79], v[222:223]
    v_pk_mul_f32 v[80:81], v[80:81], v[220:221]
    v_pk_mul_f32 v[82:83], v[82:83], v[222:223]
    v_pk_mul_f32 v[84:85], v[84:85], v[220:221]
    v_pk_mul_f32 v[86:87], v[86:87], v[222:223]
    v_pk_mul_f32 v[88:89], v[88:89], v[220:221]
    v_pk_mul_f32 v[90:91], v[90:91], v[222:223]
    v_pk_mul_f32 v[92:93], v[92:93], v[220:221]
    v_pk_mul_f32 v[94:95], v[94:95], v[222:223]
    v_mfma_f32_16x16x32_bf16 v[200:203], a[0:3], v[176:179], v[236:239]
    v_cvt_pk_bf16_f32 v64, v64, v68
    v_cvt_pk_bf16_f32 v68, v65, v69
    v_mfma_f32_16x16x32_bf16 v[200:203], a[4:7], v[180:183], v[200:203]
    v_cvt_pk_bf16_f32 v65, v72, v76
    v_cvt_pk_bf16_f32 v69, v73, v77
    v_mfma_f32_16x16x32_bf16 v[200:203], a[8:11], v[184:187], v[200:203]
    v_cvt_pk_bf16_f32 v72, v66, v70
    v_cvt_pk_bf16_f32 v76, v67, v71
    v_mfma_f32_16x16x32_bf16 v[200:203], a[12:15], v[188:191], v[200:203]
    v_cvt_pk_bf16_f32 v73, v74, v78
    v_cvt_pk_bf16_f32 v77, v75, v79
    v_mfma_f32_16x16x32_bf16 v[204:207], a[16:19], v[188:191], v[236:239]
    v_cvt_pk_bf16_f32 v66, v80, v84
    v_cvt_pk_bf16_f32 v70, v81, v85
    v_mfma_f32_16x16x32_bf16 v[204:207], a[20:23], v[184:187], v[204:207]
    v_exp_f32_e64 v200, v200
    v_mfma_f32_16x16x32_bf16 v[204:207], a[24:27], v[180:183], v[204:207]
    v_exp_f32_e64 v201, v201
    v_mfma_f32_16x16x32_bf16 v[204:207], a[28:31], v[176:179], v[204:207]
    v_cvt_pk_bf16_f32 v74, v82, v86
    v_cvt_pk_bf16_f32 v78, v83, v87
    v_exp_f32_e64 v202, v202
    v_mfma_f32_4x4x4_16b_bf16 v[80:83], v[64:65], a[160:161], 0 cbsz:1 abid:0
    v_cvt_pk_bf16_f32 v67, v88, v92
    v_mfma_f32_4x4x4_16b_bf16 v[84:87], v[64:65], a[160:161], 0 cbsz:1 abid:1
    v_cvt_pk_bf16_f32 v71, v89, v93
    v_cvt_pk_bf16_f32 v75, v90, v94
    v_mfma_f32_4x4x4_16b_bf16 v[80:83], v[66:67], a[162:163], v[80:83] cbsz:1 abid:0
    v_cvt_pk_bf16_f32 v79, v91, v95
    v_mfma_f32_4x4x4_16b_bf16 v[84:87], v[66:67], a[162:163], v[84:87] cbsz:1 abid:1
    v_cvt_pk_bf16_f32 v216, v200, v201
    v_mfma_f32_4x4x4_16b_bf16 v[88:91], v[68:69], a[160:161], 0 cbsz:1 abid:0
    v_exp_f32_e64 v203, v203
    v_mfma_f32_4x4x4_16b_bf16 v[92:95], v[68:69], a[160:161], 0 cbsz:1 abid:1
    v_cvt_pk_bf16_f32 v64, v80, v81
    v_mfma_f32_4x4x4_16b_bf16 v[88:91], v[70:71], a[162:163], v[88:91] cbsz:1 abid:0
    v_cvt_pk_bf16_f32 v65, v82, v83
    v_cvt_pk_bf16_f32 v66, v84, v85
    v_cvt_pk_bf16_f32 v67, v86, v87
    v_mfma_f32_4x4x4_16b_bf16 v[92:95], v[70:71], a[162:163], v[92:95] cbsz:1 abid:1
    buffer_store_dwordx4 v[64:67], v208, s[16:19], s40 offen sc1 nt
    s_addk_i32 s40, 0x4000
    v_exp_f32 v204, v204
    v_mfma_f32_4x4x4_16b_bf16 v[80:83], v[72:73], a[160:161], 0 cbsz:1 abid:0
    v_cvt_pk_bf16_f32 v68, v88, v89
    v_mfma_f32_4x4x4_16b_bf16 v[84:87], v[72:73], a[160:161], 0 cbsz:1 abid:1
    v_cvt_pk_bf16_f32 v69, v90, v91
    v_mfma_f32_4x4x4_16b_bf16 v[80:83], v[74:75], a[162:163], v[80:83] cbsz:1 abid:0
    v_cvt_pk_bf16_f32 v70, v92, v93
    v_cvt_pk_bf16_f32 v71, v94, v95
    v_mfma_f32_4x4x4_16b_bf16 v[84:87], v[74:75], a[162:163], v[84:87] cbsz:1 abid:1
    buffer_store_dwordx4 v[68:71], v208, s[16:19], s40 offen sc1 nt
    s_add_i32 s40, s40, 0x4000
    v_cvt_pk_bf16_f32 v217, v202, v203
    v_mfma_f32_4x4x4_16b_bf16 v[88:91], v[76:77], a[160:161], 0 cbsz:1 abid:0
    v_cvt_pk_bf16_f32 v72, v80, v81
    v_mfma_f32_4x4x4_16b_bf16 v[92:95], v[76:77], a[160:161], 0 cbsz:1 abid:1
    v_cvt_pk_bf16_f32 v73, v82, v83
    v_mfma_f32_4x4x4_16b_bf16 v[88:91], v[78:79], a[162:163], v[88:91] cbsz:1 abid:0
    v_cvt_pk_bf16_f32 v74, v84, v85
    v_cvt_pk_bf16_f32 v75, v86, v87
    v_exp_f32_e64 v205, v205
    v_mfma_f32_4x4x4_16b_bf16 v[92:95], v[78:79], a[162:163], v[92:95] cbsz:1 abid:1
    buffer_store_dwordx4 v[72:75], v208, s[16:19], s40 offen sc1 nt
    s_add_i32 s40, s40, 0x4000
    v_exp_f32 v206, v206
    v_cvt_pk_bf16_f32 v218, v204, v205
    v_exp_f32_e64 v207, v207
    s_nop 0
    v_cvt_pk_bf16_f32 v219, v206, v207
    s_nop 1
    v_smfmac_f32_16x16x64_bf16 v[244:247], a[172:175], v[212:219], v255
    s_nop 0
    v_cvt_pk_bf16_f32 v76, v88, v89
    v_mfma_f32_16x16x32_bf16 v[96:99], v[216:219], a[64:67], v[96:99]
    s_nop 0
    ds_read_b128 a[0:3], v248 offset:0
    v_cvt_pk_bf16_f32 v77, v90, v91
    v_mfma_f32_16x16x32_bf16 v[100:103], v[216:219], a[76:79], v[100:103]
    s_mov_b32 s32, s31
    ds_read_b128 a[4:7], v248 offset:64
    v_add_f32 v209, v246, v247
    v_mfma_f32_16x16x32_bf16 v[104:107], v[216:219], a[80:83], v[104:107]
    s_mov_b32 m0, s31
    ds_read_b128 a[8:11], v248 offset:128
    v_subrev_u32 v210, 0x37800000, v209
    v_mfma_f32_16x16x32_bf16 v[108:111], v[216:219], a[92:95], v[108:111]
    s_mov_b32 s22, s24
    ds_read_b128 a[12:15], v248 offset:192
    v_rcp_f32 v209, v209
    v_mfma_f32_16x16x32_bf16 v[112:115], v[216:219], a[96:99], v[112:115]
    s_add_u32 s23, s24, s25
    ds_read_b128 a[16:19], v248 offset:704
    v_cmp_lt_u32 s[66:67], s79, v210
    v_mfma_f32_16x16x32_bf16 v[116:119], v[216:219], a[108:111], v[116:119]
    s_add_u32 s24, s23, s25
    ds_read_b128 a[20:23], v248 offset:640
    v_mov_b32_dpp v209, v209 row_ror:12 row_mask:0xa bank_mask:0xf
    v_mfma_f32_16x16x32_bf16 v[120:123], v[216:219], a[112:115], v[120:123]
    s_or_b64 s[64:65], s[64:65], s[66:67]
    ds_read_b128 a[24:27], v248 offset:576
    v_mov_b32_dpp v209, v209 row_ror:8 row_mask:0xc bank_mask:0xf
    v_mfma_f32_16x16x32_bf16 v[124:127], v[216:219], a[124:127], v[124:127]
    s_nop 0
    ds_read_b128 a[28:31], v248 offset:512
    v_mov_b32_dpp v220, v209 row_newbcast:0 row_mask:0xf bank_mask:0xf
    v_mov_b32_dpp v221, v209 row_newbcast:1 row_mask:0xf bank_mask:0xf
    v_mov_b32_dpp v222, v209 row_newbcast:2 row_mask:0xf bank_mask:0xf
    v_mov_b32_dpp v223, v209 row_newbcast:3 row_mask:0xf bank_mask:0xf
    v_pk_mul_f32 v[96:97], v[96:97], v[220:221]
    v_pk_mul_f32 v[98:99], v[98:99], v[222:223]
    v_pk_mul_f32 v[100:101], v[100:101], v[220:221]
    v_pk_mul_f32 v[102:103], v[102:103], v[222:223]
    v_pk_mul_f32 v[104:105], v[104:105], v[220:221]
    v_pk_mul_f32 v[106:107], v[106:107], v[222:223]
    v_pk_mul_f32 v[108:109], v[108:109], v[220:221]
    v_pk_mul_f32 v[110:111], v[110:111], v[222:223]
    v_pk_mul_f32 v[112:113], v[112:113], v[220:221]
    v_pk_mul_f32 v[114:115], v[114:115], v[222:223]
    v_pk_mul_f32 v[116:117], v[116:117], v[220:221]
    v_pk_mul_f32 v[118:119], v[118:119], v[222:223]
    v_pk_mul_f32 v[120:121], v[120:121], v[220:221]
    v_pk_mul_f32 v[122:123], v[122:123], v[222:223]
    v_pk_mul_f32 v[124:125], v[124:125], v[220:221]
    v_pk_mul_f32 v[126:127], v[126:127], v[222:223]
    v_mfma_f32_4x4x4_16b_bf16 v[0:3], a[156:157], v[128:129], 0
    buffer_load_dwordx4 v250, s[8:11], s22 offen offset:0 lds
    v_mfma_f32_4x4x4_16b_bf16 v[4:7], a[156:157], v[130:131], 0
    v_cvt_pk_bf16_f32 v78, v92, v93
    v_cvt_pk_bf16_f32 v79, v94, v95
    v_mfma_f32_4x4x4_16b_bf16 v[8:11], a[156:157], v[132:133], 0
    buffer_store_dwordx4 v[76:79], v208, s[16:19], s40 offen sc1 nt
    s_add_i32 s40, s40, 0x4000
    v_cvt_pk_bf16_f32 v96, v96, v100
    v_mfma_f32_4x4x4_16b_bf16 v[0:3], a[158:159], v[128:129], v[0:3]
    v_cvt_pk_bf16_f32 v100, v97, v101
    v_mfma_f32_4x4x4_16b_bf16 v[12:15], a[156:157], v[134:135], 0
    v_cvt_pk_bf16_f32 v97, v104, v108
    v_mfma_f32_4x4x4_16b_bf16 v[4:7], a[158:159], v[130:131], v[4:7]
    v_cvt_pk_bf16_f32 v101, v105, v109
    v_mfma_f32_4x4x4_16b_bf16 v[16:19], a[156:157], v[136:137], 0
    v_cvt_pk_bf16_f32 v104, v98, v102
    v_cvt_pk_bf16_f32 v108, v99, v103
    v_cvt_pk_bf16_f32 v105, v106, v110
    v_cvt_pk_bf16_f32 v109, v107, v111
    v_cvt_pk_bf16_f32 v98, v112, v116
    v_cvt_pk_bf16_f32 v102, v113, v117
    v_cvt_pk_bf16_f32 v106, v114, v118
    v_cvt_pk_bf16_f32 v110, v115, v119
    v_mfma_f32_4x4x4_16b_bf16 v[112:115], v[96:97], a[160:161], 0 cbsz:1 abid:0
    v_cvt_pk_bf16_f32 v99, v120, v124
    v_mfma_f32_4x4x4_16b_bf16 v[116:119], v[96:97], a[160:161], 0 cbsz:1 abid:1
    v_cvt_pk_bf16_f32 v103, v121, v125
    v_cvt_pk_bf16_f32 v107, v122, v126
    v_mfma_f32_4x4x4_16b_bf16 v[112:115], v[98:99], a[162:163], v[112:115] cbsz:1 abid:0
    v_cvt_pk_bf16_f32 v111, v123, v127
    v_mfma_f32_4x4x4_16b_bf16 v[116:119], v[98:99], a[162:163], v[116:119] cbsz:1 abid:1
    v_cvt_pk_bf16_f32 v128, v0, v1
    v_mfma_f32_4x4x4_16b_bf16 v[120:123], v[100:101], a[160:161], 0 cbsz:1 abid:0
    v_mfma_f32_4x4x4_16b_bf16 v[124:127], v[100:101], a[160:161], 0 cbsz:1 abid:1
    v_cvt_pk_bf16_f32 v96, v112, v113
    v_mfma_f32_4x4x4_16b_bf16 v[120:123], v[102:103], a[162:163], v[120:123] cbsz:1 abid:0
    v_cvt_pk_bf16_f32 v97, v114, v115
    v_mfma_f32_4x4x4_16b_bf16 v[8:11], a[158:159], v[132:133], v[8:11]
    v_cvt_pk_bf16_f32 v98, v116, v117
    v_cvt_pk_bf16_f32 v99, v118, v119
    v_mfma_f32_4x4x4_16b_bf16 v[124:127], v[102:103], a[162:163], v[124:127] cbsz:1 abid:1
    buffer_store_dwordx4 v[96:99], v208, s[16:19], s40 offen sc1 nt
    s_addk_i32 s40, 0x4000
    s_mov_b32 s76, s39
    s_mov_b32 s39, 0
    s_mov_b32 s73, s37
    v_cvt_pk_bf16_f32 v129, v2, v3
    v_mfma_f32_4x4x4_16b_bf16 v[112:115], v[104:105], a[160:161], 0 cbsz:1 abid:0
    v_cvt_pk_bf16_f32 v100, v120, v121
    v_mfma_f32_4x4x4_16b_bf16 v[116:119], v[104:105], a[160:161], 0 cbsz:1 abid:1
    v_cvt_pk_bf16_f32 v101, v122, v123
    v_mfma_f32_4x4x4_16b_bf16 v[112:115], v[106:107], a[162:163], v[112:115] cbsz:1 abid:0
    v_cvt_pk_bf16_f32 v102, v124, v125
    v_mfma_f32_4x4x4_16b_bf16 v[20:23], a[156:157], v[138:139], 0
    v_cvt_pk_bf16_f32 v103, v126, v127
    v_mfma_f32_4x4x4_16b_bf16 v[116:119], v[106:107], a[162:163], v[116:119] cbsz:1 abid:1
    v_cvt_pk_bf16_f32 v130, v4, v5
    v_mfma_f32_4x4x4_16b_bf16 v[12:15], a[158:159], v[134:135], v[12:15]
    v_cvt_pk_bf16_f32 v131, v6, v7
    v_mfma_f32_4x4x4_16b_bf16 v[24:27], a[156:157], v[140:141], 0
    buffer_load_dwordx4 v251, s[8:11], s22 offen offset:1152 lds
    buffer_store_dwordx4 v[100:103], v208, s[16:19], s40 offen sc1 nt
    s_addk_i32 s40, 0x4000
    s_mov_b32 s74, s26
    s_lshr_b32 s34, s36, 1
    s_sub_u32 s34, s34, 2
    v_cvt_pk_bf16_f32 v132, v8, v9
    v_mfma_f32_4x4x4_16b_bf16 v[120:123], v[108:109], a[160:161], 0 cbsz:1 abid:0
    v_cvt_pk_bf16_f32 v104, v112, v113
    v_mfma_f32_4x4x4_16b_bf16 v[124:127], v[108:109], a[160:161], 0 cbsz:1 abid:1
    v_cvt_pk_bf16_f32 v105, v114, v115
    v_mfma_f32_4x4x4_16b_bf16 v[120:123], v[110:111], a[162:163], v[120:123] cbsz:1 abid:0
    v_cvt_pk_bf16_f32 v106, v116, v117
    v_mfma_f32_4x4x4_16b_bf16 v[16:19], a[158:159], v[136:137], v[16:19]
    v_cvt_pk_bf16_f32 v107, v118, v119
    v_mfma_f32_4x4x4_16b_bf16 v[124:127], v[110:111], a[162:163], v[124:127] cbsz:1 abid:1
    v_cvt_pk_bf16_f32 v133, v10, v11
    v_mfma_f32_4x4x4_16b_bf16 v[28:31], a[156:157], v[142:143], 0
    v_cvt_pk_bf16_f32 v134, v12, v13
    v_mfma_f32_4x4x4_16b_bf16 v[20:23], a[158:159], v[138:139], v[20:23]
    v_cvt_pk_bf16_f32 v135, v14, v15
    v_mfma_f32_4x4x4_16b_bf16 v[32:35], a[156:157], v[144:145], 0
    v_cvt_pk_bf16_f32 v136, v16, v17
    v_mfma_f32_4x4x4_16b_bf16 v[24:27], a[158:159], v[140:141], v[24:27]
    v_cvt_pk_bf16_f32 v137, v18, v19
    v_mfma_f32_4x4x4_16b_bf16 v[36:39], a[156:157], v[146:147], 0
    v_cvt_pk_bf16_f32 v138, v20, v21
    v_mfma_f32_4x4x4_16b_bf16 v[28:31], a[158:159], v[142:143], v[28:31]
    buffer_load_dwordx4 v250, s[12:15], s22 offen offset:2176 lds
    buffer_store_dwordx4 v[104:107], v208, s[16:19], s40 offen sc1 nt
    s_add_i32 s40, s40, 0x4000
    s_mov_b32 s26, 2.0
    s_mov_b32 s27, 2.0
    s_mov_b32 s28, 2.0
    v_cvt_pk_bf16_f32 v139, v22, v23
    v_mfma_f32_4x4x4_16b_bf16 v[40:43], a[156:157], v[148:149], 0
    v_cvt_pk_bf16_f32 v140, v24, v25
    v_mfma_f32_4x4x4_16b_bf16 v[32:35], a[158:159], v[144:145], v[32:35]
    v_cvt_pk_bf16_f32 v108, v120, v121
    v_cvt_pk_bf16_f32 v109, v122, v123
    v_cvt_pk_bf16_f32 v110, v124, v125
    v_cvt_pk_bf16_f32 v111, v126, v127
    buffer_store_dwordx4 v[108:111], v208, s[16:19], s40 offen sc1 nt
    s_mov_b32 s18, s38
    s_cmp_lg_u32 s54, 0
    s_waitcnt lgkmcnt(0)
    v_cvt_pk_bf16_f32 v141, v26, v27
    v_mfma_f32_4x4x4_16b_bf16 v[44:47], a[156:157], v[150:151], 0
    v_cvt_pk_bf16_f32 v142, v28, v29
    v_mfma_f32_4x4x4_16b_bf16 v[36:39], a[158:159], v[146:147], v[36:39]
    v_cvt_pk_bf16_f32 v143, v30, v31
    v_mfma_f32_4x4x4_16b_bf16 v[48:51], a[156:157], v[152:153], 0
    v_cvt_pk_bf16_f32 v144, v32, v33
    v_mfma_f32_4x4x4_16b_bf16 v[40:43], a[158:159], v[148:149], v[40:43]
    v_cvt_pk_bf16_f32 v145, v34, v35
    v_mfma_f32_4x4x4_16b_bf16 v[52:55], a[156:157], v[154:155], 0
    buffer_load_dwordx4 v252, s[12:15], s22 offen offset:3216 lds
    v_cvt_pk_bf16_f32 v146, v36, v37
    v_mfma_f32_4x4x4_16b_bf16 v[44:47], a[158:159], v[150:151], v[44:47]
    v_cvt_pk_bf16_f32 v147, v38, v39
    v_mfma_f32_4x4x4_16b_bf16 v[56:59], a[156:157], v[156:157], 0
    v_cvt_pk_bf16_f32 v148, v40, v41
    v_mfma_f32_4x4x4_16b_bf16 v[48:51], a[158:159], v[152:153], v[48:51]
    v_cvt_pk_bf16_f32 v149, v42, v43
    v_mfma_f32_4x4x4_16b_bf16 v[60:63], a[156:157], v[158:159], 0
    v_cvt_pk_bf16_f32 v150, v44, v45
    v_mfma_f32_4x4x4_16b_bf16 v[52:55], a[158:159], v[154:155], v[52:55]
    v_cvt_pk_bf16_f32 v151, v46, v47
    v_mfma_f32_4x4x4_16b_bf16 v[56:59], a[158:159], v[156:157], v[56:59]
    v_cvt_pk_bf16_f32 v152, v48, v49
    v_mfma_f32_4x4x4_16b_bf16 v[60:63], a[158:159], v[158:159], v[60:63]
    v_cvt_pk_bf16_f32 v153, v50, v51
    v_cvt_pk_bf16_f32 v154, v52, v53
    v_cvt_pk_bf16_f32 v155, v54, v55
    v_cvt_pk_bf16_f32 v156, v56, v57
    v_cvt_pk_bf16_f32 v157, v58, v59
    v_cvt_pk_bf16_f32 v158, v60, v61
    v_cvt_pk_bf16_f32 v159, v62, v63
    s_cbranch_scc1 L_maxpass2
    s_cmp_eq_u32 s76, 5
    s_cbranch_scc1 L_first2p_2
    s_branch L_first2p_3
.p2align 12
.p2align 5
P_loop_3:
    s_setpc_b64 s[62:63]
.fill 7, 4, 0xbf800000
L_loop_3:
    v_mfma_f32_16x16x32_bf16 v[192:195], a[0:3], v[144:147], v[228:231]
    s_add_u32 s31, s30, s33
    ds_read_b64_tr_b16 a[96:97], v249 offset:2240
    ds_read_b64_tr_b16 a[98:99], v249 offset:2752
    v_mfma_f32_16x16x32_bf16 v[192:195], a[4:7], v[148:151], v[192:195]
    s_add_u32 s30, s30, s80
    v_exp_f32 v205, v205
    v_mfma_f32_16x16x32_bf16 v[192:195], a[8:11], v[152:155], v[192:195]
    s_cmp_eq_u32 s30, 105216
    ds_read_b64_tr_b16 a[100:101], v249 offset:19776
    ds_read_b64_tr_b16 a[102:103], v249 offset:20288
    v_mfma_f32_16x16x32_bf16 v[192:195], a[12:15], v[156:159], v[192:195]
    s_cmov_b32 s30, 0
    v_exp_f32 v206, v206
    v_mfma_f32_16x16x32_bf16 v[196:199], a[16:19], v[156:159], v[228:231]
    s_cselect_b32 s35, s81, s80
    ds_read_b64_tr_b16 a[104:105], v249 offset:19792
    ds_read_b64_tr_b16 a[106:107], v249 offset:20304
    v_mfma_f32_16x16x32_bf16 v[196:199], a[20:23], v[152:155], v[196:199]
    s_mov_b32 s44, s24
    v_exp_f32 v207, v207
    v_mfma_f32_16x16x32_bf16 v[196:199], a[24:27], v[148:151], v[196:199]
    s_add_u32 s45, s24, s25
    ds_read_b64_tr_b16 a[108:109], v249 offset:2256
    ds_read_b64_tr_b16 a[110:111], v249 offset:2768
    v_mfma_f32_16x16x32_bf16 v[196:199], a[28:31], v[144:147], v[196:199]
    s_add_u32 s24, s45, s25
    v_cvt_pk_bf16_f32 v98, v204, v205
    v_cvt_pk_bf16_f32 v99, v206, v207
    v_mfma_f32_16x16x32_bf16 v[200:203], a[32:35], v[144:147], v[228:231]
    s_cmp_eq_u32 s34, 2
    ds_read_b64_tr_b16 a[112:113], v249 offset:2272
    ds_read_b64_tr_b16 a[114:115], v249 offset:2784
    v_mfma_f32_16x16x32_bf16 v[200:203], a[36:39], v[148:151], v[200:203]
    s_cmov_b32 s45, 2.0
    v_exp_f32 v192, v192
    v_mfma_f32_16x16x32_bf16 v[200:203], a[40:43], v[152:155], v[200:203]
    s_cmp_eq_u32 s34, 1
    ds_read_b64_tr_b16 a[116:117], v249 offset:19808
    ds_read_b64_tr_b16 a[118:119], v249 offset:20320
    v_mfma_f32_16x16x32_bf16 v[200:203], a[44:47], v[156:159], v[200:203]
    s_cmov_b64 s[44:45], s[26:27]
    v_exp_f32 v193, v193
    v_mfma_f32_16x16x32_bf16 v[204:207], a[48:51], v[156:159], v[228:231]
    s_cmov_b64 s[24:25], s[28:29]
    ds_read_b64_tr_b16 a[120:121], v249 offset:19824
    ds_read_b64_tr_b16 a[122:123], v249 offset:20336
    v_mfma_f32_16x16x32_bf16 v[204:207], a[52:55], v[152:155], v[204:207]
    s_cselect_b32 s46, s78, 0x13da880
    v_exp_f32 v194, v194
    v_mfma_f32_16x16x32_bf16 v[204:207], a[56:59], v[148:151], v[204:207]
    ds_read_b64_tr_b16 a[124:125], v249 offset:2288
    ds_read_b64_tr_b16 a[126:127], v249 offset:2800
    v_mfma_f32_16x16x32_bf16 v[204:207], a[60:63], v[144:147], v[204:207]
    s_waitcnt lgkmcnt(15)
    v_exp_f32 v195, v195
    v_mfma_f32_16x16x32_bf16 v[0:3], v[100:103], a[64:67], v[0:3]
    v_cvt_pk_bf16_f32 v104, v192, v193
    v_cvt_pk_bf16_f32 v105, v194, v195
    v_mfma_f32_16x16x32_bf16 v[0:3], v[96:99], a[68:71], v[0:3]
    v_exp_f32 v196, v196
    v_mfma_f32_16x16x32_bf16 v[4:7], v[96:99], a[72:75], v[4:7]
    v_exp_f32 v197, v197
    v_mfma_f32_16x16x32_bf16 v[4:7], v[100:103], a[76:79], v[4:7]
    v_exp_f32 v198, v198
    v_mfma_f32_16x16x32_bf16 v[8:11], v[100:103], a[80:83], v[8:11]
    v_exp_f32 v199, v199
    v_mfma_f32_16x16x32_bf16 v[8:11], v[96:99], a[84:87], v[8:11]
    v_cvt_pk_bf16_f32 v107, v198, v199
    v_mfma_f32_16x16x32_bf16 v[12:15], v[96:99], a[88:91], v[12:15]
    v_exp_f32 v200, v200
    v_mfma_f32_16x16x32_bf16 v[12:15], v[100:103], a[92:95], v[12:15]
    s_waitcnt lgkmcnt(8)
    v_exp_f32 v201, v201
    v_mfma_f32_16x16x32_bf16 v[16:19], v[100:103], a[96:99], v[16:19]
    v_add_u32 v248, s35, v248
    v_cvt_pk_bf16_f32 v106, v196, v197
    v_mfma_f32_16x16x32_bf16 v[16:19], v[96:99], a[100:103], v[16:19]
    v_exp_f32 v202, v202
    v_mfma_f32_16x16x32_bf16 v[20:23], v[96:99], a[104:107], v[20:23]
    v_exp_f32 v203, v203
    v_mfma_f32_16x16x32_bf16 v[20:23], v[100:103], a[108:111], v[20:23]
    s_waitcnt lgkmcnt(0)
    v_cvt_pk_bf16_f32 v108, v200, v201
    v_cvt_pk_bf16_f32 v109, v202, v203
    v_mfma_f32_16x16x32_bf16 v[24:27], v[100:103], a[112:115], v[24:27]
    v_exp_f32 v204, v204
    v_mfma_f32_16x16x32_bf16 v[24:27], v[96:99], a[116:119], v[24:27]
    v_exp_f32 v205, v205
    v_mfma_f32_16x16x32_bf16 v[28:31], v[96:99], a[120:123], v[28:31]
    v_exp_f32 v206, v206
    v_mfma_f32_16x16x32_bf16 v[28:31], v[100:103], a[124:127], v[28:31]
    s_waitcnt vmcnt(6)
    v_exp_f32 v207, v207
    v_smfmac_f32_16x16x64_bf16 v[240:243], a[132:135], v[96:103], v255
    s_barrier
    v_mfma_f32_16x16x32_bf16 v[192:195], a[0:3], v[160:163], v[232:235]
    buffer_load_dwordx4 v250, s[12:15], s23 offen offset:2176 lds
    v_mfma_f32_16x16x32_bf16 v[192:195], a[4:7], v[164:167], v[192:195]
    v_cvt_pk_bf16_f32 v110, v204, v205
    v_cvt_pk_bf16_f32 v111, v206, v207
    v_mfma_f32_16x16x32_bf16 v[192:195], a[8:11], v[168:171], v[192:195]
    ds_read_b128 a[0:3], v248 offset:0
    ds_read_b128 a[4:7], v248 offset:64
    v_mfma_f32_16x16x32_bf16 v[192:195], a[12:15], v[172:175], v[192:195]
    v_mfma_f32_16x16x32_bf16 v[196:199], a[16:19], v[172:175], v[232:235]
    v_mfma_f32_16x16x32_bf16 v[196:199], a[20:23], v[168:171], v[196:199]
    ds_read_b128 a[8:11], v248 offset:128
    ds_read_b128 a[12:15], v248 offset:192
    v_mfma_f32_16x16x32_bf16 v[196:199], a[24:27], v[164:167], v[196:199]
    v_exp_f32 v192, v192
    v_mfma_f32_16x16x32_bf16 v[196:199], a[28:31], v[160:163], v[196:199]
    v_exp_f32 v193, v193
    v_mfma_f32_16x16x32_bf16 v[200:203], a[32:35], v[160:163], v[232:235]
    v_exp_f32 v194, v194
    v_mfma_f32_16x16x32_bf16 v[200:203], a[36:39], v[164:167], v[200:203]
    ds_read_b128 a[16:19], v248 offset:704
    ds_read_b128 a[20:23], v248 offset:640
    v_mfma_f32_16x16x32_bf16 v[200:203], a[40:43], v[168:171], v[200:203]
    buffer_load_dwordx4 v252, s[12:15], s23 offen offset:3216 lds
    v_mfma_f32_16x16x32_bf16 v[200:203], a[44:47], v[172:175], v[200:203]
    s_mov_b64 s[22:23], s[44:45]
    v_exp_f32 v195, v195
    v_mfma_f32_16x16x32_bf16 v[204:207], a[48:51], v[172:175], v[232:235]
    s_mov_b32 s14, s46
    ds_read_b128 a[24:27], v248 offset:576
    ds_read_b128 a[28:31], v248 offset:512
    v_mfma_f32_16x16x32_bf16 v[204:207], a[52:55], v[168:171], v[204:207]
    s_mov_b32 s32, s31
    v_cvt_pk_bf16_f32 v116, v192, v193
    v_cvt_pk_bf16_f32 v117, v194, v195
    v_mfma_f32_16x16x32_bf16 v[204:207], a[56:59], v[164:167], v[204:207]
    s_mov_b32 m0, s31
    v_exp_f32 v196, v196
    v_mfma_f32_16x16x32_bf16 v[204:207], a[60:63], v[160:163], v[204:207]
    v_exp_f32 v197, v197
    v_mfma_f32_16x16x32_bf16 v[32:35], v[104:107], a[64:67], v[32:35]
    ds_read_b128 a[32:35], v248 offset:17536
    ds_read_b128 a[36:39], v248 offset:17600
    v_mfma_f32_16x16x32_bf16 v[32:35], v[108:111], a[68:71], v[32:35]
    v_exp_f32 v198, v198
    v_mfma_f32_16x16x32_bf16 v[36:39], v[108:111], a[72:75], v[36:39]
    buffer_load_dwordx4 v250, s[8:11], s22 offen offset:0 lds
    v_mfma_f32_16x16x32_bf16 v[36:39], v[104:107], a[76:79], v[36:39]
    ds_read_b128 a[40:43], v248 offset:17664
    ds_read_b128 a[44:47], v248 offset:17728
    v_mfma_f32_16x16x32_bf16 v[40:43], v[104:107], a[80:83], v[40:43]
    v_exp_f32 v199, v199
    v_mfma_f32_16x16x32_bf16 v[40:43], v[108:111], a[84:87], v[40:43]
    v_cvt_pk_bf16_f32 v118, v196, v197
    v_cvt_pk_bf16_f32 v119, v198, v199
    v_mfma_f32_16x16x32_bf16 v[44:47], v[108:111], a[88:91], v[44:47]
    v_exp_f32 v200, v200
    v_mfma_f32_16x16x32_bf16 v[44:47], v[104:107], a[92:95], v[44:47]
    ds_read_b128 a[48:51], v248 offset:18240
    ds_read_b128 a[52:55], v248 offset:18176
    v_mfma_f32_16x16x32_bf16 v[48:51], v[104:107], a[96:99], v[48:51]
    v_exp_f32 v201, v201
    v_mfma_f32_16x16x32_bf16 v[48:51], v[108:111], a[100:103], v[48:51]
    v_exp_f32 v202, v202
    v_mfma_f32_16x16x32_bf16 v[52:55], v[108:111], a[104:107], v[52:55]
    ds_read_b128 a[56:59], v248 offset:18112
    ds_read_b128 a[60:63], v248 offset:18048
    v_mfma_f32_16x16x32_bf16 v[52:55], v[104:107], a[108:111], v[52:55]
    v_exp_f32 v203, v203
    v_mfma_f32_16x16x32_bf16 v[56:59], v[104:107], a[112:115], v[56:59]
    buffer_load_dwordx4 v251, s[8:11], s22 offen offset:1152 lds
    v_mfma_f32_16x16x32_bf16 v[56:59], v[108:111], a[116:119], v[56:59]
    v_cvt_pk_bf16_f32 v112, v200, v201
    v_cvt_pk_bf16_f32 v113, v202, v203
    v_mfma_f32_16x16x32_bf16 v[60:63], v[108:111], a[120:123], v[60:63]
    v_exp_f32 v204, v204
    v_mfma_f32_16x16x32_bf16 v[60:63], v[104:107], a[124:127], v[60:63]
    v_exp_f32 v205, v205
    v_smfmac_f32_16x16x64_bf16 v[240:243], a[136:139], v[104:111], v255
    s_waitcnt lgkmcnt(12)
    v_cvt_pk_bf16_f32 v114, v204, v205
    v_mfma_f32_16x16x32_bf16 v[192:195], a[0:3], v[128:131], v[224:227]
    v_exp_f32 v206, v206
    v_mfma_f32_16x16x32_bf16 v[192:195], a[4:7], v[132:135], v[192:195]
    v_exp_f32 v207, v207
    v_mfma_f32_16x16x32_bf16 v[192:195], a[8:11], v[136:139], v[192:195]
    v_cvt_pk_bf16_f32 v115, v206, v207
    v_add_u32 v249, s35, v249
    v_mfma_f32_16x16x32_bf16 v[192:195], a[12:15], v[140:143], v[192:195]
    s_waitcnt lgkmcnt(9)
    buffer_load_dwordx4 v250, s[12:15], s22 offen offset:2176 lds
    v_mfma_f32_16x16x32_bf16 v[196:199], a[16:19], v[140:143], v[224:227]
    v_mfma_f32_16x16x32_bf16 v[196:199], a[20:23], v[136:139], v[196:199]
    s_cmp_eq_u32 s34, 0
    v_exp_f32 v192, v192
    v_mfma_f32_16x16x32_bf16 v[196:199], a[24:27], v[132:135], v[196:199]
    s_waitcnt lgkmcnt(4)
    v_exp_f32 v193, v193
    v_mfma_f32_16x16x32_bf16 v[196:199], a[28:31], v[128:131], v[196:199]
    s_cbranch_scc1 L_out_3
    v_exp_f32 v194, v194
    v_mfma_f32_16x16x32_bf16 v[200:203], a[32:35], v[128:131], v[224:227]
    v_exp_f32 v195, v195
    v_mfma_f32_16x16x32_bf16 v[200:203], a[36:39], v[132:135], v[200:203]
    buffer_load_dwordx4 v252, s[12:15], s22 offen offset:3216 lds
    v_mfma_f32_16x16x32_bf16 v[200:203], a[40:43], v[136:139], v[200:203]
    s_addk_i32 s32, 17536
    v_cvt_pk_bf16_f32 v100, v192, v193
    v_cvt_pk_bf16_f32 v101, v194, v195
    v_mfma_f32_16x16x32_bf16 v[200:203], a[44:47], v[140:143], v[200:203]
    s_waitcnt lgkmcnt(0)
    v_exp_f32 v196, v196
    v_mfma_f32_16x16x32_bf16 v[204:207], a[48:51], v[140:143], v[224:227]
    s_mov_b32 m0, s32
    v_exp_f32 v197, v197
    v_mfma_f32_16x16x32_bf16 v[204:207], a[52:55], v[136:139], v[204:207]
    s_mov_b32 s14, 0x13da880
    v_exp_f32 v198, v198
    v_mfma_f32_16x16x32_bf16 v[204:207], a[56:59], v[132:135], v[204:207]
    v_exp_f32 v199, v199
    v_mfma_f32_16x16x32_bf16 v[204:207], a[60:63], v[128:131], v[204:207]
    v_cvt_pk_bf16_f32 v102, v196, v197
    v_cvt_pk_bf16_f32 v103, v198, v199
    v_mfma_f32_16x16x32_bf16 v[64:67], v[116:119], a[64:67], v[64:67]
    ds_read_b64_tr_b16 a[64:65], v249 offset:2176
    ds_read_b64_tr_b16 a[66:67], v249 offset:2688
    v_mfma_f32_16x16x32_bf16 v[64:67], v[112:115], a[68:71], v[64:67]
    v_exp_f32 v200, v200
    v_mfma_f32_16x16x32_bf16 v[68:71], v[112:115], a[72:75], v[68:71]
    ds_read_b64_tr_b16 a[68:69], v249 offset:19712
    ds_read_b64_tr_b16 a[70:71], v249 offset:20224
    v_mfma_f32_16x16x32_bf16 v[68:71], v[116:119], a[76:79], v[68:71]
    buffer_load_dwordx4 v250, s[8:11], s23 offen offset:0 lds
    v_mfma_f32_16x16x32_bf16 v[72:75], v[116:119], a[80:83], v[72:75]
    ds_read_b64_tr_b16 a[72:73], v249 offset:19728
    ds_read_b64_tr_b16 a[74:75], v249 offset:20240
    v_mfma_f32_16x16x32_bf16 v[72:75], v[112:115], a[84:87], v[72:75]
    v_exp_f32 v201, v201
    v_mfma_f32_16x16x32_bf16 v[76:79], v[112:115], a[88:91], v[76:79]
    ds_read_b64_tr_b16 a[76:77], v249 offset:2192
    ds_read_b64_tr_b16 a[78:79], v249 offset:2704
    v_mfma_f32_16x16x32_bf16 v[76:79], v[116:119], a[92:95], v[76:79]
    v_exp_f32 v202, v202
    v_mfma_f32_16x16x32_bf16 v[80:83], v[116:119], a[96:99], v[80:83]
    ds_read_b64_tr_b16 a[80:81], v249 offset:2208
    ds_read_b64_tr_b16 a[82:83], v249 offset:2720
    v_mfma_f32_16x16x32_bf16 v[80:83], v[112:115], a[100:103], v[80:83]
    v_exp_f32 v203, v203
    v_mfma_f32_16x16x32_bf16 v[84:87], v[112:115], a[104:107], v[84:87]
    ds_read_b64_tr_b16 a[84:85], v249 offset:19744
    ds_read_b64_tr_b16 a[86:87], v249 offset:20256
    v_mfma_f32_16x16x32_bf16 v[84:87], v[116:119], a[108:111], v[84:87]
    v_cvt_pk_bf16_f32 v96, v200, v201
    v_cvt_pk_bf16_f32 v97, v202, v203
    v_mfma_f32_16x16x32_bf16 v[88:91], v[116:119], a[112:115], v[88:91]
    s_sub_u32 s34, s34, 1
    ds_read_b64_tr_b16 a[88:89], v249 offset:19760
    ds_read_b64_tr_b16 a[90:91], v249 offset:20272
    v_mfma_f32_16x16x32_bf16 v[88:91], v[112:115], a[116:119], v[88:91]
    s_cmp_lg_u32 s34, s3
    buffer_load_dwordx4 v251, s[8:11], s23 offen offset:1152 lds
    v_mfma_f32_16x16x32_bf16 v[92:95], v[112:115], a[120:123], v[92:95]
    ds_read_b64_tr_b16 a[92:93], v249 offset:2224
    ds_read_b64_tr_b16 a[94:95], v249 offset:2736
    v_mfma_f32_16x16x32_bf16 v[92:95], v[116:119], a[124:127], v[92:95]
    v_exp_f32 v204, v204
    v_smfmac_f32_16x16x64_bf16 v[244:247], a[132:135], v[112:119], v255
    s_cbranch_scc1 L_loop_3
    s_branch L_lq_3
.p2align 3
L_out_3:
    s_cmp_eq_u32 s39, 0
    s_cbranch_scc1 L_laste_3
    s_branch L_lastm_3
.p2align 5
L_lq_3:
    v_mfma_f32_16x16x32_bf16 v[192:195], a[0:3], v[144:147], v[228:231]
    s_add_u32 s31, s30, s33
    ds_read_b64_tr_b16 a[96:97], v249 offset:2240
    ds_read_b64_tr_b16 a[98:99], v249 offset:2752
    v_mfma_f32_16x16x32_bf16 v[192:195], a[4:7], v[148:151], v[192:195]
    s_add_u32 s30, s30, s80
    v_exp_f32 v205, v205
    v_mfma_f32_16x16x32_bf16 v[192:195], a[8:11], v[152:155], v[192:195]
    s_cmp_eq_u32 s30, 105216
    ds_read_b64_tr_b16 a[100:101], v249 offset:19776
    ds_read_b64_tr_b16 a[102:103], v249 offset:20288
    v_mfma_f32_16x16x32_bf16 v[192:195], a[12:15], v[156:159], v[192:195]
    s_cmov_b32 s30, 0
    v_exp_f32 v206, v206
    v_mfma_f32_16x16x32_bf16 v[196:199], a[16:19], v[156:159], v[228:231]
    s_cselect_b32 s35, s81, s80
    ds_read_b64_tr_b16 a[104:105], v249 offset:19792
    ds_read_b64_tr_b16 a[106:107], v249 offset:20304
    v_mfma_f32_16x16x32_bf16 v[196:199], a[20:23], v[152:155], v[196:199]
    s_mov_b32 s44, s24
    v_exp_f32 v207, v207
    v_mfma_f32_16x16x32_bf16 v[196:199], a[24:27], v[148:151], v[196:199]
    s_add_u32 s45, s24, s25
    ds_read_b64_tr_b16 a[108:109], v249 offset:2256
    ds_read_b64_tr_b16 a[110:111], v249 offset:2768
    v_mfma_f32_16x16x32_bf16 v[196:199], a[28:31], v[144:147], v[196:199]
    s_add_u32 s24, s45, s25
    v_cvt_pk_bf16_f32 v98, v204, v205
    v_cvt_pk_bf16_f32 v99, v206, v207
    v_mfma_f32_16x16x32_bf16 v[200:203], a[32:35], v[144:147], v[228:231]
    s_cmp_eq_u32 s34, 2
    ds_read_b64_tr_b16 a[112:113], v249 offset:2272
    ds_read_b64_tr_b16 a[114:115], v249 offset:2784
    v_mfma_f32_16x16x32_bf16 v[200:203], a[36:39], v[148:151], v[200:203]
    s_cmov_b32 s45, 2.0
    v_exp_f32 v192, v192
    v_mfma_f32_16x16x32_bf16 v[200:203], a[40:43], v[152:155], v[200:203]
    s_cmp_eq_u32 s34, 1
    ds_read_b64_tr_b16 a[116:117], v249 offset:19808
    ds_read_b64_tr_b16 a[118:119], v249 offset:20320
    v_mfma_f32_16x16x32_bf16 v[200:203], a[44:47], v[156:159], v[200:203]
    s_cmov_b64 s[44:45], s[26:27]
    v_exp_f32 v193, v193
    v_mfma_f32_16x16x32_bf16 v[204:207], a[48:51], v[156:159], v[228:231]
    s_cmov_b64 s[24:25], s[28:29]
    ds_read_b64_tr_b16 a[120:121], v249 offset:19824
    ds_read_b64_tr_b16 a[122:123], v249 offset:20336
    v_mfma_f32_16x16x32_bf16 v[204:207], a[52:55], v[152:155], v[204:207]
    s_cselect_b32 s46, s78, 0x13da880
    v_exp_f32 v194, v194
    v_mfma_f32_16x16x32_bf16 v[204:207], a[56:59], v[148:151], v[204:207]
    ds_read_b64_tr_b16 a[124:125], v249 offset:2288
    ds_read_b64_tr_b16 a[126:127], v249 offset:2800
    v_mfma_f32_16x16x32_bf16 v[204:207], a[60:63], v[144:147], v[204:207]
    s_waitcnt lgkmcnt(15)
    v_exp_f32 v195, v195
    v_mfma_f32_16x16x32_bf16 v[0:3], v[100:103], a[64:67], v[0:3]
    v_cvt_pk_bf16_f32 v104, v192, v193
    v_cvt_pk_bf16_f32 v105, v194, v195
    v_mfma_f32_16x16x32_bf16 v[0:3], v[96:99], a[68:71], v[0:3]
    v_exp_f32 v196, v196
    v_mfma_f32_16x16x32_bf16 v[4:7], v[96:99], a[72:75], v[4:7]
    v_exp_f32 v197, v197
    v_mfma_f32_16x16x32_bf16 v[4:7], v[100:103], a[76:79], v[4:7]
    v_exp_f32 v198, v198
    v_mfma_f32_16x16x32_bf16 v[8:11], v[100:103], a[80:83], v[8:11]
    v_exp_f32 v199, v199
    v_mfma_f32_16x16x32_bf16 v[8:11], v[96:99], a[84:87], v[8:11]
    v_cvt_pk_bf16_f32 v107, v198, v199
    v_mfma_f32_16x16x32_bf16 v[12:15], v[96:99], a[88:91], v[12:15]
    v_exp_f32 v200, v200
    v_mfma_f32_16x16x32_bf16 v[12:15], v[100:103], a[92:95], v[12:15]
    s_waitcnt lgkmcnt(8)
    v_exp_f32 v201, v201
    v_mfma_f32_16x16x32_bf16 v[16:19], v[100:103], a[96:99], v[16:19]
    v_add_u32 v248, s35, v248
    v_cvt_pk_bf16_f32 v106, v196, v197
    v_mfma_f32_16x16x32_bf16 v[16:19], v[96:99], a[100:103], v[16:19]
    v_exp_f32 v202, v202
    v_mfma_f32_16x16x32_bf16 v[20:23], v[96:99], a[104:107], v[20:23]
    v_exp_f32 v203, v203
    v_mfma_f32_16x16x32_bf16 v[20:23], v[100:103], a[108:111], v[20:23]
    s_waitcnt lgkmcnt(0)
    v_cvt_pk_bf16_f32 v108, v200, v201
    v_cvt_pk_bf16_f32 v109, v202, v203
    v_mfma_f32_16x16x32_bf16 v[24:27], v[100:103], a[112:115], v[24:27]
    v_exp_f32 v204, v204
    v_mfma_f32_16x16x32_bf16 v[24:27], v[96:99], a[116:119], v[24:27]
    v_exp_f32 v205, v205
    v_mfma_f32_16x16x32_bf16 v[28:31], v[96:99], a[120:123], v[28:31]
    v_exp_f32 v206, v206
    v_mfma_f32_16x16x32_bf16 v[28:31], v[100:103], a[124:127], v[28:31]
    s_waitcnt vmcnt(6)
    v_exp_f32 v207, v207
    v_smfmac_f32_16x16x64_bf16 v[240:243], a[132:135], v[96:103], v255
    s_barrier
    v_mfma_f32_16x16x32_bf16 v[192:195], a[0:3], v[160:163], v[232:235]
    buffer_load_dwordx4 v250, s[12:15], s23 offen offset:2176 lds
    v_mfma_f32_16x16x32_bf16 v[192:195], a[4:7], v[164:167], v[192:195]
    s_mov_b32 m0, s51
    v_cvt_pk_bf16_f32 v110, v204, v205
    v_cvt_pk_bf16_f32 v111, v206, v207
    v_mfma_f32_16x16x32_bf16 v[192:195], a[8:11], v[168:171], v[192:195]
    ds_read_b128 a[0:3], v248 offset:0
    ds_read_b128 a[4:7], v248 offset:64
    v_mfma_f32_16x16x32_bf16 v[192:195], a[12:15], v[172:175], v[192:195]
    buffer_load_dwordx4 v253, s[4:7], s52 offen offset:0 nt lds
    v_mfma_f32_16x16x32_bf16 v[196:199], a[16:19], v[172:175], v[232:235]
    s_addk_i32 s52, 15296
    v_mfma_f32_16x16x32_bf16 v[196:199], a[20:23], v[168:171], v[196:199]
    ds_read_b128 a[8:11], v248 offset:128
    ds_read_b128 a[12:15], v248 offset:192
    v_mfma_f32_16x16x32_bf16 v[196:199], a[24:27], v[164:167], v[196:199]
    buffer_load_dwordx4 v253, s[4:7], s52 offen offset:1088 nt lds
    v_mfma_f32_16x16x32_bf16 v[196:199], a[28:31], v[160:163], v[196:199]
    s_mov_b32 m0, s32
    v_exp_f32 v192, v192
    v_mfma_f32_16x16x32_bf16 v[200:203], a[32:35], v[160:163], v[232:235]
    s_addk_i32 s52, 17472
    v_exp_f32 v193, v193
    v_mfma_f32_16x16x32_bf16 v[200:203], a[36:39], v[164:167], v[200:203]
    s_addk_i32 s51, 2176
    ds_read_b128 a[16:19], v248 offset:704
    ds_read_b128 a[20:23], v248 offset:640
    v_mfma_f32_16x16x32_bf16 v[200:203], a[40:43], v[168:171], v[200:203]
    buffer_load_dwordx4 v252, s[12:15], s23 offen offset:3216 lds
    v_mfma_f32_16x16x32_bf16 v[200:203], a[44:47], v[172:175], v[200:203]
    s_mov_b64 s[22:23], s[44:45]
    v_exp_f32 v194, v194
    v_mfma_f32_16x16x32_bf16 v[204:207], a[48:51], v[172:175], v[232:235]
    s_mov_b32 s14, s46
    ds_read_b128 a[24:27], v248 offset:576
    ds_read_b128 a[28:31], v248 offset:512
    v_mfma_f32_16x16x32_bf16 v[204:207], a[52:55], v[168:171], v[204:207]
    s_mov_b32 s32, s31
    v_exp_f32 v195, v195
    v_mfma_f32_16x16x32_bf16 v[204:207], a[56:59], v[164:167], v[204:207]
    s_mov_b32 m0, s31
    v_cvt_pk_bf16_f32 v116, v192, v193
    v_cvt_pk_bf16_f32 v117, v194, v195
    v_mfma_f32_16x16x32_bf16 v[204:207], a[60:63], v[160:163], v[204:207]
    v_exp_f32 v196, v196
    v_mfma_f32_16x16x32_bf16 v[32:35], v[104:107], a[64:67], v[32:35]
    ds_read_b128 a[32:35], v248 offset:17536
    ds_read_b128 a[36:39], v248 offset:17600
    v_mfma_f32_16x16x32_bf16 v[32:35], v[108:111], a[68:71], v[32:35]
    v_exp_f32 v197, v197
    v_mfma_f32_16x16x32_bf16 v[36:39], v[108:111], a[72:75], v[36:39]
    buffer_load_dwordx4 v250, s[8:11], s22 offen offset:0 lds
    v_mfma_f32_16x16x32_bf16 v[36:39], v[104:107], a[76:79], v[36:39]
    ds_read_b128 a[40:43], v248 offset:17664
    ds_read_b128 a[44:47], v248 offset:17728
    v_mfma_f32_16x16x32_bf16 v[40:43], v[104:107], a[80:83], v[40:43]
    v_exp_f32 v198, v198
    v_mfma_f32_16x16x32_bf16 v[40:43], v[108:111], a[84:87], v[40:43]
    v_exp_f32 v199, v199
    v_mfma_f32_16x16x32_bf16 v[44:47], v[108:111], a[88:91], v[44:47]
    v_cvt_pk_bf16_f32 v118, v196, v197
    v_cvt_pk_bf16_f32 v119, v198, v199
    v_mfma_f32_16x16x32_bf16 v[44:47], v[104:107], a[92:95], v[44:47]
    ds_read_b128 a[48:51], v248 offset:18240
    ds_read_b128 a[52:55], v248 offset:18176
    v_mfma_f32_16x16x32_bf16 v[48:51], v[104:107], a[96:99], v[48:51]
    v_exp_f32 v200, v200
    v_mfma_f32_16x16x32_bf16 v[48:51], v[108:111], a[100:103], v[48:51]
    v_exp_f32 v201, v201
    v_mfma_f32_16x16x32_bf16 v[52:55], v[108:111], a[104:107], v[52:55]
    ds_read_b128 a[56:59], v248 offset:18112
    ds_read_b128 a[60:63], v248 offset:18048
    v_mfma_f32_16x16x32_bf16 v[52:55], v[104:107], a[108:111], v[52:55]
    v_exp_f32 v202, v202
    v_mfma_f32_16x16x32_bf16 v[56:59], v[104:107], a[112:115], v[56:59]
    buffer_load_dwordx4 v251, s[8:11], s22 offen offset:1152 lds
    v_mfma_f32_16x16x32_bf16 v[56:59], v[108:111], a[116:119], v[56:59]
    v_exp_f32 v203, v203
    v_mfma_f32_16x16x32_bf16 v[60:63], v[108:111], a[120:123], v[60:63]
    v_cvt_pk_bf16_f32 v113, v202, v203
    v_add_u32 v249, s35, v249
    v_mfma_f32_16x16x32_bf16 v[60:63], v[104:107], a[124:127], v[60:63]
    v_exp_f32 v204, v204
    v_smfmac_f32_16x16x64_bf16 v[240:243], a[136:139], v[104:111], v255
    s_waitcnt lgkmcnt(12)
    v_cvt_pk_bf16_f32 v112, v200, v201
    v_mfma_f32_16x16x32_bf16 v[192:195], a[0:3], v[128:131], v[224:227]
    v_exp_f32 v205, v205
    v_mfma_f32_16x16x32_bf16 v[192:195], a[4:7], v[132:135], v[192:195]
    v_exp_f32 v206, v206
    v_mfma_f32_16x16x32_bf16 v[192:195], a[8:11], v[136:139], v[192:195]
    v_exp_f32 v207, v207
    v_mfma_f32_16x16x32_bf16 v[192:195], a[12:15], v[140:143], v[192:195]
    s_waitcnt lgkmcnt(9)
    buffer_load_dwordx4 v250, s[12:15], s22 offen offset:2176 lds
    v_mfma_f32_16x16x32_bf16 v[196:199], a[16:19], v[140:143], v[224:227]
    v_cvt_pk_bf16_f32 v114, v204, v205
    v_cvt_pk_bf16_f32 v115, v206, v207
    v_mfma_f32_16x16x32_bf16 v[196:199], a[20:23], v[136:139], v[196:199]
    v_exp_f32 v192, v192
    v_mfma_f32_16x16x32_bf16 v[196:199], a[24:27], v[132:135], v[196:199]
    s_waitcnt lgkmcnt(4)
    v_exp_f32 v193, v193
    v_mfma_f32_16x16x32_bf16 v[196:199], a[28:31], v[128:131], v[196:199]
    v_exp_f32 v194, v194
    v_mfma_f32_16x16x32_bf16 v[200:203], a[32:35], v[128:131], v[224:227]
    v_exp_f32 v195, v195
    v_mfma_f32_16x16x32_bf16 v[200:203], a[36:39], v[132:135], v[200:203]
    buffer_load_dwordx4 v252, s[12:15], s22 offen offset:3216 lds
    v_mfma_f32_16x16x32_bf16 v[200:203], a[40:43], v[136:139], v[200:203]
    s_addk_i32 s32, 17536
    v_cvt_pk_bf16_f32 v100, v192, v193
    v_cvt_pk_bf16_f32 v101, v194, v195
    v_mfma_f32_16x16x32_bf16 v[200:203], a[44:47], v[140:143], v[200:203]
    s_waitcnt lgkmcnt(0)
    v_exp_f32 v196, v196
    v_mfma_f32_16x16x32_bf16 v[204:207], a[48:51], v[140:143], v[224:227]
    s_mov_b32 m0, s32
    v_exp_f32 v197, v197
    v_mfma_f32_16x16x32_bf16 v[204:207], a[52:55], v[136:139], v[204:207]
    s_mov_b32 s14, 0x13da880
    v_exp_f32 v198, v198
    v_mfma_f32_16x16x32_bf16 v[204:207], a[56:59], v[132:135], v[204:207]
    v_exp_f32 v199, v199
    v_mfma_f32_16x16x32_bf16 v[204:207], a[60:63], v[128:131], v[204:207]
    v_cvt_pk_bf16_f32 v102, v196, v197
    v_cvt_pk_bf16_f32 v103, v198, v199
    v_mfma_f32_16x16x32_bf16 v[64:67], v[116:119], a[64:67], v[64:67]
    ds_read_b64_tr_b16 a[64:65], v249 offset:2176
    ds_read_b64_tr_b16 a[66:67], v249 offset:2688
    v_mfma_f32_16x16x32_bf16 v[64:67], v[112:115], a[68:71], v[64:67]
    v_exp_f32 v200, v200
    v_mfma_f32_16x16x32_bf16 v[68:71], v[112:115], a[72:75], v[68:71]
    ds_read_b64_tr_b16 a[68:69], v249 offset:19712
    ds_read_b64_tr_b16 a[70:71], v249 offset:20224
    v_mfma_f32_16x16x32_bf16 v[68:71], v[116:119], a[76:79], v[68:71]
    buffer_load_dwordx4 v250, s[8:11], s23 offen offset:0 lds
    v_mfma_f32_16x16x32_bf16 v[72:75], v[116:119], a[80:83], v[72:75]
    ds_read_b64_tr_b16 a[72:73], v249 offset:19728
    ds_read_b64_tr_b16 a[74:75], v249 offset:20240
    v_mfma_f32_16x16x32_bf16 v[72:75], v[112:115], a[84:87], v[72:75]
    v_exp_f32 v201, v201
    v_mfma_f32_16x16x32_bf16 v[76:79], v[112:115], a[88:91], v[76:79]
    ds_read_b64_tr_b16 a[76:77], v249 offset:2192
    ds_read_b64_tr_b16 a[78:79], v249 offset:2704
    v_mfma_f32_16x16x32_bf16 v[76:79], v[116:119], a[92:95], v[76:79]
    v_exp_f32 v202, v202
    v_mfma_f32_16x16x32_bf16 v[80:83], v[116:119], a[96:99], v[80:83]
    ds_read_b64_tr_b16 a[80:81], v249 offset:2208
    ds_read_b64_tr_b16 a[82:83], v249 offset:2720
    v_mfma_f32_16x16x32_bf16 v[80:83], v[112:115], a[100:103], v[80:83]
    v_exp_f32 v203, v203
    v_mfma_f32_16x16x32_bf16 v[84:87], v[112:115], a[104:107], v[84:87]
    ds_read_b64_tr_b16 a[84:85], v249 offset:19744
    ds_read_b64_tr_b16 a[86:87], v249 offset:20256
    v_mfma_f32_16x16x32_bf16 v[84:87], v[116:119], a[108:111], v[84:87]
    v_cvt_pk_bf16_f32 v96, v200, v201
    v_cvt_pk_bf16_f32 v97, v202, v203
    v_mfma_f32_16x16x32_bf16 v[88:91], v[116:119], a[112:115], v[88:91]
    s_sub_u32 s34, s34, 1
    ds_read_b64_tr_b16 a[88:89], v249 offset:19760
    ds_read_b64_tr_b16 a[90:91], v249 offset:20272
    v_mfma_f32_16x16x32_bf16 v[88:91], v[112:115], a[116:119], v[88:91]
    s_cmp_lg_u32 s34, s53
    buffer_load_dwordx4 v251, s[8:11], s23 offen offset:1152 lds
    v_mfma_f32_16x16x32_bf16 v[92:95], v[112:115], a[120:123], v[92:95]
    s_mov_b32 s3, -1
    ds_read_b64_tr_b16 a[92:93], v249 offset:2224
    ds_read_b64_tr_b16 a[94:95], v249 offset:2736
    v_mfma_f32_16x16x32_bf16 v[92:95], v[116:119], a[124:127], v[92:95]
    v_exp_f32 v204, v204
    v_smfmac_f32_16x16x64_bf16 v[244:247], a[132:135], v[112:119], v255
    s_cbranch_scc1 L_lq_3
    s_branch L_loop_3
.p2align 12
.p2align 5
P_first1p_4c:
    s_setpc_b64 s[62:63]
.fill 1, 4, 0xbf800000
L_first1p_4c:
    s_waitcnt vmcnt(8)
    v_exp_f32_e64 v198, v198
    s_barrier
    v_mfma_f32_16x16x32_bf16 v[64:67], v[212:215], a[64:67], 0
    s_add_u32 m0, s33, 87680
    ds_read_b128 a[0:3], v248 offset:0
    v_cvt_pk_bf16_f32 v218, v196, v197
    v_mfma_f32_16x16x32_bf16 v[64:67], v[208:211], a[68:71], v[64:67]
    s_cmp_eq_u32 s56, 0
    ds_read_b128 a[4:7], v248 offset:64
    buffer_load_dwordx4 v250, s[8:11], s23 offen offset:0 lds
    s_cmov_b32 s3, -1
    s_cmov_b32 s39, 0
    v_mfma_f32_16x16x32_bf16 v[68:71], v[208:211], a[72:75], 0
    s_cmov_b32 s26, 2.0
    ds_read_b128 a[8:11], v248 offset:128
    v_exp_f32_e64 v199, v199
    v_mfma_f32_16x16x32_bf16 v[68:71], v[212:215], a[76:79], v[68:71]
    s_cmov_b32 s27, 2.0
    ds_read_b128 a[12:15], v248 offset:192
    buffer_load_dwordx4 v251, s[8:11], s23 offen offset:1152 lds
    s_cmov_b32 s28, 2.0
    v_mfma_f32_16x16x32_bf16 v[72:75], v[212:215], a[80:83], 0
    ds_read_b128 a[16:19], v248 offset:704
    v_exp_f32_e64 v200, v200
    v_mfma_f32_16x16x32_bf16 v[72:75], v[208:211], a[84:87], v[72:75]
    ds_read_b128 a[20:23], v248 offset:640
    buffer_load_dwordx4 v250, s[12:15], s23 offen offset:2176 lds
    v_mfma_f32_16x16x32_bf16 v[76:79], v[208:211], a[88:91], 0
    ds_read_b128 a[24:27], v248 offset:576
    v_cvt_pk_bf16_f32 v219, v198, v199
    v_mfma_f32_16x16x32_bf16 v[76:79], v[212:215], a[92:95], v[76:79]
    ds_read_b128 a[28:31], v248 offset:512
    buffer_load_dwordx4 v252, s[12:15], s23 offen offset:3216 lds
    v_mfma_f32_16x16x32_bf16 v[80:83], v[212:215], a[96:99], 0
    ds_read_b128 a[32:35], v248 offset:17536
    v_exp_f32 v201, v201
    v_mfma_f32_16x16x32_bf16 v[80:83], v[208:211], a[100:103], v[80:83]
    ds_read_b128 a[36:39], v248 offset:17600
    v_exp_f32 v202, v202
    v_mfma_f32_16x16x32_bf16 v[84:87], v[208:211], a[104:107], 0
    ds_read_b128 a[40:43], v248 offset:17664
    v_cvt_pk_bf16_f32 v220, v200, v201
    v_mfma_f32_16x16x32_bf16 v[84:87], v[212:215], a[108:111], v[84:87]
    ds_read_b128 a[44:47], v248 offset:17728
    v_exp_f32 v203, v203
    v_mfma_f32_16x16x32_bf16 v[88:91], v[212:215], a[112:115], 0
    ds_read_b128 a[48:51], v248 offset:18240
    v_exp_f32 v204, v204
    v_mfma_f32_16x16x32_bf16 v[88:91], v[208:211], a[116:119], v[88:91]
    ds_read_b128 a[52:55], v248 offset:18176
    v_cvt_pk_bf16_f32 v221, v202, v203
    v_mfma_f32_16x16x32_bf16 v[92:95], v[208:211], a[120:123], 0
    ds_read_b128 a[56:59], v248 offset:18112
    v_exp_f32 v205, v205
    v_mfma_f32_16x16x32_bf16 v[92:95], v[212:215], a[124:127], v[92:95]
    ds_read_b128 a[60:63], v248 offset:18048
    v_exp_f32 v206, v206
    v_smfmac_f32_16x16x64_bf16 v[244:247], a[140:143], v[208:215], v255
    s_waitcnt lgkmcnt(12)
    v_cvt_pk_bf16_f32 v222, v204, v205
    v_mfma_f32_16x16x32_bf16 v[192:195], a[0:3], v[128:131], v[224:227]
    s_mov_b32 s22, s24
    s_add_u32 s23, s24, s25
    v_mfma_f32_16x16x32_bf16 v[192:195], a[4:7], v[132:135], v[192:195]
    s_add_u32 s24, s23, s25
    s_mov_b32 s32, s31
    v_add_u32 v249, s35, v249
    v_mfma_f32_16x16x32_bf16 v[192:195], a[8:11], v[136:139], v[192:195]
    s_mov_b32 m0, s31
    v_exp_f32_e64 v207, v207
    v_mfma_f32_16x16x32_bf16 v[192:195], a[12:15], v[140:143], v[192:195]
    s_waitcnt lgkmcnt(8)
    buffer_load_dwordx4 v250, s[8:11], s22 offen offset:0 lds
    v_mfma_f32_16x16x32_bf16 v[196:199], a[16:19], v[140:143], v[224:227]
    v_cvt_pk_bf16_f32 v223, v206, v207
    v_mfma_f32_16x16x32_bf16 v[196:199], a[20:23], v[136:139], v[196:199]
    buffer_load_dwordx4 v251, s[8:11], s22 offen offset:1152 lds
    v_mfma_f32_16x16x32_bf16 v[196:199], a[24:27], v[132:135], v[196:199]
    v_exp_f32 v192, v192
    v_mfma_f32_16x16x32_bf16 v[196:199], a[28:31], v[128:131], v[196:199]
    s_waitcnt lgkmcnt(4)
    buffer_load_dwordx4 v250, s[12:15], s22 offen offset:2176 lds
    v_mfma_f32_16x16x32_bf16 v[200:203], a[32:35], v[128:131], v[224:227]
    v_exp_f32_e64 v193, v193
    v_mfma_f32_16x16x32_bf16 v[200:203], a[36:39], v[132:135], v[200:203]
    buffer_load_dwordx4 v252, s[12:15], s22 offen offset:3216 lds
    v_mfma_f32_16x16x32_bf16 v[200:203], a[40:43], v[136:139], v[200:203]
    s_addk_i32 s32, 17536
    v_exp_f32 v194, v194
    s_mov_b32 m0, s32
    v_mfma_f32_16x16x32_bf16 v[200:203], a[44:47], v[140:143], v[200:203]
    s_waitcnt lgkmcnt(0)
    s_mov_b32 s14, 0x13da880
    v_mfma_f32_16x16x32_bf16 v[204:207], a[48:51], v[140:143], v[224:227]
    buffer_load_dwordx4 v250, s[8:11], s23 offen offset:0 lds
    v_mfma_f32_16x16x32_bf16 v[204:207], a[52:55], v[136:139], v[204:207]
    v_exp_f32_e64 v195, v195
    v_mfma_f32_16x16x32_bf16 v[204:207], a[56:59], v[132:135], v[204:207]
    v_cvt_pk_bf16_f32 v212, v192, v193
    v_cvt_pk_bf16_f32 v213, v194, v195
    v_mfma_f32_16x16x32_bf16 v[204:207], a[60:63], v[128:131], v[204:207]
    v_exp_f32 v196, v196
    v_mfma_f32_16x16x32_bf16 v[96:99], v[216:219], a[64:67], 0
    v_exp_f32 v197, v197
    v_mfma_f32_16x16x32_bf16 v[96:99], v[220:223], a[68:71], v[96:99]
    v_exp_f32 v198, v198
    v_mfma_f32_16x16x32_bf16 v[100:103], v[220:223], a[72:75], 0
    v_exp_f32 v199, v199
    v_mfma_f32_16x16x32_bf16 v[100:103], v[216:219], a[76:79], v[100:103]
    v_cvt_pk_bf16_f32 v214, v196, v197
    v_cvt_pk_bf16_f32 v215, v198, v199
    v_mfma_f32_16x16x32_bf16 v[104:107], v[216:219], a[80:83], 0
    v_exp_f32 v200, v200
    v_mfma_f32_16x16x32_bf16 v[104:107], v[220:223], a[84:87], v[104:107]
    v_exp_f32 v201, v201
    v_mfma_f32_16x16x32_bf16 v[108:111], v[220:223], a[88:91], 0
    v_exp_f32 v202, v202
    v_mfma_f32_16x16x32_bf16 v[108:111], v[216:219], a[92:95], v[108:111]
    v_exp_f32 v203, v203
    v_mfma_f32_16x16x32_bf16 v[112:115], v[216:219], a[96:99], 0
    v_cvt_pk_bf16_f32 v208, v200, v201
    v_cvt_pk_bf16_f32 v209, v202, v203
    v_mfma_f32_16x16x32_bf16 v[112:115], v[220:223], a[100:103], v[112:115]
    v_exp_f32_e64 v204, v204
    v_mfma_f32_16x16x32_bf16 v[116:119], v[220:223], a[104:107], 0
    v_exp_f32_e64 v205, v205
    v_mfma_f32_16x16x32_bf16 v[116:119], v[216:219], a[108:111], v[116:119]
    s_waitcnt vmcnt(13)
    s_barrier
    v_mfma_f32_16x16x32_bf16 v[120:123], v[216:219], a[112:115], 0
    ds_read_b64_tr_b16 a[64:65], v249 offset:2176
    ds_read_b64_tr_b16 a[66:67], v249 offset:2688
    ds_read_b64_tr_b16 a[68:69], v249 offset:19712
    ds_read_b64_tr_b16 a[70:71], v249 offset:20224
    v_mfma_f32_16x16x32_bf16 v[120:123], v[220:223], a[116:119], v[120:123]
    s_mov_b32 s51, s50
    ds_read_b64_tr_b16 a[72:73], v249 offset:19728
    ds_read_b64_tr_b16 a[74:75], v249 offset:20240
    ds_read_b64_tr_b16 a[76:77], v249 offset:2192
    ds_read_b64_tr_b16 a[78:79], v249 offset:2704
    v_mfma_f32_16x16x32_bf16 v[124:127], v[220:223], a[120:123], 0
    s_mov_b32 s52, s37
    ds_read_b64_tr_b16 a[80:81], v249 offset:2208
    ds_read_b64_tr_b16 a[82:83], v249 offset:2720
    ds_read_b64_tr_b16 a[84:85], v249 offset:19744
    ds_read_b64_tr_b16 a[86:87], v249 offset:20256
    v_mfma_f32_16x16x32_bf16 v[124:127], v[216:219], a[124:127], v[124:127]
    s_mov_b32 s6, s38
    ds_read_b64_tr_b16 a[88:89], v249 offset:19760
    ds_read_b64_tr_b16 a[90:91], v249 offset:20272
    ds_read_b64_tr_b16 a[92:93], v249 offset:2224
    ds_read_b64_tr_b16 a[94:95], v249 offset:2736
    v_smfmac_f32_16x16x64_bf16 v[244:247], a[144:147], v[216:223], v255
    s_branch L_loop_4
.p2align 5
P_loop_4:
    s_setpc_b64 s[62:63]
.fill 7, 4, 0xbf800000
L_loop_4:
    v_mfma_f32_16x16x32_bf16 v[192:195], a[0:3], v[144:147], v[228:231]
    s_add_u32 s31, s30, s33
    ds_read_b64_tr_b16 a[96:97], v249 offset:2240
    ds_read_b64_tr_b16 a[98:99], v249 offset:2752
    v_mfma_f32_16x16x32_bf16 v[192:195], a[4:7], v[148:151], v[192:195]
    s_add_u32 s30, s30, s80
    v_exp_f32 v206, v206
    v_mfma_f32_16x16x32_bf16 v[192:195], a[8:11], v[152:155], v[192:195]
    s_cmp_eq_u32 s30, 105216
    ds_read_b64_tr_b16 a[100:101], v249 offset:19776
    ds_read_b64_tr_b16 a[102:103], v249 offset:20288
    v_mfma_f32_16x16x32_bf16 v[192:195], a[12:15], v[156:159], v[192:195]
    s_cmov_b32 s30, 0
    v_exp_f32 v207, v207
    v_mfma_f32_16x16x32_bf16 v[196:199], a[16:19], v[156:159], v[228:231]
    s_cselect_b32 s35, s81, s80
    ds_read_b64_tr_b16 a[104:105], v249 offset:19792
    ds_read_b64_tr_b16 a[106:107], v249 offset:20304
    v_mfma_f32_16x16x32_bf16 v[196:199], a[20:23], v[152:155], v[196:199]
    s_mov_b32 s44, s24
    v_cvt_pk_bf16_f32 v210, v204, v205
    v_cvt_pk_bf16_f32 v211, v206, v207
    v_mfma_f32_16x16x32_bf16 v[196:199], a[24:27], v[148:151], v[196:199]
    s_add_u32 s45, s24, s25
    ds_read_b64_tr_b16 a[108:109], v249 offset:2256
    ds_read_b64_tr_b16 a[110:111], v249 offset:2768
    v_mfma_f32_16x16x32_bf16 v[196:199], a[28:31], v[144:147], v[196:199]
    s_add_u32 s24, s45, s25
    v_exp_f32 v192, v192
    v_mfma_f32_16x16x32_bf16 v[200:203], a[32:35], v[144:147], v[228:231]
    s_cmp_eq_u32 s34, 2
    ds_read_b64_tr_b16 a[112:113], v249 offset:2272
    ds_read_b64_tr_b16 a[114:115], v249 offset:2784
    v_mfma_f32_16x16x32_bf16 v[200:203], a[36:39], v[148:151], v[200:203]
    s_cmov_b32 s45, 2.0
    v_exp_f32 v193, v193
    v_mfma_f32_16x16x32_bf16 v[200:203], a[40:43], v[152:155], v[200:203]
    s_cmp_eq_u32 s34, 1
    ds_read_b64_tr_b16 a[116:117], v249 offset:19808
    ds_read_b64_tr_b16 a[118:119], v249 offset:20320
    v_mfma_f32_16x16x32_bf16 v[200:203], a[44:47], v[156:159], v[200:203]
    s_cmov_b64 s[44:45], s[26:27]
    v_exp_f32 v194, v194
    v_mfma_f32_16x16x32_bf16 v[204:207], a[48:51], v[156:159], v[228:231]
    s_cmov_b64 s[24:25], s[28:29]
    ds_read_b64_tr_b16 a[120:121], v249 offset:19824
    ds_read_b64_tr_b16 a[122:123], v249 offset:20336
    v_mfma_f32_16x16x32_bf16 v[204:207], a[52:55], v[152:155], v[204:207]
    s_cselect_b32 s46, s78, 0x13da880
    v_exp_f32 v195, v195
    v_mfma_f32_16x16x32_bf16 v[204:207], a[56:59], v[148:151], v[204:207]
    ds_read_b64_tr_b16 a[124:125], v249 offset:2288
    ds_read_b64_tr_b16 a[126:127], v249 offset:2800
    v_mfma_f32_16x16x32_bf16 v[204:207], a[60:63], v[144:147], v[204:207]
    s_waitcnt lgkmcnt(15)
    buffer_load_dwordx4 v251, s[8:11], s23 offen offset:1152 lds
    v_mfma_f32_16x16x32_bf16 v[0:3], v[212:215], a[64:67], v[0:3]
    v_cvt_pk_bf16_f32 v216, v192, v193
    v_cvt_pk_bf16_f32 v217, v194, v195
    v_mfma_f32_16x16x32_bf16 v[0:3], v[208:211], a[68:71], v[0:3]
    v_exp_f32 v196, v196
    v_mfma_f32_16x16x32_bf16 v[4:7], v[208:211], a[72:75], v[4:7]
    v_exp_f32 v197, v197
    v_mfma_f32_16x16x32_bf16 v[4:7], v[212:215], a[76:79], v[4:7]
    v_exp_f32 v198, v198
    v_mfma_f32_16x16x32_bf16 v[8:11], v[212:215], a[80:83], v[8:11]
    v_exp_f32 v199, v199
    v_mfma_f32_16x16x32_bf16 v[8:11], v[208:211], a[84:87], v[8:11]
    v_cvt_pk_bf16_f32 v218, v196, v197
    v_cvt_pk_bf16_f32 v219, v198, v199
    v_mfma_f32_16x16x32_bf16 v[12:15], v[208:211], a[88:91], v[12:15]
    v_exp_f32 v200, v200
    v_mfma_f32_16x16x32_bf16 v[12:15], v[212:215], a[92:95], v[12:15]
    s_waitcnt lgkmcnt(8)
    v_exp_f32 v201, v201
    v_mfma_f32_16x16x32_bf16 v[16:19], v[212:215], a[96:99], v[16:19]
    v_exp_f32 v202, v202
    v_mfma_f32_16x16x32_bf16 v[16:19], v[208:211], a[100:103], v[16:19]
    v_exp_f32 v203, v203
    v_mfma_f32_16x16x32_bf16 v[20:23], v[208:211], a[104:107], v[20:23]
    v_cvt_pk_bf16_f32 v220, v200, v201
    v_cvt_pk_bf16_f32 v221, v202, v203
    v_mfma_f32_16x16x32_bf16 v[20:23], v[212:215], a[108:111], v[20:23]
    s_waitcnt lgkmcnt(0)
    v_exp_f32 v204, v204
    v_mfma_f32_16x16x32_bf16 v[24:27], v[212:215], a[112:115], v[24:27]
    v_exp_f32 v205, v205
    v_mfma_f32_16x16x32_bf16 v[24:27], v[208:211], a[116:119], v[24:27]
    buffer_load_dwordx4 v250, s[12:15], s23 offen offset:2176 lds
    v_mfma_f32_16x16x32_bf16 v[28:31], v[208:211], a[120:123], v[28:31]
    v_exp_f32 v206, v206
    v_mfma_f32_16x16x32_bf16 v[28:31], v[212:215], a[124:127], v[28:31]
    v_exp_f32 v207, v207
    v_smfmac_f32_16x16x64_bf16 v[240:243], a[132:135], v[208:215], v255
    v_add_u32 v248, s35, v248
    v_mfma_f32_16x16x32_bf16 v[192:195], a[0:3], v[160:163], v[232:235]
    v_cvt_pk_bf16_f32 v222, v204, v205
    v_cvt_pk_bf16_f32 v223, v206, v207
    v_mfma_f32_16x16x32_bf16 v[192:195], a[4:7], v[164:167], v[192:195]
    v_mfma_f32_16x16x32_bf16 v[192:195], a[8:11], v[168:171], v[192:195]
    v_mfma_f32_16x16x32_bf16 v[192:195], a[12:15], v[172:175], v[192:195]
    v_mfma_f32_16x16x32_bf16 v[196:199], a[16:19], v[172:175], v[232:235]
    v_mfma_f32_16x16x32_bf16 v[196:199], a[20:23], v[168:171], v[196:199]
    v_exp_f32 v192, v192
    v_mfma_f32_16x16x32_bf16 v[196:199], a[24:27], v[164:167], v[196:199]
    v_exp_f32 v193, v193
    v_mfma_f32_16x16x32_bf16 v[196:199], a[28:31], v[160:163], v[196:199]
    v_exp_f32 v194, v194
    v_mfma_f32_16x16x32_bf16 v[200:203], a[32:35], v[160:163], v[232:235]
    v_exp_f32 v195, v195
    v_mfma_f32_16x16x32_bf16 v[200:203], a[36:39], v[164:167], v[200:203]
    v_cvt_pk_bf16_f32 v212, v192, v193
    v_cvt_pk_bf16_f32 v213, v194, v195
    v_mfma_f32_16x16x32_bf16 v[200:203], a[40:43], v[168:171], v[200:203]
    v_exp_f32 v196, v196
    v_mfma_f32_16x16x32_bf16 v[200:203], a[44:47], v[172:175], v[200:203]
    buffer_load_dwordx4 v252, s[12:15], s23 offen offset:3216 lds
    v_mfma_f32_16x16x32_bf16 v[204:207], a[48:51], v[172:175], v[232:235]
    s_mov_b64 s[22:23], s[44:45]
    v_exp_f32 v197, v197
    v_mfma_f32_16x16x32_bf16 v[204:207], a[52:55], v[168:171], v[204:207]
    s_mov_b32 s14, s46
    v_exp_f32 v198, v198
    v_mfma_f32_16x16x32_bf16 v[204:207], a[56:59], v[164:167], v[204:207]
    s_mov_b32 s32, s31
    v_exp_f32 v199, v199
    v_mfma_f32_16x16x32_bf16 v[204:207], a[60:63], v[160:163], v[204:207]
    s_mov_b32 m0, s31
    v_cvt_pk_bf16_f32 v214, v196, v197
    v_cvt_pk_bf16_f32 v215, v198, v199
    v_mfma_f32_16x16x32_bf16 v[32:35], v[216:219], a[64:67], v[32:35]
    v_exp_f32 v200, v200
    v_mfma_f32_16x16x32_bf16 v[32:35], v[220:223], a[68:71], v[32:35]
    v_exp_f32 v201, v201
    v_mfma_f32_16x16x32_bf16 v[36:39], v[220:223], a[72:75], v[36:39]
    v_exp_f32 v202, v202
    v_mfma_f32_16x16x32_bf16 v[36:39], v[216:219], a[76:79], v[36:39]
    v_exp_f32 v203, v203
    v_mfma_f32_16x16x32_bf16 v[40:43], v[216:219], a[80:83], v[40:43]
    v_cvt_pk_bf16_f32 v208, v200, v201
    v_cvt_pk_bf16_f32 v209, v202, v203
    v_mfma_f32_16x16x32_bf16 v[40:43], v[220:223], a[84:87], v[40:43]
    v_exp_f32 v204, v204
    v_mfma_f32_16x16x32_bf16 v[44:47], v[220:223], a[88:91], v[44:47]
    v_exp_f32 v205, v205
    v_mfma_f32_16x16x32_bf16 v[44:47], v[216:219], a[92:95], v[44:47]
    v_exp_f32 v206, v206
    v_mfma_f32_16x16x32_bf16 v[48:51], v[216:219], a[96:99], v[48:51]
    v_exp_f32 v207, v207
    v_mfma_f32_16x16x32_bf16 v[48:51], v[220:223], a[100:103], v[48:51]
    v_cvt_pk_bf16_f32 v210, v204, v205
    v_cvt_pk_bf16_f32 v211, v206, v207
    v_mfma_f32_16x16x32_bf16 v[52:55], v[220:223], a[104:107], v[52:55]
    v_mfma_f32_16x16x32_bf16 v[52:55], v[216:219], a[108:111], v[52:55]
    v_mfma_f32_16x16x32_bf16 v[56:59], v[216:219], a[112:115], v[56:59]
    v_mfma_f32_16x16x32_bf16 v[56:59], v[220:223], a[116:119], v[56:59]
    v_mfma_f32_16x16x32_bf16 v[60:63], v[220:223], a[120:123], v[60:63]
    v_mfma_f32_16x16x32_bf16 v[60:63], v[216:219], a[124:127], v[60:63]
    s_waitcnt vmcnt(8)
    v_smfmac_f32_16x16x64_bf16 v[240:243], a[136:139], v[216:223], v255
    s_barrier
    v_mfma_f32_16x16x32_bf16 v[192:195], a[0:3], v[176:179], v[236:239]
    buffer_load_dwordx4 v250, s[8:11], s22 offen offset:0 lds
    v_mfma_f32_16x16x32_bf16 v[192:195], a[4:7], v[180:183], v[192:195]
    v_mfma_f32_16x16x32_bf16 v[192:195], a[8:11], v[184:187], v[192:195]
    ds_read_b128 a[0:3], v248 offset:0
    ds_read_b128 a[4:7], v248 offset:64
    v_mfma_f32_16x16x32_bf16 v[192:195], a[12:15], v[188:191], v[192:195]
    v_mfma_f32_16x16x32_bf16 v[196:199], a[16:19], v[188:191], v[236:239]
    v_mfma_f32_16x16x32_bf16 v[196:199], a[20:23], v[184:187], v[196:199]
    ds_read_b128 a[8:11], v248 offset:128
    ds_read_b128 a[12:15], v248 offset:192
    v_mfma_f32_16x16x32_bf16 v[196:199], a[24:27], v[180:183], v[196:199]
    v_exp_f32 v192, v192
    v_mfma_f32_16x16x32_bf16 v[196:199], a[28:31], v[176:179], v[196:199]
    v_exp_f32 v193, v193
    v_mfma_f32_16x16x32_bf16 v[200:203], a[32:35], v[176:179], v[236:239]
    ds_read_b128 a[16:19], v248 offset:704
    ds_read_b128 a[20:23], v248 offset:640
    v_mfma_f32_16x16x32_bf16 v[200:203], a[36:39], v[180:183], v[200:203]
    v_exp_f32 v194, v194
    v_mfma_f32_16x16x32_bf16 v[200:203], a[40:43], v[184:187], v[200:203]
    v_exp_f32 v195, v195
    v_mfma_f32_16x16x32_bf16 v[200:203], a[44:47], v[188:191], v[200:203]
    ds_read_b128 a[24:27], v248 offset:576
    ds_read_b128 a[28:31], v248 offset:512
    v_mfma_f32_16x16x32_bf16 v[204:207], a[48:51], v[188:191], v[236:239]
    v_cvt_pk_bf16_f32 v216, v192, v193
    v_cvt_pk_bf16_f32 v217, v194, v195
    v_mfma_f32_16x16x32_bf16 v[204:207], a[52:55], v[184:187], v[204:207]
    v_exp_f32 v196, v196
    v_mfma_f32_16x16x32_bf16 v[204:207], a[56:59], v[180:183], v[204:207]
    ds_read_b128 a[32:35], v248 offset:17536
    ds_read_b128 a[36:39], v248 offset:17600
    v_mfma_f32_16x16x32_bf16 v[204:207], a[60:63], v[176:179], v[204:207]
    v_exp_f32 v197, v197
    v_mfma_f32_16x16x32_bf16 v[64:67], v[212:215], a[64:67], v[64:67]
    v_exp_f32 v198, v198
    v_mfma_f32_16x16x32_bf16 v[64:67], v[208:211], a[68:71], v[64:67]
    ds_read_b128 a[40:43], v248 offset:17664
    ds_read_b128 a[44:47], v248 offset:17728
    v_mfma_f32_16x16x32_bf16 v[68:71], v[208:211], a[72:75], v[68:71]
    buffer_load_dwordx4 v251, s[8:11], s22 offen offset:1152 lds
    v_mfma_f32_16x16x32_bf16 v[68:71], v[212:215], a[76:79], v[68:71]
    v_exp_f32 v199, v199
    v_mfma_f32_16x16x32_bf16 v[72:75], v[212:215], a[80:83], v[72:75]
    ds_read_b128 a[48:51], v248 offset:18240
    ds_read_b128 a[52:55], v248 offset:18176
    v_mfma_f32_16x16x32_bf16 v[72:75], v[208:211], a[84:87], v[72:75]
    v_cvt_pk_bf16_f32 v218, v196, v197
    v_cvt_pk_bf16_f32 v219, v198, v199
    v_mfma_f32_16x16x32_bf16 v[76:79], v[208:211], a[88:91], v[76:79]
    v_exp_f32 v200, v200
    v_mfma_f32_16x16x32_bf16 v[76:79], v[212:215], a[92:95], v[76:79]
    ds_read_b128 a[56:59], v248 offset:18112
    ds_read_b128 a[60:63], v248 offset:18048
    v_mfma_f32_16x16x32_bf16 v[80:83], v[212:215], a[96:99], v[80:83]
    v_exp_f32 v201, v201
    v_mfma_f32_16x16x32_bf16 v[80:83], v[208:211], a[100:103], v[80:83]
    v_exp_f32 v202, v202
    v_mfma_f32_16x16x32_bf16 v[84:87], v[208:211], a[104:107], v[84:87]
    v_exp_f32 v203, v203
    v_mfma_f32_16x16x32_bf16 v[84:87], v[212:215], a[108:111], v[84:87]
    v_cvt_pk_bf16_f32 v220, v200, v201
    v_cvt_pk_bf16_f32 v221, v202, v203
    v_mfma_f32_16x16x32_bf16 v[88:91], v[212:215], a[112:115], v[88:91]
    v_exp_f32 v204, v204
    v_mfma_f32_16x16x32_bf16 v[88:91], v[208:211], a[116:119], v[88:91]
    v_exp_f32 v205, v205
    v_mfma_f32_16x16x32_bf16 v[92:95], v[208:211], a[120:123], v[92:95]
    v_exp_f32 v206, v206
    v_mfma_f32_16x16x32_bf16 v[92:95], v[212:215], a[124:127], v[92:95]
    v_exp_f32 v207, v207
    v_smfmac_f32_16x16x64_bf16 v[244:247], a[132:135], v[208:215], v255
    s_waitcnt lgkmcnt(12)
    v_cvt_pk_bf16_f32 v222, v204, v205
    v_mfma_f32_16x16x32_bf16 v[192:195], a[0:3], v[128:131], v[224:227]
    buffer_load_dwordx4 v250, s[12:15], s22 offen offset:2176 lds
    v_mfma_f32_16x16x32_bf16 v[192:195], a[4:7], v[132:135], v[192:195]
    v_cvt_pk_bf16_f32 v223, v206, v207
    v_add_u32 v249, s35, v249
    v_mfma_f32_16x16x32_bf16 v[192:195], a[8:11], v[136:139], v[192:195]
    v_mfma_f32_16x16x32_bf16 v[192:195], a[12:15], v[140:143], v[192:195]
    s_waitcnt lgkmcnt(9)
    v_mfma_f32_16x16x32_bf16 v[196:199], a[16:19], v[140:143], v[224:227]
    v_mfma_f32_16x16x32_bf16 v[196:199], a[20:23], v[136:139], v[196:199]
    s_cmp_eq_u32 s34, 0
    v_exp_f32 v192, v192
    v_mfma_f32_16x16x32_bf16 v[196:199], a[24:27], v[132:135], v[196:199]
    s_waitcnt lgkmcnt(4)
    v_exp_f32 v193, v193
    v_mfma_f32_16x16x32_bf16 v[196:199], a[28:31], v[128:131], v[196:199]
    s_cbranch_scc1 L_out_4
    v_exp_f32 v194, v194
    v_mfma_f32_16x16x32_bf16 v[200:203], a[32:35], v[128:131], v[224:227]
    v_exp_f32 v195, v195
    v_mfma_f32_16x16x32_bf16 v[200:203], a[36:39], v[132:135], v[200:203]
    v_cvt_pk_bf16_f32 v212, v192, v193
    v_cvt_pk_bf16_f32 v213, v194, v195
    v_mfma_f32_16x16x32_bf16 v[200:203], a[40:43], v[136:139], v[200:203]
    v_exp_f32 v196, v196
    v_mfma_f32_16x16x32_bf16 v[200:203], a[44:47], v[140:143], v[200:203]
    s_waitcnt lgkmcnt(0)
    v_exp_f32 v197, v197
    v_mfma_f32_16x16x32_bf16 v[204:207], a[48:51], v[140:143], v[224:227]
    v_exp_f32 v198, v198
    v_mfma_f32_16x16x32_bf16 v[204:207], a[52:55], v[136:139], v[204:207]
    v_exp_f32 v199, v199
    v_mfma_f32_16x16x32_bf16 v[204:207], a[56:59], v[132:135], v[204:207]
    buffer_load_dwordx4 v252, s[12:15], s22 offen offset:3216 lds
    v_mfma_f32_16x16x32_bf16 v[204:207], a[60:63], v[128:131], v[204:207]
    s_addk_i32 s32, 17536
    v_cvt_pk_bf16_f32 v214, v196, v197
    v_cvt_pk_bf16_f32 v215, v198, v199
    v_mfma_f32_16x16x32_bf16 v[96:99], v[216:219], a[64:67], v[96:99]
    s_mov_b32 m0, s32
    ds_read_b64_tr_b16 a[64:65], v249 offset:2176
    ds_read_b64_tr_b16 a[66:67], v249 offset:2688
    v_mfma_f32_16x16x32_bf16 v[96:99], v[220:223], a[68:71], v[96:99]
    s_mov_b32 s14, 0x13da880
    v_exp_f32 v200, v200
    v_mfma_f32_16x16x32_bf16 v[100:103], v[220:223], a[72:75], v[100:103]
    ds_read_b64_tr_b16 a[68:69], v249 offset:19712
    ds_read_b64_tr_b16 a[70:71], v249 offset:20224
    v_mfma_f32_16x16x32_bf16 v[100:103], v[216:219], a[76:79], v[100:103]
    v_exp_f32 v201, v201
    v_mfma_f32_16x16x32_bf16 v[104:107], v[216:219], a[80:83], v[104:107]
    ds_read_b64_tr_b16 a[72:73], v249 offset:19728
    ds_read_b64_tr_b16 a[74:75], v249 offset:20240
    v_mfma_f32_16x16x32_bf16 v[104:107], v[220:223], a[84:87], v[104:107]
    v_exp_f32 v202, v202
    v_mfma_f32_16x16x32_bf16 v[108:111], v[220:223], a[88:91], v[108:111]
    ds_read_b64_tr_b16 a[76:77], v249 offset:2192
    ds_read_b64_tr_b16 a[78:79], v249 offset:2704
    v_mfma_f32_16x16x32_bf16 v[108:111], v[216:219], a[92:95], v[108:111]
    v_exp_f32 v203, v203
    v_mfma_f32_16x16x32_bf16 v[112:115], v[216:219], a[96:99], v[112:115]
    ds_read_b64_tr_b16 a[80:81], v249 offset:2208
    ds_read_b64_tr_b16 a[82:83], v249 offset:2720
    v_mfma_f32_16x16x32_bf16 v[112:115], v[220:223], a[100:103], v[112:115]
    v_cvt_pk_bf16_f32 v208, v200, v201
    v_cvt_pk_bf16_f32 v209, v202, v203
    v_mfma_f32_16x16x32_bf16 v[116:119], v[220:223], a[104:107], v[116:119]
    ds_read_b64_tr_b16 a[84:85], v249 offset:19744
    ds_read_b64_tr_b16 a[86:87], v249 offset:20256
    v_mfma_f32_16x16x32_bf16 v[116:119], v[216:219], a[108:111], v[116:119]
    v_exp_f32 v204, v204
    v_mfma_f32_16x16x32_bf16 v[120:123], v[216:219], a[112:115], v[120:123]
    s_sub_u32 s34, s34, 1
    ds_read_b64_tr_b16 a[88:89], v249 offset:19760
    ds_read_b64_tr_b16 a[90:91], v249 offset:20272
    v_mfma_f32_16x16x32_bf16 v[120:123], v[220:223], a[116:119], v[120:123]
    s_cmp_lg_u32 s34, s3
    buffer_load_dwordx4 v250, s[8:11], s23 offen offset:0 lds
    v_mfma_f32_16x16x32_bf16 v[124:127], v[220:223], a[120:123], v[124:127]
    ds_read_b64_tr_b16 a[92:93], v249 offset:2224
    ds_read_b64_tr_b16 a[94:95], v249 offset:2736
    v_mfma_f32_16x16x32_bf16 v[124:127], v[216:219], a[124:127], v[124:127]
    v_exp_f32 v205, v205
    v_smfmac_f32_16x16x64_bf16 v[244:247], a[136:139], v[216:223], v255
    s_cbranch_scc1 L_loop_4
    s_branch L_lq_4
.p2align 3
L_out_4:
    s_cmp_eq_u32 s39, 0
    s_cbranch_scc1 L_laste_4
    s_branch L_lastm_4h
.p2align 12
.p2align 5
P_lq_4:
    s_setpc_b64 s[62:63]
.fill 7, 4, 0xbf800000
L_lq_4:
    v_mfma_f32_16x16x32_bf16 v[192:195], a[0:3], v[144:147], v[228:231]
    s_add_u32 s31, s30, s33
    ds_read_b64_tr_b16 a[96:97], v249 offset:2240
    ds_read_b64_tr_b16 a[98:99], v249 offset:2752
    v_mfma_f32_16x16x32_bf16 v[192:195], a[4:7], v[148:151], v[192:195]
    s_add_u32 s30, s30, s80
    v_exp_f32 v206, v206
    v_mfma_f32_16x16x32_bf16 v[192:195], a[8:11], v[152:155], v[192:195]
    s_cmp_eq_u32 s30, 105216
    ds_read_b64_tr_b16 a[100:101], v249 offset:19776
    ds_read_b64_tr_b16 a[102:103], v249 offset:20288
    v_mfma_f32_16x16x32_bf16 v[192:195], a[12:15], v[156:159], v[192:195]
    s_cmov_b32 s30, 0
    v_exp_f32 v207, v207
    v_mfma_f32_16x16x32_bf16 v[196:199], a[16:19], v[156:159], v[228:231]
    s_cselect_b32 s35, s81, s80
    ds_read_b64_tr_b16 a[104:105], v249 offset:19792
    ds_read_b64_tr_b16 a[106:107], v249 offset:20304
    v_mfma_f32_16x16x32_bf16 v[196:199], a[20:23], v[152:155], v[196:199]
    s_mov_b32 s44, s24
    v_cvt_pk_bf16_f32 v210, v204, v205
    v_cvt_pk_bf16_f32 v211, v206, v207
    v_mfma_f32_16x16x32_bf16 v[196:199], a[24:27], v[148:151], v[196:199]
    s_add_u32 s45, s24, s25
    ds_read_b64_tr_b16 a[108:109], v249 offset:2256
    ds_read_b64_tr_b16 a[110:111], v249 offset:2768
    v_mfma_f32_16x16x32_bf16 v[196:199], a[28:31], v[144:147], v[196:199]
    s_add_u32 s24, s45, s25
    v_exp_f32 v192, v192
    v_mfma_f32_16x16x32_bf16 v[200:203], a[32:35], v[144:147], v[228:231]
    s_cmp_eq_u32 s34, 2
    ds_read_b64_tr_b16 a[112:113], v249 offset:2272
    ds_read_b64_tr_b16 a[114:115], v249 offset:2784
    v_mfma_f32_16x16x32_bf16 v[200:203], a[36:39], v[148:151], v[200:203]
    s_cmov_b32 s45, 2.0
    v_exp_f32 v193, v193
    v_mfma_f32_16x16x32_bf16 v[200:203], a[40:43], v[152:155], v[200:203]
    s_cmp_eq_u32 s34, 1
    ds_read_b64_tr_b16 a[116:117], v249 offset:19808
    ds_read_b64_tr_b16 a[118:119], v249 offset:20320
    v_mfma_f32_16x16x32_bf16 v[200:203], a[44:47], v[156:159], v[200:203]
    s_cmov_b64 s[44:45], s[26:27]
    v_exp_f32 v194, v194
    v_mfma_f32_16x16x32_bf16 v[204:207], a[48:51], v[156:159], v[228:231]
    s_cmov_b64 s[24:25], s[28:29]
    ds_read_b64_tr_b16 a[120:121], v249 offset:19824
    ds_read_b64_tr_b16 a[122:123], v249 offset:20336
    v_mfma_f32_16x16x32_bf16 v[204:207], a[52:55], v[152:155], v[204:207]
    s_cselect_b32 s46, s78, 0x13da880
    v_exp_f32 v195, v195
    v_mfma_f32_16x16x32_bf16 v[204:207], a[56:59], v[148:151], v[204:207]
    ds_read_b64_tr_b16 a[124:125], v249 offset:2288
    ds_read_b64_tr_b16 a[126:127], v249 offset:2800
    v_mfma_f32_16x16x32_bf16 v[204:207], a[60:63], v[144:147], v[204:207]
    s_waitcnt lgkmcnt(15)
    buffer_load_dwordx4 v251, s[8:11], s23 offen offset:1152 lds
    v_mfma_f32_16x16x32_bf16 v[0:3], v[212:215], a[64:67], v[0:3]
    v_cvt_pk_bf16_f32 v216, v192, v193
    v_cvt_pk_bf16_f32 v217, v194, v195
    v_mfma_f32_16x16x32_bf16 v[0:3], v[208:211], a[68:71], v[0:3]
    v_exp_f32 v196, v196
    v_mfma_f32_16x16x32_bf16 v[4:7], v[208:211], a[72:75], v[4:7]
    v_exp_f32 v197, v197
    v_mfma_f32_16x16x32_bf16 v[4:7], v[212:215], a[76:79], v[4:7]
    v_exp_f32 v198, v198
    v_mfma_f32_16x16x32_bf16 v[8:11], v[212:215], a[80:83], v[8:11]
    v_exp_f32 v199, v199
    v_mfma_f32_16x16x32_bf16 v[8:11], v[208:211], a[84:87], v[8:11]
    v_cvt_pk_bf16_f32 v218, v196, v197
    v_cvt_pk_bf16_f32 v219, v198, v199
    v_mfma_f32_16x16x32_bf16 v[12:15], v[208:211], a[88:91], v[12:15]
    v_exp_f32 v200, v200
    v_mfma_f32_16x16x32_bf16 v[12:15], v[212:215], a[92:95], v[12:15]
    s_waitcnt lgkmcnt(8)
    v_exp_f32 v201, v201
    v_mfma_f32_16x16x32_bf16 v[16:19], v[212:215], a[96:99], v[16:19]
    v_exp_f32 v202, v202
    v_mfma_f32_16x16x32_bf16 v[16:19], v[208:211], a[100:103], v[16:19]
    v_exp_f32 v203, v203
    v_mfma_f32_16x16x32_bf16 v[20:23], v[208:211], a[104:107], v[20:23]
    v_cvt_pk_bf16_f32 v220, v200, v201
    v_cvt_pk_bf16_f32 v221, v202, v203
    v_mfma_f32_16x16x32_bf16 v[20:23], v[212:215], a[108:111], v[20:23]
    s_waitcnt lgkmcnt(0)
    v_exp_f32 v204, v204
    v_mfma_f32_16x16x32_bf16 v[24:27], v[212:215], a[112:115], v[24:27]
    v_exp_f32 v205, v205
    v_mfma_f32_16x16x32_bf16 v[24:27], v[208:211], a[116:119], v[24:27]
    buffer_load_dwordx4 v250, s[12:15], s23 offen offset:2176 lds
    v_mfma_f32_16x16x32_bf16 v[28:31], v[208:211], a[120:123], v[28:31]
    v_exp_f32 v206, v206
    v_mfma_f32_16x16x32_bf16 v[28:31], v[212:215], a[124:127], v[28:31]
    v_exp_f32 v207, v207
    v_smfmac_f32_16x16x64_bf16 v[240:243], a[132:135], v[208:215], v255
    v_add_u32 v248, s35, v248
    v_mfma_f32_16x16x32_bf16 v[192:195], a[0:3], v[160:163], v[232:235]
    v_cvt_pk_bf16_f32 v222, v204, v205
    v_cvt_pk_bf16_f32 v223, v206, v207
    v_mfma_f32_16x16x32_bf16 v[192:195], a[4:7], v[164:167], v[192:195]
    v_mfma_f32_16x16x32_bf16 v[192:195], a[8:11], v[168:171], v[192:195]
    v_mfma_f32_16x16x32_bf16 v[192:195], a[12:15], v[172:175], v[192:195]
    v_mfma_f32_16x16x32_bf16 v[196:199], a[16:19], v[172:175], v[232:235]
    v_mfma_f32_16x16x32_bf16 v[196:199], a[20:23], v[168:171], v[196:199]
    v_exp_f32 v192, v192
    v_mfma_f32_16x16x32_bf16 v[196:199], a[24:27], v[164:167], v[196:199]
    v_exp_f32 v193, v193
    v_mfma_f32_16x16x32_bf16 v[196:199], a[28:31], v[160:163], v[196:199]
    v_exp_f32 v194, v194
    v_mfma_f32_16x16x32_bf16 v[200:203], a[32:35], v[160:163], v[232:235]
    v_exp_f32 v195, v195
    v_mfma_f32_16x16x32_bf16 v[200:203], a[36:39], v[164:167], v[200:203]
    v_cvt_pk_bf16_f32 v212, v192, v193
    v_cvt_pk_bf16_f32 v213, v194, v195
    v_mfma_f32_16x16x32_bf16 v[200:203], a[40:43], v[168:171], v[200:203]
    v_exp_f32 v196, v196
    v_mfma_f32_16x16x32_bf16 v[200:203], a[44:47], v[172:175], v[200:203]
    buffer_load_dwordx4 v252, s[12:15], s23 offen offset:3216 lds
    v_mfma_f32_16x16x32_bf16 v[204:207], a[48:51], v[172:175], v[232:235]
    s_mov_b64 s[22:23], s[44:45]
    v_exp_f32 v197, v197
    v_mfma_f32_16x16x32_bf16 v[204:207], a[52:55], v[168:171], v[204:207]
    s_mov_b32 s14, s46
    v_exp_f32 v198, v198
    v_mfma_f32_16x16x32_bf16 v[204:207], a[56:59], v[164:167], v[204:207]
    s_mov_b32 s32, s31
    v_exp_f32 v199, v199
    v_mfma_f32_16x16x32_bf16 v[204:207], a[60:63], v[160:163], v[204:207]
    s_mov_b32 m0, s31
    v_cvt_pk_bf16_f32 v214, v196, v197
    v_cvt_pk_bf16_f32 v215, v198, v199
    v_mfma_f32_16x16x32_bf16 v[32:35], v[216:219], a[64:67], v[32:35]
    v_exp_f32 v200, v200
    v_mfma_f32_16x16x32_bf16 v[32:35], v[220:223], a[68:71], v[32:35]
    v_exp_f32 v201, v201
    v_mfma_f32_16x16x32_bf16 v[36:39], v[220:223], a[72:75], v[36:39]
    v_exp_f32 v202, v202
    v_mfma_f32_16x16x32_bf16 v[36:39], v[216:219], a[76:79], v[36:39]
    v_exp_f32 v203, v203
    v_mfma_f32_16x16x32_bf16 v[40:43], v[216:219], a[80:83], v[40:43]
    v_cvt_pk_bf16_f32 v208, v200, v201
    v_cvt_pk_bf16_f32 v209, v202, v203
    v_mfma_f32_16x16x32_bf16 v[40:43], v[220:223], a[84:87], v[40:43]
    v_exp_f32 v204, v204
    v_mfma_f32_16x16x32_bf16 v[44:47], v[220:223], a[88:91], v[44:47]
    v_exp_f32 v205, v205
    v_mfma_f32_16x16x32_bf16 v[44:47], v[216:219], a[92:95], v[44:47]
    v_exp_f32 v206, v206
    v_mfma_f32_16x16x32_bf16 v[48:51], v[216:219], a[96:99], v[48:51]
    v_exp_f32 v207, v207
    v_mfma_f32_16x16x32_bf16 v[48:51], v[220:223], a[100:103], v[48:51]
    v_cvt_pk_bf16_f32 v210, v204, v205
    v_cvt_pk_bf16_f32 v211, v206, v207
    v_mfma_f32_16x16x32_bf16 v[52:55], v[220:223], a[104:107], v[52:55]
    v_mfma_f32_16x16x32_bf16 v[52:55], v[216:219], a[108:111], v[52:55]
    v_mfma_f32_16x16x32_bf16 v[56:59], v[216:219], a[112:115], v[56:59]
    v_mfma_f32_16x16x32_bf16 v[56:59], v[220:223], a[116:119], v[56:59]
    v_mfma_f32_16x16x32_bf16 v[60:63], v[220:223], a[120:123], v[60:63]
    v_mfma_f32_16x16x32_bf16 v[60:63], v[216:219], a[124:127], v[60:63]
    s_waitcnt vmcnt(8)
    v_smfmac_f32_16x16x64_bf16 v[240:243], a[136:139], v[216:223], v255
    s_barrier
    v_mfma_f32_16x16x32_bf16 v[192:195], a[0:3], v[176:179], v[236:239]
    buffer_load_dwordx4 v250, s[8:11], s22 offen offset:0 lds
    v_mfma_f32_16x16x32_bf16 v[192:195], a[4:7], v[180:183], v[192:195]
    s_mov_b32 m0, s51
    v_mfma_f32_16x16x32_bf16 v[192:195], a[8:11], v[184:187], v[192:195]
    ds_read_b128 a[0:3], v248 offset:0
    ds_read_b128 a[4:7], v248 offset:64
    v_mfma_f32_16x16x32_bf16 v[192:195], a[12:15], v[188:191], v[192:195]
    buffer_load_dwordx4 v253, s[4:7], s52 offen offset:0 nt lds
    v_mfma_f32_16x16x32_bf16 v[196:199], a[16:19], v[188:191], v[236:239]
    s_addk_i32 s52, 15296
    v_mfma_f32_16x16x32_bf16 v[196:199], a[20:23], v[184:187], v[196:199]
    ds_read_b128 a[8:11], v248 offset:128
    ds_read_b128 a[12:15], v248 offset:192
    v_mfma_f32_16x16x32_bf16 v[196:199], a[24:27], v[180:183], v[196:199]
    buffer_load_dwordx4 v253, s[4:7], s52 offen offset:1088 nt lds
    v_mfma_f32_16x16x32_bf16 v[196:199], a[28:31], v[176:179], v[196:199]
    s_addk_i32 s52, 15296
    v_exp_f32 v192, v192
    v_mfma_f32_16x16x32_bf16 v[200:203], a[32:35], v[176:179], v[236:239]
    ds_read_b128 a[16:19], v248 offset:704
    ds_read_b128 a[20:23], v248 offset:640
    v_mfma_f32_16x16x32_bf16 v[200:203], a[36:39], v[180:183], v[200:203]
    buffer_load_dwordx4 v253, s[4:7], s52 offen offset:2176 nt lds
    v_mfma_f32_16x16x32_bf16 v[200:203], a[40:43], v[184:187], v[200:203]
    s_addk_i32 s52, 15296
    v_exp_f32 v193, v193
    v_mfma_f32_16x16x32_bf16 v[200:203], a[44:47], v[188:191], v[200:203]
    ds_read_b128 a[24:27], v248 offset:576
    ds_read_b128 a[28:31], v248 offset:512
    v_mfma_f32_16x16x32_bf16 v[204:207], a[48:51], v[188:191], v[236:239]
    buffer_load_dwordx4 v253, s[4:7], s52 offen offset:3264 nt lds
    v_mfma_f32_16x16x32_bf16 v[204:207], a[52:55], v[184:187], v[204:207]
    s_mov_b32 m0, s32
    v_exp_f32 v194, v194
    v_mfma_f32_16x16x32_bf16 v[204:207], a[56:59], v[180:183], v[204:207]
    s_addk_i32 s52, 19648
    ds_read_b128 a[32:35], v248 offset:17536
    ds_read_b128 a[36:39], v248 offset:17600
    v_mfma_f32_16x16x32_bf16 v[204:207], a[60:63], v[176:179], v[204:207]
    s_addk_i32 s51, 4352
    v_exp_f32 v195, v195
    v_mfma_f32_16x16x32_bf16 v[64:67], v[212:215], a[64:67], v[64:67]
    v_cvt_pk_bf16_f32 v216, v192, v193
    v_cvt_pk_bf16_f32 v217, v194, v195
    v_mfma_f32_16x16x32_bf16 v[64:67], v[208:211], a[68:71], v[64:67]
    ds_read_b128 a[40:43], v248 offset:17664
    ds_read_b128 a[44:47], v248 offset:17728
    v_mfma_f32_16x16x32_bf16 v[68:71], v[208:211], a[72:75], v[68:71]
    buffer_load_dwordx4 v251, s[8:11], s22 offen offset:1152 lds
    v_mfma_f32_16x16x32_bf16 v[68:71], v[212:215], a[76:79], v[68:71]
    v_exp_f32 v196, v196
    v_mfma_f32_16x16x32_bf16 v[72:75], v[212:215], a[80:83], v[72:75]
    ds_read_b128 a[48:51], v248 offset:18240
    ds_read_b128 a[52:55], v248 offset:18176
    v_mfma_f32_16x16x32_bf16 v[72:75], v[208:211], a[84:87], v[72:75]
    v_exp_f32 v197, v197
    v_mfma_f32_16x16x32_bf16 v[76:79], v[208:211], a[88:91], v[76:79]
    v_exp_f32 v198, v198
    v_mfma_f32_16x16x32_bf16 v[76:79], v[212:215], a[92:95], v[76:79]
    ds_read_b128 a[56:59], v248 offset:18112
    ds_read_b128 a[60:63], v248 offset:18048
    v_mfma_f32_16x16x32_bf16 v[80:83], v[212:215], a[96:99], v[80:83]
    v_exp_f32 v199, v199
    v_mfma_f32_16x16x32_bf16 v[80:83], v[208:211], a[100:103], v[80:83]
    v_cvt_pk_bf16_f32 v218, v196, v197
    v_cvt_pk_bf16_f32 v219, v198, v199
    v_mfma_f32_16x16x32_bf16 v[84:87], v[208:211], a[104:107], v[84:87]
    v_exp_f32 v200, v200
    v_mfma_f32_16x16x32_bf16 v[84:87], v[212:215], a[108:111], v[84:87]
    v_exp_f32 v201, v201
    v_mfma_f32_16x16x32_bf16 v[88:91], v[212:215], a[112:115], v[88:91]
    v_exp_f32 v202, v202
    v_mfma_f32_16x16x32_bf16 v[88:91], v[208:211], a[116:119], v[88:91]
    v_exp_f32 v203, v203
    v_mfma_f32_16x16x32_bf16 v[92:95], v[208:211], a[120:123], v[92:95]
    v_cvt_pk_bf16_f32 v221, v202, v203
    v_add_u32 v249, s35, v249
    v_mfma_f32_16x16x32_bf16 v[92:95], v[212:215], a[124:127], v[92:95]
    v_exp_f32 v204, v204
    v_smfmac_f32_16x16x64_bf16 v[244:247], a[132:135], v[208:215], v255
    s_waitcnt lgkmcnt(12)
    v_cvt_pk_bf16_f32 v220, v200, v201
    v_mfma_f32_16x16x32_bf16 v[192:195], a[0:3], v[128:131], v[224:227]
    buffer_load_dwordx4 v250, s[12:15], s22 offen offset:2176 lds
    v_mfma_f32_16x16x32_bf16 v[192:195], a[4:7], v[132:135], v[192:195]
    v_exp_f32 v205, v205
    v_mfma_f32_16x16x32_bf16 v[192:195], a[8:11], v[136:139], v[192:195]
    v_exp_f32 v206, v206
    v_mfma_f32_16x16x32_bf16 v[192:195], a[12:15], v[140:143], v[192:195]
    s_waitcnt lgkmcnt(9)
    v_exp_f32 v207, v207
    v_mfma_f32_16x16x32_bf16 v[196:199], a[16:19], v[140:143], v[224:227]
    v_cvt_pk_bf16_f32 v222, v204, v205
    v_cvt_pk_bf16_f32 v223, v206, v207
    v_mfma_f32_16x16x32_bf16 v[196:199], a[20:23], v[136:139], v[196:199]
    v_exp_f32 v192, v192
    v_mfma_f32_16x16x32_bf16 v[196:199], a[24:27], v[132:135], v[196:199]
    s_waitcnt lgkmcnt(4)
    v_exp_f32 v193, v193
    v_mfma_f32_16x16x32_bf16 v[196:199], a[28:31], v[128:131], v[196:199]
    v_exp_f32 v194, v194
    v_mfma_f32_16x16x32_bf16 v[200:203], a[32:35], v[128:131], v[224:227]
    v_exp_f32 v195, v195
    v_mfma_f32_16x16x32_bf16 v[200:203], a[36:39], v[132:135], v[200:203]
    v_cvt_pk_bf16_f32 v212, v192, v193
    v_cvt_pk_bf16_f32 v213, v194, v195
    v_mfma_f32_16x16x32_bf16 v[200:203], a[40:43], v[136:139], v[200:203]
    v_exp_f32 v196, v196
    v_mfma_f32_16x16x32_bf16 v[200:203], a[44:47], v[140:143], v[200:203]
    s_waitcnt lgkmcnt(0)
    v_exp_f32 v197, v197
    v_mfma_f32_16x16x32_bf16 v[204:207], a[48:51], v[140:143], v[224:227]
    v_exp_f32 v198, v198
    v_mfma_f32_16x16x32_bf16 v[204:207], a[52:55], v[136:139], v[204:207]
    v_exp_f32 v199, v199
    v_mfma_f32_16x16x32_bf16 v[204:207], a[56:59], v[132:135], v[204:207]
    buffer_load_dwordx4 v252, s[12:15], s22 offen offset:3216 lds
    v_mfma_f32_16x16x32_bf16 v[204:207], a[60:63], v[128:131], v[204:207]
    s_addk_i32 s32, 17536
    v_cvt_pk_bf16_f32 v214, v196, v197
    v_cvt_pk_bf16_f32 v215, v198, v199
    v_mfma_f32_16x16x32_bf16 v[96:99], v[216:219], a[64:67], v[96:99]
    s_mov_b32 m0, s32
    ds_read_b64_tr_b16 a[64:65], v249 offset:2176
    ds_read_b64_tr_b16 a[66:67], v249 offset:2688
    v_mfma_f32_16x16x32_bf16 v[96:99], v[220:223], a[68:71], v[96:99]
    s_mov_b32 s14, 0x13da880
    v_exp_f32 v200, v200
    v_mfma_f32_16x16x32_bf16 v[100:103], v[220:223], a[72:75], v[100:103]
    ds_read_b64_tr_b16 a[68:69], v249 offset:19712
    ds_read_b64_tr_b16 a[70:71], v249 offset:20224
    v_mfma_f32_16x16x32_bf16 v[100:103], v[216:219], a[76:79], v[100:103]
    v_exp_f32 v201, v201
    v_mfma_f32_16x16x32_bf16 v[104:107], v[216:219], a[80:83], v[104:107]
    ds_read_b64_tr_b16 a[72:73], v249 offset:19728
    ds_read_b64_tr_b16 a[74:75], v249 offset:20240
    v_mfma_f32_16x16x32_bf16 v[104:107], v[220:223], a[84:87], v[104:107]
    v_exp_f32 v202, v202
    v_mfma_f32_16x16x32_bf16 v[108:111], v[220:223], a[88:91], v[108:111]
    ds_read_b64_tr_b16 a[76:77], v249 offset:2192
    ds_read_b64_tr_b16 a[78:79], v249 offset:2704
    v_mfma_f32_16x16x32_bf16 v[108:111], v[216:219], a[92:95], v[108:111]
    v_exp_f32 v203, v203
    v_mfma_f32_16x16x32_bf16 v[112:115], v[216:219], a[96:99], v[112:115]
    ds_read_b64_tr_b16 a[80:81], v249 offset:2208
    ds_read_b64_tr_b16 a[82:83], v249 offset:2720
    v_mfma_f32_16x16x32_bf16 v[112:115], v[220:223], a[100:103], v[112:115]
    v_cvt_pk_bf16_f32 v208, v200, v201
    v_cvt_pk_bf16_f32 v209, v202, v203
    v_mfma_f32_16x16x32_bf16 v[116:119], v[220:223], a[104:107], v[116:119]
    ds_read_b64_tr_b16 a[84:85], v249 offset:19744
    ds_read_b64_tr_b16 a[86:87], v249 offset:20256
    v_mfma_f32_16x16x32_bf16 v[116:119], v[216:219], a[108:111], v[116:119]
    v_exp_f32 v204, v204
    v_mfma_f32_16x16x32_bf16 v[120:123], v[216:219], a[112:115], v[120:123]
    s_sub_u32 s34, s34, 1
    ds_read_b64_tr_b16 a[88:89], v249 offset:19760
    ds_read_b64_tr_b16 a[90:91], v249 offset:20272
    v_mfma_f32_16x16x32_bf16 v[120:123], v[220:223], a[116:119], v[120:123]
    s_cmp_lg_u32 s34, s53
    buffer_load_dwordx4 v250, s[8:11], s23 offen offset:0 lds
    v_mfma_f32_16x16x32_bf16 v[124:127], v[220:223], a[120:123], v[124:127]
    s_mov_b32 s3, -1
    ds_read_b64_tr_b16 a[92:93], v249 offset:2224
    ds_read_b64_tr_b16 a[94:95], v249 offset:2736
    v_mfma_f32_16x16x32_bf16 v[124:127], v[216:219], a[124:127], v[124:127]
    v_exp_f32 v205, v205
    v_smfmac_f32_16x16x64_bf16 v[244:247], a[136:139], v[216:223], v255
    s_cbranch_scc1 L_lq_4
    s_branch L_loop_4
.p2align 3
L_lastm_4h:
    v_exp_f32 v194, v194
    v_mfma_f32_16x16x32_bf16 v[200:203], a[0:3], v[144:147], v[228:231]
    s_waitcnt vmcnt(6)
    v_exp_f32_e64 v195, v195
    v_mfma_f32_16x16x32_bf16 v[200:203], a[4:7], v[148:151], v[200:203]
    buffer_load_dwordx4 v252, s[12:15], s22 offen offset:3216 lds
    v_mfma_f32_16x16x32_bf16 v[200:203], a[8:11], v[152:155], v[200:203]
    s_addk_i32 s32, 17536
    v_cvt_pk_bf16_f32 v212, v192, v193
    s_mov_b32 m0, s32
    v_mfma_f32_16x16x32_bf16 v[200:203], a[12:15], v[156:159], v[200:203]
    s_mov_b32 s14, 0x13da880
    v_cvt_pk_bf16_f32 v213, v194, v195
    v_exp_f32_e64 v196, v196
    v_mfma_f32_16x16x32_bf16 v[204:207], a[16:19], v[156:159], v[228:231]
    ds_read_b128 v[156:159], v254 offset:4544
    buffer_load_dwordx4 v250, s[8:11], s23 offen offset:0 lds
    v_mfma_f32_16x16x32_bf16 v[204:207], a[20:23], v[152:155], v[204:207]
    ds_read_b128 v[152:155], v254 offset:4480
    v_exp_f32_e64 v197, v197
    v_mfma_f32_16x16x32_bf16 v[204:207], a[24:27], v[148:151], v[204:207]
    ds_read_b128 v[148:151], v254 offset:4416
    buffer_load_dwordx4 v251, s[8:11], s23 offen offset:1152 lds
    v_mfma_f32_16x16x32_bf16 v[204:207], a[28:31], v[144:147], v[204:207]
    ds_read_b128 v[144:147], v254 offset:4352
    v_exp_f32_e64 v198, v198
    v_mfma_f32_16x16x32_bf16 v[96:99], v[216:219], a[64:67], v[96:99]
    ds_read_b64_tr_b16 a[64:65], v249 offset:2176
    ds_read_b64_tr_b16 a[66:67], v249 offset:2688
    v_mfma_f32_16x16x32_bf16 v[96:99], v[220:223], a[68:71], v[96:99]
    buffer_load_dwordx4 v250, s[12:15], s23 offen offset:2176 lds
    v_mfma_f32_16x16x32_bf16 v[100:103], v[220:223], a[72:75], v[100:103]
    v_exp_f32_e64 v199, v199
    v_mfma_f32_16x16x32_bf16 v[100:103], v[216:219], a[76:79], v[100:103]
    ds_read_b64_tr_b16 a[76:77], v249 offset:2192
    ds_read_b64_tr_b16 a[78:79], v249 offset:2704
    v_mfma_f32_16x16x32_bf16 v[104:107], v[216:219], a[80:83], v[104:107]
    ds_read_b64_tr_b16 a[80:81], v249 offset:2208
    ds_read_b64_tr_b16 a[82:83], v249 offset:2720
    v_mfma_f32_16x16x32_bf16 v[104:107], v[220:223], a[84:87], v[104:107]
    buffer_load_dwordx4 v252, s[12:15], s23 offen offset:3216 lds
    v_mfma_f32_16x16x32_bf16 v[108:111], v[220:223], a[88:91], v[108:111]
    v_cvt_pk_bf16_f32 v214, v196, v197
    v_cvt_pk_bf16_f32 v215, v198, v199
    v_mfma_f32_16x16x32_bf16 v[108:111], v[216:219], a[92:95], v[108:111]
    ds_read_b64_tr_b16 a[92:93], v249 offset:2224
    ds_read_b64_tr_b16 a[94:95], v249 offset:2736
    v_mfma_f32_16x16x32_bf16 v[112:115], v[216:219], a[96:99], v[112:115]
    ds_read_b64_tr_b16 a[96:97], v249 offset:2240
    ds_read_b64_tr_b16 a[98:99], v249 offset:2752
    v_mfma_f32_16x16x32_bf16 v[112:115], v[220:223], a[100:103], v[112:115]
    ds_read_b128 v[128:131], v254 offset:0
    v_exp_f32_e64 v200, v200
    v_mfma_f32_16x16x32_bf16 v[116:119], v[220:223], a[104:107], v[116:119]
    ds_read_b128 v[132:135], v254 offset:64
    v_exp_f32_e64 v201, v201
    v_mfma_f32_16x16x32_bf16 v[116:119], v[216:219], a[108:111], v[116:119]
    ds_read_b64_tr_b16 a[108:109], v249 offset:2256
    ds_read_b64_tr_b16 a[110:111], v249 offset:2768
    v_mfma_f32_16x16x32_bf16 v[120:123], v[216:219], a[112:115], v[120:123]
    ds_read_b64_tr_b16 a[112:113], v249 offset:2272
    ds_read_b64_tr_b16 a[114:115], v249 offset:2784
    v_mfma_f32_16x16x32_bf16 v[120:123], v[220:223], a[116:119], v[120:123]
    ds_read_b128 v[136:139], v254 offset:128
    v_exp_f32_e64 v202, v202
    v_mfma_f32_16x16x32_bf16 v[124:127], v[220:223], a[120:123], v[124:127]
    ds_read_b128 v[140:143], v254 offset:192
    v_exp_f32_e64 v203, v203
    v_mfma_f32_16x16x32_bf16 v[124:127], v[216:219], a[124:127], v[124:127]
    ds_read_b64_tr_b16 a[124:125], v249 offset:2288
    ds_read_b64_tr_b16 a[126:127], v249 offset:2800
    v_smfmac_f32_16x16x64_bf16 v[244:247], a[136:139], v[216:223], v255
    s_mov_b32 s40, s73
    v_exp_f32 v204, v204
    v_smfmac_f32_16x16x64_bf16 v[240:243], a[168:171], v[212:219], v255
    s_waitcnt lgkmcnt(6)
    v_exp_f32_e64 v205, v205
    v_mfma_f32_16x16x32_bf16 v[0:3], v[212:215], a[64:67], v[0:3]
    s_add_u32 s31, s30, s33
    v_exp_f32_e64 v206, v206
    v_mfma_f32_16x16x32_bf16 v[4:7], v[212:215], a[76:79], v[4:7]
    s_add_u32 s30, s30, s80
    v_exp_f32 v207, v207
    v_mfma_f32_16x16x32_bf16 v[8:11], v[212:215], a[80:83], v[8:11]
    s_cmp_eq_u32 s30, 105216
    v_accvgpr_read_b32 v208, a164
    v_add_f32 v209, v240, v241
    v_mfma_f32_16x16x32_bf16 v[12:15], v[212:215], a[92:95], v[12:15]
    s_cmov_b32 s30, 0
    v_subrev_u32 v210, 0x37800000, v209
    v_rcp_f32 v209, v209
    v_mfma_f32_16x16x32_bf16 v[16:19], v[212:215], a[96:99], v[16:19]
    s_cselect_b32 s35, s81, s80
    v_cmp_lt_u32 s[66:67], s79, v210
    v_mov_b32_dpp v209, v209 row_ror:12 row_mask:0xa bank_mask:0xf
    v_mfma_f32_16x16x32_bf16 v[20:23], v[212:215], a[108:111], v[20:23]
    s_waitcnt lgkmcnt(0)
    v_add_u32 v248, s35, v248
    v_add_u32 v249, s35, v249
    v_mfma_f32_16x16x32_bf16 v[24:27], v[212:215], a[112:115], v[24:27]
    s_or_b64 s[64:65], s[64:65], s[66:67]
    v_mov_b32_dpp v209, v209 row_ror:8 row_mask:0xc bank_mask:0xf
    s_waitcnt vmcnt(8)
    v_mfma_f32_16x16x32_bf16 v[28:31], v[212:215], a[124:127], v[28:31]
    s_barrier
    v_mov_b32_dpp v220, v209 row_newbcast:0 row_mask:0xf bank_mask:0xf
    v_mov_b32_dpp v221, v209 row_newbcast:1 row_mask:0xf bank_mask:0xf
    v_mov_b32_dpp v222, v209 row_newbcast:2 row_mask:0xf bank_mask:0xf
    v_mov_b32_dpp v223, v209 row_newbcast:3 row_mask:0xf bank_mask:0xf
    v_cvt_pk_bf16_f32 v216, v200, v201
    v_cvt_pk_bf16_f32 v217, v202, v203
    v_cvt_pk_bf16_f32 v218, v204, v205
    v_cvt_pk_bf16_f32 v219, v206, v207
    v_pk_mul_f32 v[0:1], v[0:1], v[220:221]
    v_pk_mul_f32 v[2:3], v[2:3], v[222:223]
    v_pk_mul_f32 v[4:5], v[4:5], v[220:221]
    v_pk_mul_f32 v[6:7], v[6:7], v[222:223]
    v_pk_mul_f32 v[8:9], v[8:9], v[220:221]
    v_pk_mul_f32 v[10:11], v[10:11], v[222:223]
    v_pk_mul_f32 v[12:13], v[12:13], v[220:221]
    v_pk_mul_f32 v[14:15], v[14:15], v[222:223]
    v_pk_mul_f32 v[16:17], v[16:17], v[220:221]
    v_pk_mul_f32 v[18:19], v[18:19], v[222:223]
    v_pk_mul_f32 v[20:21], v[20:21], v[220:221]
    v_pk_mul_f32 v[22:23], v[22:23], v[222:223]
    v_pk_mul_f32 v[24:25], v[24:25], v[220:221]
    v_pk_mul_f32 v[26:27], v[26:27], v[222:223]
    v_pk_mul_f32 v[28:29], v[28:29], v[220:221]
    v_pk_mul_f32 v[30:31], v[30:31], v[222:223]
    v_smfmac_f32_16x16x64_bf16 v[240:243], a[172:175], v[212:219], v255
    ds_read_b128 a[32:35], v248 offset:17536
    ds_read_b128 a[36:39], v248 offset:17600
    v_mfma_f32_16x16x32_bf16 v[32:35], v[216:219], a[64:67], v[32:35]
    s_branch L_lastm_4
.p2align 12
.p2align 5
P_first2p_2:
    s_setpc_b64 s[62:63]
.fill 1, 4, 0xbf800000
L_first2p_2:
    v_mfma_f32_16x16x32_bf16 v[192:195], a[0:3], v[128:131], v[224:227]
    s_addk_i32 s32, 17536
    s_mov_b32 m0, s32
    ds_read_b64_tr_b16 a[64:65], v249 offset:2176
    ds_read_b64_tr_b16 a[66:67], v249 offset:2688
    v_mfma_f32_16x16x32_bf16 v[192:195], a[4:7], v[132:135], v[192:195]
    s_mov_b32 s14, 0x13da880
    ds_read_b64_tr_b16 a[68:69], v249 offset:19712
    ds_read_b64_tr_b16 a[70:71], v249 offset:20224
    v_mfma_f32_16x16x32_bf16 v[192:195], a[8:11], v[136:139], v[192:195]
    buffer_load_dwordx4 v250, s[8:11], s23 offen offset:0 lds
    v_mfma_f32_16x16x32_bf16 v[192:195], a[12:15], v[140:143], v[192:195]
    s_add_u32 s31, s30, s33
    ds_read_b64_tr_b16 a[72:73], v249 offset:19728
    ds_read_b64_tr_b16 a[74:75], v249 offset:20240
    v_mfma_f32_16x16x32_bf16 v[196:199], a[16:19], v[140:143], v[224:227]
    s_add_u32 s30, s30, s80
    ds_read_b64_tr_b16 a[76:77], v249 offset:2192
    ds_read_b64_tr_b16 a[78:79], v249 offset:2704
    v_mfma_f32_16x16x32_bf16 v[196:199], a[20:23], v[136:139], v[196:199]
    s_cmp_eq_u32 s30, 105216
    v_mov_b32 v240, 0
    v_mov_b32 v241, 0
    v_mfma_f32_16x16x32_bf16 v[196:199], a[24:27], v[132:135], v[196:199]
    s_cmov_b32 s30, 0
    ds_read_b64_tr_b16 a[80:81], v249 offset:2208
    ds_read_b64_tr_b16 a[82:83], v249 offset:2720
    v_mfma_f32_16x16x32_bf16 v[196:199], a[28:31], v[128:131], v[196:199]
    s_cselect_b32 s35, s81, s80
    ds_read_b64_tr_b16 a[84:85], v249 offset:19744
    ds_read_b64_tr_b16 a[86:87], v249 offset:20256
    v_mfma_f32_16x16x32_bf16 v[200:203], a[32:35], v[128:131], v[224:227]
    buffer_load_dwordx4 v251, s[8:11], s23 offen offset:1152 lds
    v_mfma_f32_16x16x32_bf16 v[200:203], a[36:39], v[132:135], v[200:203]
    ds_read_b64_tr_b16 a[88:89], v249 offset:19760
    ds_read_b64_tr_b16 a[90:91], v249 offset:20272
    v_mfma_f32_16x16x32_bf16 v[200:203], a[40:43], v[136:139], v[200:203]
    ds_read_b64_tr_b16 a[92:93], v249 offset:2224
    ds_read_b64_tr_b16 a[94:95], v249 offset:2736
    v_mfma_f32_16x16x32_bf16 v[200:203], a[44:47], v[140:143], v[200:203]
    v_mov_b32 v242, 0
    v_mov_b32 v243, 0
    v_mfma_f32_16x16x32_bf16 v[204:207], a[48:51], v[140:143], v[224:227]
    ds_read_b64_tr_b16 a[96:97], v249 offset:2240
    ds_read_b64_tr_b16 a[98:99], v249 offset:2752
    v_mfma_f32_16x16x32_bf16 v[204:207], a[52:55], v[136:139], v[204:207]
    ds_read_b64_tr_b16 a[100:101], v249 offset:19776
    ds_read_b64_tr_b16 a[102:103], v249 offset:20288
    v_mfma_f32_16x16x32_bf16 v[204:207], a[56:59], v[132:135], v[204:207]
    buffer_load_dwordx4 v250, s[12:15], s23 offen offset:2176 lds
    v_mfma_f32_16x16x32_bf16 v[204:207], a[60:63], v[128:131], v[204:207]
    ds_read_b64_tr_b16 a[104:105], v249 offset:19792
    ds_read_b64_tr_b16 a[106:107], v249 offset:20304
    v_exp_f32 v192, v192
    v_exp_f32 v193, v193
    v_exp_f32 v194, v194
    v_cvt_pk_bf16_f32 v212, v192, v193
    v_exp_f32 v195, v195
    v_exp_f32_e64 v196, v196
    v_cvt_pk_bf16_f32 v213, v194, v195
    v_mfma_f32_16x16x32_bf16 v[192:195], a[0:3], v[144:147], v[228:231]
    ds_read_b64_tr_b16 a[108:109], v249 offset:2256
    ds_read_b64_tr_b16 a[110:111], v249 offset:2768
    v_mfma_f32_16x16x32_bf16 v[192:195], a[4:7], v[148:151], v[192:195]
    v_exp_f32_e64 v197, v197
    v_mfma_f32_16x16x32_bf16 v[192:195], a[8:11], v[152:155], v[192:195]
    ds_read_b64_tr_b16 a[112:113], v249 offset:2272
    ds_read_b64_tr_b16 a[114:115], v249 offset:2784
    v_mfma_f32_16x16x32_bf16 v[192:195], a[12:15], v[156:159], v[192:195]
    ds_read_b64_tr_b16 a[116:117], v249 offset:19808
    ds_read_b64_tr_b16 a[118:119], v249 offset:20320
    v_exp_f32 v198, v198
    v_cvt_pk_bf16_f32 v214, v196, v197
    v_exp_f32 v199, v199
    v_exp_f32_e64 v200, v200
    v_cvt_pk_bf16_f32 v215, v198, v199
    v_mfma_f32_16x16x32_bf16 v[196:199], a[16:19], v[156:159], v[228:231]
    buffer_load_dwordx4 v252, s[12:15], s23 offen offset:3216 lds
    v_mfma_f32_16x16x32_bf16 v[196:199], a[20:23], v[152:155], v[196:199]
    ds_read_b64_tr_b16 a[120:121], v249 offset:19824
    ds_read_b64_tr_b16 a[122:123], v249 offset:20336
    v_mfma_f32_16x16x32_bf16 v[196:199], a[24:27], v[148:151], v[196:199]
    ds_read_b64_tr_b16 a[124:125], v249 offset:2288
    ds_read_b64_tr_b16 a[126:127], v249 offset:2800
    v_mfma_f32_16x16x32_bf16 v[196:199], a[28:31], v[144:147], v[196:199]
    v_exp_f32 v201, v201
    v_exp_f32 v202, v202
    v_cvt_pk_bf16_f32 v208, v200, v201
    v_exp_f32_e64 v203, v203
    v_exp_f32_e64 v204, v204
    v_cvt_pk_bf16_f32 v209, v202, v203
    v_mfma_f32_16x16x32_bf16 v[200:203], a[32:35], v[144:147], v[228:231]
    v_exp_f32_e64 v205, v205
    v_mfma_f32_16x16x32_bf16 v[200:203], a[36:39], v[148:151], v[200:203]
    v_exp_f32_e64 v206, v206
    v_mfma_f32_16x16x32_bf16 v[200:203], a[40:43], v[152:155], v[200:203]
    v_cvt_pk_bf16_f32 v210, v204, v205
    v_exp_f32_e64 v207, v207
    v_mfma_f32_16x16x32_bf16 v[200:203], a[44:47], v[156:159], v[200:203]
    v_cvt_pk_bf16_f32 v211, v206, v207
    v_exp_f32_e64 v192, v192
    v_mfma_f32_16x16x32_bf16 v[204:207], a[48:51], v[156:159], v[228:231]
    v_exp_f32_e64 v193, v193
    v_mfma_f32_16x16x32_bf16 v[204:207], a[52:55], v[152:155], v[204:207]
    v_exp_f32 v194, v194
    v_add_u32_e64 v248, s35, v248
    v_mfma_f32_16x16x32_bf16 v[204:207], a[56:59], v[148:151], v[204:207]
    s_waitcnt vmcnt(20)
    v_cvt_pk_bf16_f32 v216, v192, v193
    s_waitcnt lgkmcnt(0)
    v_mfma_f32_16x16x32_bf16 v[204:207], a[60:63], v[144:147], v[204:207]
    s_barrier
    v_exp_f32_e64 v195, v195
    v_mfma_f32_16x16x32_bf16 v[0:3], v[212:215], a[64:67], 0
    s_mov_b32 s22, s24
    s_add_u32 s23, s24, s25
    ds_read_b128 a[0:3], v248 offset:0
    v_mfma_f32_16x16x32_bf16 v[0:3], v[208:211], a[68:71], v[0:3]
    s_add_u32 s24, s23, s25
    s_mov_b32 s32, s31
    ds_read_b128 a[4:7], v248 offset:64
    v_mfma_f32_16x16x32_bf16 v[4:7], v[208:211], a[72:75], 0
    s_mov_b32 m0, s31
    ds_read_b128 a[8:11], v248 offset:128
    v_exp_f32 v196, v196
    v_mfma_f32_16x16x32_bf16 v[4:7], v[212:215], a[76:79], v[4:7]
    ds_read_b128 a[12:15], v248 offset:192
    buffer_load_dwordx4 v250, s[8:11], s22 offen offset:0 lds
    v_mfma_f32_16x16x32_bf16 v[8:11], v[212:215], a[80:83], 0
    ds_read_b128 a[16:19], v248 offset:704
    v_cvt_pk_bf16_f32 v217, v194, v195
    v_mfma_f32_16x16x32_bf16 v[8:11], v[208:211], a[84:87], v[8:11]
    ds_read_b128 a[20:23], v248 offset:640
    v_exp_f32_e64 v197, v197
    v_mfma_f32_16x16x32_bf16 v[12:15], v[208:211], a[88:91], 0
    ds_read_b128 a[24:27], v248 offset:576
    v_exp_f32_e64 v198, v198
    v_mfma_f32_16x16x32_bf16 v[12:15], v[212:215], a[92:95], v[12:15]
    ds_read_b128 a[28:31], v248 offset:512
    buffer_load_dwordx4 v251, s[8:11], s22 offen offset:1152 lds
    v_mfma_f32_16x16x32_bf16 v[16:19], v[212:215], a[96:99], 0
    ds_read_b128 a[32:35], v248 offset:17536
    v_cvt_pk_bf16_f32 v218, v196, v197
    v_mfma_f32_16x16x32_bf16 v[16:19], v[208:211], a[100:103], v[16:19]
    ds_read_b128 a[36:39], v248 offset:17600
    v_exp_f32_e64 v199, v199
    v_mfma_f32_16x16x32_bf16 v[20:23], v[208:211], a[104:107], 0
    ds_read_b128 a[40:43], v248 offset:17664
    v_exp_f32_e64 v200, v200
    v_mfma_f32_16x16x32_bf16 v[20:23], v[212:215], a[108:111], v[20:23]
    ds_read_b128 a[44:47], v248 offset:17728
    buffer_load_dwordx4 v250, s[12:15], s22 offen offset:2176 lds
    v_mfma_f32_16x16x32_bf16 v[24:27], v[212:215], a[112:115], 0
    ds_read_b128 a[48:51], v248 offset:18240
    v_cvt_pk_bf16_f32 v219, v198, v199
    v_mfma_f32_16x16x32_bf16 v[24:27], v[208:211], a[116:119], v[24:27]
    ds_read_b128 a[52:55], v248 offset:18176
    v_exp_f32_e64 v201, v201
    v_mfma_f32_16x16x32_bf16 v[28:31], v[208:211], a[120:123], 0
    ds_read_b128 a[56:59], v248 offset:18112
    v_exp_f32_e64 v202, v202
    v_mfma_f32_16x16x32_bf16 v[28:31], v[212:215], a[124:127], v[28:31]
    ds_read_b128 a[60:63], v248 offset:18048
    buffer_load_dwordx4 v252, s[12:15], s22 offen offset:3216 lds
    v_smfmac_f32_16x16x64_bf16 v[240:243], a[148:151], v[208:215], v255
    s_waitcnt lgkmcnt(12)
    v_cvt_pk_bf16_f32 v220, v200, v201
    v_mfma_f32_16x16x32_bf16 v[192:195], a[0:3], v[128:131], v[224:227]
    v_exp_f32 v203, v203
    v_mfma_f32_16x16x32_bf16 v[192:195], a[4:7], v[132:135], v[192:195]
    s_addk_i32 s32, 17536
    s_mov_b32 m0, s32
    v_add_u32_e64 v249, s35, v249
    v_mfma_f32_16x16x32_bf16 v[192:195], a[8:11], v[136:139], v[192:195]
    s_mov_b32 s14, 0x13da880
    v_exp_f32 v204, v204
    v_mfma_f32_16x16x32_bf16 v[192:195], a[12:15], v[140:143], v[192:195]
    s_waitcnt lgkmcnt(8)
    buffer_load_dwordx4 v250, s[8:11], s23 offen offset:0 lds
    v_mfma_f32_16x16x32_bf16 v[196:199], a[16:19], v[140:143], v[224:227]
    v_cvt_pk_bf16_f32 v221, v202, v203
    v_exp_f32 v205, v205
    v_mfma_f32_16x16x32_bf16 v[196:199], a[20:23], v[136:139], v[196:199]
    v_exp_f32 v206, v206
    v_mfma_f32_16x16x32_bf16 v[196:199], a[24:27], v[132:135], v[196:199]
    v_cvt_pk_bf16_f32 v222, v204, v205
    v_exp_f32 v207, v207
    v_mfma_f32_16x16x32_bf16 v[196:199], a[28:31], v[128:131], v[196:199]
    s_waitcnt lgkmcnt(4)
    buffer_load_dwordx4 v251, s[8:11], s23 offen offset:1152 lds
    v_mfma_f32_16x16x32_bf16 v[200:203], a[32:35], v[128:131], v[224:227]
    v_cvt_pk_bf16_f32 v223, v206, v207
    v_exp_f32 v192, v192
    v_mfma_f32_16x16x32_bf16 v[200:203], a[36:39], v[132:135], v[200:203]
    v_exp_f32 v193, v193
    v_mfma_f32_16x16x32_bf16 v[200:203], a[40:43], v[136:139], v[200:203]
    v_exp_f32 v194, v194
    v_mfma_f32_16x16x32_bf16 v[200:203], a[44:47], v[140:143], v[200:203]
    s_waitcnt lgkmcnt(0)
    buffer_load_dwordx4 v250, s[12:15], s23 offen offset:2176 lds
    v_mfma_f32_16x16x32_bf16 v[204:207], a[48:51], v[140:143], v[224:227]
    v_exp_f32_e64 v195, v195
    v_mfma_f32_16x16x32_bf16 v[204:207], a[52:55], v[136:139], v[204:207]
    v_cvt_pk_bf16_f32 v212, v192, v193
    v_cvt_pk_bf16_f32 v213, v194, v195
    v_mfma_f32_16x16x32_bf16 v[204:207], a[56:59], v[132:135], v[204:207]
    v_exp_f32_e64 v196, v196
    v_mfma_f32_16x16x32_bf16 v[204:207], a[60:63], v[128:131], v[204:207]
    buffer_load_dwordx4 v252, s[12:15], s23 offen offset:3216 lds
    v_mfma_f32_16x16x32_bf16 v[32:35], v[216:219], a[64:67], 0
    ds_read_b64_tr_b16 a[64:65], v249 offset:2176
    ds_read_b64_tr_b16 a[66:67], v249 offset:2688
    v_mfma_f32_16x16x32_bf16 v[32:35], v[220:223], a[68:71], v[32:35]
    v_exp_f32_e64 v197, v197
    v_mfma_f32_16x16x32_bf16 v[36:39], v[220:223], a[72:75], 0
    ds_read_b64_tr_b16 a[68:69], v249 offset:19712
    ds_read_b64_tr_b16 a[70:71], v249 offset:20224
    v_mfma_f32_16x16x32_bf16 v[36:39], v[216:219], a[76:79], v[36:39]
    v_exp_f32_e64 v198, v198
    v_mfma_f32_16x16x32_bf16 v[40:43], v[216:219], a[80:83], 0
    ds_read_b64_tr_b16 a[72:73], v249 offset:19728
    ds_read_b64_tr_b16 a[74:75], v249 offset:20240
    v_mfma_f32_16x16x32_bf16 v[40:43], v[220:223], a[84:87], v[40:43]
    v_exp_f32_e64 v199, v199
    v_mfma_f32_16x16x32_bf16 v[44:47], v[220:223], a[88:91], 0
    ds_read_b64_tr_b16 a[76:77], v249 offset:2192
    ds_read_b64_tr_b16 a[78:79], v249 offset:2704
    v_mfma_f32_16x16x32_bf16 v[44:47], v[216:219], a[92:95], v[44:47]
    v_cvt_pk_bf16_f32 v214, v196, v197
    v_cvt_pk_bf16_f32 v215, v198, v199
    v_mfma_f32_16x16x32_bf16 v[48:51], v[216:219], a[96:99], 0
    ds_read_b64_tr_b16 a[80:81], v249 offset:2208
    ds_read_b64_tr_b16 a[82:83], v249 offset:2720
    v_mfma_f32_16x16x32_bf16 v[48:51], v[220:223], a[100:103], v[48:51]
    v_exp_f32_e64 v200, v200
    v_mfma_f32_16x16x32_bf16 v[52:55], v[220:223], a[104:107], 0
    ds_read_b64_tr_b16 a[84:85], v249 offset:19744
    ds_read_b64_tr_b16 a[86:87], v249 offset:20256
    v_mfma_f32_16x16x32_bf16 v[52:55], v[216:219], a[108:111], v[52:55]
    v_exp_f32_e64 v201, v201
    v_mfma_f32_16x16x32_bf16 v[56:59], v[216:219], a[112:115], 0
    ds_read_b64_tr_b16 a[88:89], v249 offset:19760
    ds_read_b64_tr_b16 a[90:91], v249 offset:20272
    v_mfma_f32_16x16x32_bf16 v[56:59], v[220:223], a[116:119], v[56:59]
    v_cvt_pk_bf16_f32 v208, v200, v201
    v_exp_f32_e64 v202, v202
    v_mfma_f32_16x16x32_bf16 v[60:63], v[220:223], a[120:123], 0
    ds_read_b64_tr_b16 a[92:93], v249 offset:2224
    ds_read_b64_tr_b16 a[94:95], v249 offset:2736
    v_mfma_f32_16x16x32_bf16 v[60:63], v[216:219], a[124:127], v[60:63]
    v_exp_f32_e64 v203, v203
    v_smfmac_f32_16x16x64_bf16 v[240:243], a[152:155], v[216:223], v255
.p2align 5
L_loop_2:
    v_mfma_f32_16x16x32_bf16 v[192:195], a[0:3], v[144:147], v[228:231]
    s_add_u32 s31, s30, s33
    ds_read_b64_tr_b16 a[96:97], v249 offset:2240
    ds_read_b64_tr_b16 a[98:99], v249 offset:2752
    v_cvt_pk_bf16_f32 v209, v202, v203
    v_mfma_f32_16x16x32_bf16 v[192:195], a[4:7], v[148:151], v[192:195]
    s_add_u32 s30, s30, s80
    ds_read_b64_tr_b16 a[100:101], v249 offset:19776
    ds_read_b64_tr_b16 a[102:103], v249 offset:20288
    v_mfma_f32_16x16x32_bf16 v[192:195], a[8:11], v[152:155], v[192:195]
    s_cmp_eq_u32 s30, 105216
    ds_read_b64_tr_b16 a[104:105], v249 offset:19792
    ds_read_b64_tr_b16 a[106:107], v249 offset:20304
    v_mfma_f32_16x16x32_bf16 v[192:195], a[12:15], v[156:159], v[192:195]
    s_cmov_b32 s30, 0
    ds_read_b64_tr_b16 a[108:109], v249 offset:2256
    ds_read_b64_tr_b16 a[110:111], v249 offset:2768
    v_mfma_f32_16x16x32_bf16 v[196:199], a[16:19], v[156:159], v[228:231]
    s_cselect_b32 s35, s81, s80
    ds_read_b64_tr_b16 a[112:113], v249 offset:2272
    ds_read_b64_tr_b16 a[114:115], v249 offset:2784
    v_mfma_f32_16x16x32_bf16 v[196:199], a[20:23], v[152:155], v[196:199]
    s_mov_b32 s44, s24
    ds_read_b64_tr_b16 a[116:117], v249 offset:19808
    ds_read_b64_tr_b16 a[118:119], v249 offset:20320
    v_mfma_f32_16x16x32_bf16 v[196:199], a[24:27], v[148:151], v[196:199]
    s_add_u32 s45, s24, s25
    ds_read_b64_tr_b16 a[120:121], v249 offset:19824
    ds_read_b64_tr_b16 a[122:123], v249 offset:20336
    v_mfma_f32_16x16x32_bf16 v[196:199], a[28:31], v[144:147], v[196:199]
    s_add_u32 s24, s45, s25
    ds_read_b64_tr_b16 a[124:125], v249 offset:2288
    ds_read_b64_tr_b16 a[126:127], v249 offset:2800
    v_mfma_f32_16x16x32_bf16 v[200:203], a[32:35], v[144:147], v[228:231]
    s_cmp_eq_u32 s34, 2
    v_exp_f32 v204, v204
    v_mfma_f32_16x16x32_bf16 v[200:203], a[36:39], v[148:151], v[200:203]
    s_cmov_b32 s45, 2.0
    v_exp_f32 v205, v205
    v_exp_f32 v206, v206
    v_exp_f32 v207, v207
    v_mfma_f32_16x16x32_bf16 v[200:203], a[40:43], v[152:155], v[200:203]
    s_cmp_eq_u32 s34, 1
    v_cvt_pk_bf16_f32 v210, v204, v205
    v_cvt_pk_bf16_f32 v211, v206, v207
    v_mfma_f32_16x16x32_bf16 v[200:203], a[44:47], v[156:159], v[200:203]
    s_cmov_b64 s[44:45], s[26:27]
    v_exp_f32 v192, v192
    v_mfma_f32_16x16x32_bf16 v[204:207], a[48:51], v[156:159], v[228:231]
    s_cmov_b64 s[24:25], s[28:29]
    v_exp_f32 v193, v193
    v_mfma_f32_16x16x32_bf16 v[204:207], a[52:55], v[152:155], v[204:207]
    s_cselect_b32 s46, s78, 0x13da880
    v_exp_f32 v194, v194
    v_mfma_f32_16x16x32_bf16 v[204:207], a[56:59], v[148:151], v[204:207]
    s_mov_b64 s[22:23], s[44:45]
    s_mov_b32 s14, s46
    v_add_u32 v248, s35, v248
    v_cvt_pk_bf16_f32 v216, v192, v193
    v_mfma_f32_16x16x32_bf16 v[204:207], a[60:63], v[144:147], v[204:207]
    s_waitcnt vmcnt(8) lgkmcnt(0)
    v_exp_f32 v195, v195
    v_mfma_f32_16x16x32_bf16 v[0:3], v[212:215], a[64:67], v[0:3]
    s_barrier
    v_mfma_f32_16x16x32_bf16 v[0:3], v[208:211], a[68:71], v[0:3]
    s_mov_b32 s32, s31
    v_cvt_pk_bf16_f32 v217, v194, v195
    v_add_u32 v249, s35, v249
    v_mfma_f32_16x16x32_bf16 v[4:7], v[208:211], a[72:75], v[4:7]
    s_mov_b32 m0, s31
    ds_read_b128 a[0:3], v248 offset:0
    ds_read_b128 a[4:7], v248 offset:64
    v_mfma_f32_16x16x32_bf16 v[4:7], v[212:215], a[76:79], v[4:7]
    buffer_load_dwordx4 v250, s[8:11], s22 offen offset:0 lds
    v_mfma_f32_16x16x32_bf16 v[8:11], v[212:215], a[80:83], v[8:11]
    v_exp_f32 v196, v196
    v_mfma_f32_16x16x32_bf16 v[8:11], v[208:211], a[84:87], v[8:11]
    ds_read_b128 a[8:11], v248 offset:128
    ds_read_b128 a[12:15], v248 offset:192
    v_mfma_f32_16x16x32_bf16 v[12:15], v[208:211], a[88:91], v[12:15]
    v_exp_f32 v197, v197
    v_mfma_f32_16x16x32_bf16 v[12:15], v[212:215], a[92:95], v[12:15]
    v_exp_f32 v198, v198
    v_mfma_f32_16x16x32_bf16 v[16:19], v[212:215], a[96:99], v[16:19]
    ds_read_b128 a[16:19], v248 offset:704
    ds_read_b128 a[20:23], v248 offset:640
    v_mfma_f32_16x16x32_bf16 v[16:19], v[208:211], a[100:103], v[16:19]
    buffer_load_dwordx4 v251, s[8:11], s22 offen offset:1152 lds
    v_mfma_f32_16x16x32_bf16 v[20:23], v[208:211], a[104:107], v[20:23]
    v_exp_f32 v199, v199
    v_mfma_f32_16x16x32_bf16 v[20:23], v[212:215], a[108:111], v[20:23]
    ds_read_b128 a[24:27], v248 offset:576
    ds_read_b128 a[28:31], v248 offset:512
    v_mfma_f32_16x16x32_bf16 v[24:27], v[212:215], a[112:115], v[24:27]
    v_cvt_pk_bf16_f32 v218, v196, v197
    v_cvt_pk_bf16_f32 v219, v198, v199
    v_mfma_f32_16x16x32_bf16 v[24:27], v[208:211], a[116:119], v[24:27]
    v_exp_f32 v200, v200
    v_mfma_f32_16x16x32_bf16 v[28:31], v[208:211], a[120:123], v[28:31]
    ds_read_b128 a[32:35], v248 offset:17536
    ds_read_b128 a[36:39], v248 offset:17600
    v_mfma_f32_16x16x32_bf16 v[28:31], v[212:215], a[124:127], v[28:31]
    v_exp_f32 v201, v201
    v_smfmac_f32_16x16x64_bf16 v[240:243], a[132:135], v[208:215], v255
    s_waitcnt lgkmcnt(6)
    v_cvt_pk_bf16_f32 v220, v200, v201
    v_mfma_f32_16x16x32_bf16 v[192:195], a[0:3], v[128:131], v[224:227]
    ds_read_b128 a[40:43], v248 offset:17664
    ds_read_b128 a[44:47], v248 offset:17728
    v_mfma_f32_16x16x32_bf16 v[192:195], a[4:7], v[132:135], v[192:195]
    buffer_load_dwordx4 v250, s[12:15], s22 offen offset:2176 lds
    v_mfma_f32_16x16x32_bf16 v[192:195], a[8:11], v[136:139], v[192:195]
    v_exp_f32 v202, v202
    v_exp_f32 v203, v203
    v_mfma_f32_16x16x32_bf16 v[192:195], a[12:15], v[140:143], v[192:195]
    s_waitcnt lgkmcnt(5)
    ds_read_b128 a[48:51], v248 offset:18240
    ds_read_b128 a[52:55], v248 offset:18176
    v_cvt_pk_bf16_f32 v221, v202, v203
    v_mfma_f32_16x16x32_bf16 v[196:199], a[16:19], v[140:143], v[224:227]
    buffer_load_dwordx4 v252, s[12:15], s22 offen offset:3216 lds
    v_exp_f32 v204, v204
    v_mfma_f32_16x16x32_bf16 v[196:199], a[20:23], v[136:139], v[196:199]
    s_cmp_eq_u32 s34, 0
    v_exp_f32 v192, v192
    v_exp_f32 v205, v205
    v_mfma_f32_16x16x32_bf16 v[196:199], a[24:27], v[132:135], v[196:199]
    s_waitcnt lgkmcnt(2)
    ds_read_b128 a[56:59], v248 offset:18112
    ds_read_b128 a[60:63], v248 offset:18048
    v_exp_f32 v206, v206
    v_mfma_f32_16x16x32_bf16 v[196:199], a[28:31], v[128:131], v[196:199]
    s_cbranch_scc1 L_laste_2
    v_exp_f32 v193, v193
    v_exp_f32 v207, v207
    v_mfma_f32_16x16x32_bf16 v[200:203], a[32:35], v[128:131], v[224:227]
    s_addk_i32 s32, 17536
    v_exp_f32 v194, v194
    v_cvt_pk_bf16_f32 v222, v204, v205
    v_mfma_f32_16x16x32_bf16 v[200:203], a[36:39], v[132:135], v[200:203]
    s_mov_b32 m0, s32
    v_exp_f32 v195, v195
    v_cvt_pk_bf16_f32 v223, v206, v207
    v_mfma_f32_16x16x32_bf16 v[200:203], a[40:43], v[136:139], v[200:203]
    s_mov_b32 s14, 0x13da880
    v_cvt_pk_bf16_f32 v212, v192, v193
    v_cvt_pk_bf16_f32 v213, v194, v195
    v_mfma_f32_16x16x32_bf16 v[200:203], a[44:47], v[140:143], v[200:203]
    s_waitcnt lgkmcnt(0)
    buffer_load_dwordx4 v250, s[8:11], s23 offen offset:0 lds
    v_mfma_f32_16x16x32_bf16 v[204:207], a[48:51], v[140:143], v[224:227]
    v_exp_f32 v196, v196
    v_mfma_f32_16x16x32_bf16 v[204:207], a[52:55], v[136:139], v[204:207]
    v_exp_f32 v197, v197
    v_mfma_f32_16x16x32_bf16 v[204:207], a[56:59], v[132:135], v[204:207]
    v_exp_f32 v198, v198
    v_mfma_f32_16x16x32_bf16 v[204:207], a[60:63], v[128:131], v[204:207]
    v_exp_f32 v199, v199
    v_mfma_f32_16x16x32_bf16 v[32:35], v[216:219], a[64:67], v[32:35]
    ds_read_b64_tr_b16 a[64:65], v249 offset:2176
    ds_read_b64_tr_b16 a[66:67], v249 offset:2688
    v_mfma_f32_16x16x32_bf16 v[32:35], v[220:223], a[68:71], v[32:35]
    buffer_load_dwordx4 v251, s[8:11], s23 offen offset:1152 lds
    v_mfma_f32_16x16x32_bf16 v[36:39], v[220:223], a[72:75], v[36:39]
    ds_read_b64_tr_b16 a[68:69], v249 offset:19712
    ds_read_b64_tr_b16 a[70:71], v249 offset:20224
    v_mfma_f32_16x16x32_bf16 v[36:39], v[216:219], a[76:79], v[36:39]
    v_cvt_pk_bf16_f32 v214, v196, v197
    v_cvt_pk_bf16_f32 v215, v198, v199
    v_mfma_f32_16x16x32_bf16 v[40:43], v[216:219], a[80:83], v[40:43]
    ds_read_b64_tr_b16 a[72:73], v249 offset:19728
    ds_read_b64_tr_b16 a[74:75], v249 offset:20240
    v_mfma_f32_16x16x32_bf16 v[40:43], v[220:223], a[84:87], v[40:43]
    buffer_load_dwordx4 v250, s[12:15], s23 offen offset:2176 lds
    v_mfma_f32_16x16x32_bf16 v[44:47], v[220:223], a[88:91], v[44:47]
    ds_read_b64_tr_b16 a[76:77], v249 offset:2192
    ds_read_b64_tr_b16 a[78:79], v249 offset:2704
    v_mfma_f32_16x16x32_bf16 v[44:47], v[216:219], a[92:95], v[44:47]
    v_exp_f32 v200, v200
    v_mfma_f32_16x16x32_bf16 v[48:51], v[216:219], a[96:99], v[48:51]
    ds_read_b64_tr_b16 a[80:81], v249 offset:2208
    ds_read_b64_tr_b16 a[82:83], v249 offset:2720
    v_mfma_f32_16x16x32_bf16 v[48:51], v[220:223], a[100:103], v[48:51]
    v_exp_f32 v201, v201
    v_mfma_f32_16x16x32_bf16 v[52:55], v[220:223], a[104:107], v[52:55]
    ds_read_b64_tr_b16 a[84:85], v249 offset:19744
    ds_read_b64_tr_b16 a[86:87], v249 offset:20256
    v_cvt_pk_bf16_f32 v208, v200, v201
    v_mfma_f32_16x16x32_bf16 v[52:55], v[216:219], a[108:111], v[52:55]
    buffer_load_dwordx4 v252, s[12:15], s23 offen offset:3216 lds
    v_mfma_f32_16x16x32_bf16 v[56:59], v[216:219], a[112:115], v[56:59]
    s_sub_u32 s34, s34, 1
    ds_read_b64_tr_b16 a[88:89], v249 offset:19760
    ds_read_b64_tr_b16 a[90:91], v249 offset:20272
    v_mfma_f32_16x16x32_bf16 v[56:59], v[220:223], a[116:119], v[56:59]
    v_exp_f32 v202, v202
    v_mfma_f32_16x16x32_bf16 v[60:63], v[220:223], a[120:123], v[60:63]
    ds_read_b64_tr_b16 a[92:93], v249 offset:2224
    ds_read_b64_tr_b16 a[94:95], v249 offset:2736
    v_mfma_f32_16x16x32_bf16 v[60:63], v[216:219], a[124:127], v[60:63]
    v_exp_f32 v203, v203
    v_smfmac_f32_16x16x64_bf16 v[240:243], a[136:139], v[216:223], v255
    s_branch L_loop_2
.p2align 12
.p2align 5
P_laste_3:
    s_setpc_b64 s[62:63]
.fill 1, 4, 0xbf800000
L_laste_3:
    v_exp_f32 v194, v194
    v_mfma_f32_16x16x32_bf16 v[200:203], a[0:3], v[144:147], v[228:231]
    v_exp_f32 v195, v195
    v_mfma_f32_16x16x32_bf16 v[200:203], a[4:7], v[148:151], v[200:203]
    v_cvt_pk_bf16_f32 v100, v192, v193
    v_cvt_pk_bf16_f32 v101, v194, v195
    v_mfma_f32_16x16x32_bf16 v[200:203], a[8:11], v[152:155], v[200:203]
    v_exp_f32_e64 v196, v196
    v_mfma_f32_16x16x32_bf16 v[200:203], a[12:15], v[156:159], v[200:203]
    v_exp_f32 v197, v197
    v_mfma_f32_16x16x32_bf16 v[204:207], a[16:19], v[156:159], v[228:231]
    v_exp_f32 v198, v198
    v_mfma_f32_16x16x32_bf16 v[204:207], a[20:23], v[152:155], v[204:207]
    v_exp_f32_e64 v199, v199
    v_mfma_f32_16x16x32_bf16 v[204:207], a[24:27], v[148:151], v[204:207]
    v_cvt_pk_bf16_f32 v102, v196, v197
    v_cvt_pk_bf16_f32 v103, v198, v199
    v_mfma_f32_16x16x32_bf16 v[204:207], a[28:31], v[144:147], v[204:207]
    v_exp_f32_e64 v200, v200
    v_mfma_f32_16x16x32_bf16 v[64:67], v[116:119], a[64:67], v[64:67]
    ds_read_b64_tr_b16 a[64:65], v249 offset:2176
    ds_read_b64_tr_b16 a[66:67], v249 offset:2688
    v_mfma_f32_16x16x32_bf16 v[64:67], v[112:115], a[68:71], v[64:67]
    v_exp_f32 v201, v201
    v_mfma_f32_16x16x32_bf16 v[68:71], v[112:115], a[72:75], v[68:71]
    v_exp_f32 v202, v202
    v_mfma_f32_16x16x32_bf16 v[68:71], v[116:119], a[76:79], v[68:71]
    ds_read_b64_tr_b16 a[76:77], v249 offset:2192
    ds_read_b64_tr_b16 a[78:79], v249 offset:2704
    v_mfma_f32_16x16x32_bf16 v[72:75], v[116:119], a[80:83], v[72:75]
    ds_read_b64_tr_b16 a[80:81], v249 offset:2208
    ds_read_b64_tr_b16 a[82:83], v249 offset:2720
    v_mfma_f32_16x16x32_bf16 v[72:75], v[112:115], a[84:87], v[72:75]
    v_exp_f32_e64 v203, v203
    v_mfma_f32_16x16x32_bf16 v[76:79], v[112:115], a[88:91], v[76:79]
    v_exp_f32_e64 v204, v204
    v_mfma_f32_16x16x32_bf16 v[76:79], v[116:119], a[92:95], v[76:79]
    ds_read_b64_tr_b16 a[92:93], v249 offset:2224
    ds_read_b64_tr_b16 a[94:95], v249 offset:2736
    v_mfma_f32_16x16x32_bf16 v[80:83], v[116:119], a[96:99], v[80:83]
    ds_read_b64_tr_b16 a[96:97], v249 offset:2240
    ds_read_b64_tr_b16 a[98:99], v249 offset:2752
    v_mfma_f32_16x16x32_bf16 v[80:83], v[112:115], a[100:103], v[80:83]
    v_exp_f32 v205, v205
    v_mfma_f32_16x16x32_bf16 v[84:87], v[112:115], a[104:107], v[84:87]
    v_exp_f32 v206, v206
    v_mfma_f32_16x16x32_bf16 v[84:87], v[116:119], a[108:111], v[84:87]
    ds_read_b64_tr_b16 a[108:109], v249 offset:2256
    ds_read_b64_tr_b16 a[110:111], v249 offset:2768
    v_mfma_f32_16x16x32_bf16 v[88:91], v[116:119], a[112:115], v[88:91]
    ds_read_b64_tr_b16 a[112:113], v249 offset:2272
    ds_read_b64_tr_b16 a[114:115], v249 offset:2784
    v_mfma_f32_16x16x32_bf16 v[88:91], v[112:115], a[116:119], v[88:91]
    v_exp_f32_e64 v207, v207
    v_mfma_f32_16x16x32_bf16 v[92:95], v[112:115], a[120:123], v[92:95]
    v_accvgpr_read_b32 v208, a164
    v_mfma_f32_16x16x32_bf16 v[92:95], v[116:119], a[124:127], v[92:95]
    ds_read_b64_tr_b16 a[124:125], v249 offset:2288
    ds_read_b64_tr_b16 a[126:127], v249 offset:2800
    v_smfmac_f32_16x16x64_bf16 v[244:247], a[132:135], v[112:119], v255
    s_mov_b32 s40, s73
    v_mov_b32_e64 v112, 0
    v_smfmac_f32_16x16x64_bf16 v[240:243], a[168:171], v[100:107], v255
    s_waitcnt lgkmcnt(4)
    v_mov_b32_e64 v113, 0
    v_mfma_f32_16x16x32_bf16 v[0:3], v[100:103], a[64:67], v[0:3]
    v_mov_b32_e64 v114, 0
    v_mov_b32_e64 v115, 0
    v_mfma_f32_16x16x32_bf16 v[4:7], v[100:103], a[76:79], v[4:7]
    v_add_f32_e64 v209, v240, v241
    v_subrev_u32 v210, 0x37800000, v209
    v_mfma_f32_16x16x32_bf16 v[8:11], v[100:103], a[80:83], v[8:11]
    v_rcp_f32_e64 v209, v209
    v_mfma_f32_16x16x32_bf16 v[12:15], v[100:103], a[92:95], v[12:15]
    v_cmp_lt_u32 s[66:67], s79, v210
    v_mov_b32_dpp v209, v209 row_ror:12 row_mask:0xa bank_mask:0xf
    v_mfma_f32_16x16x32_bf16 v[16:19], v[100:103], a[96:99], v[16:19]
    s_or_b64 s[64:65], s[64:65], s[66:67]
    v_mov_b32_dpp v209, v209 row_ror:8 row_mask:0xc bank_mask:0xf
    v_mfma_f32_16x16x32_bf16 v[20:23], v[100:103], a[108:111], v[20:23]
    s_waitcnt lgkmcnt(0)
    v_mov_b32_dpp v220, v209 row_newbcast:0 row_mask:0xf bank_mask:0xf
    v_mov_b32_dpp v221, v209 row_newbcast:1 row_mask:0xf bank_mask:0xf
    v_mfma_f32_16x16x32_bf16 v[24:27], v[100:103], a[112:115], v[24:27]
    v_mov_b32_dpp v222, v209 row_newbcast:2 row_mask:0xf bank_mask:0xf
    v_mov_b32_dpp v223, v209 row_newbcast:3 row_mask:0xf bank_mask:0xf
    v_mfma_f32_16x16x32_bf16 v[28:31], v[100:103], a[124:127], v[28:31]
    v_cvt_pk_bf16_f32 v104, v200, v201
    v_cvt_pk_bf16_f32 v105, v202, v203
    v_cvt_pk_bf16_f32 v106, v204, v205
    v_cvt_pk_bf16_f32 v107, v206, v207
    v_pk_mul_f32 v[0:1], v[0:1], v[220:221]
    v_pk_mul_f32 v[2:3], v[2:3], v[222:223]
    v_pk_mul_f32 v[4:5], v[4:5], v[220:221]
    v_pk_mul_f32 v[6:7], v[6:7], v[222:223]
    v_pk_mul_f32 v[8:9], v[8:9], v[220:221]
    v_pk_mul_f32 v[10:11], v[10:11], v[222:223]
    v_pk_mul_f32 v[12:13], v[12:13], v[220:221]
    v_pk_mul_f32 v[14:15], v[14:15], v[222:223]
    v_pk_mul_f32 v[16:17], v[16:17], v[220:221]
    v_pk_mul_f32 v[18:19], v[18:19], v[222:223]
    v_pk_mul_f32 v[20:21], v[20:21], v[220:221]
    v_pk_mul_f32 v[22:23], v[22:23], v[222:223]
    v_pk_mul_f32 v[24:25], v[24:25], v[220:221]
    v_pk_mul_f32 v[26:27], v[26:27], v[222:223]
    v_pk_mul_f32 v[28:29], v[28:29], v[220:221]
    v_pk_mul_f32 v[30:31], v[30:31], v[222:223]
    v_smfmac_f32_16x16x64_bf16 v[240:243], a[172:175], v[100:107], v255
    v_cvt_pk_bf16_f32 v0, v0, v4
    v_mfma_f32_16x16x32_bf16 v[32:35], v[104:107], a[64:67], v[32:35]
    v_cvt_pk_bf16_f32 v4, v1, v5
    v_cvt_pk_bf16_f32 v1, v8, v12
    v_mfma_f32_16x16x32_bf16 v[36:39], v[104:107], a[76:79], v[36:39]
    v_add_f32_e64 v209, v242, v243
    v_subrev_u32 v210, 0x37800000, v209
    v_mfma_f32_16x16x32_bf16 v[40:43], v[104:107], a[80:83], v[40:43]
    v_rcp_f32_e64 v209, v209
    v_mfma_f32_16x16x32_bf16 v[44:47], v[104:107], a[92:95], v[44:47]
    v_cmp_lt_u32 s[66:67], s79, v210
    v_mov_b32_dpp v209, v209 row_ror:12 row_mask:0xa bank_mask:0xf
    v_mfma_f32_16x16x32_bf16 v[48:51], v[104:107], a[96:99], v[48:51]
    s_or_b64 s[64:65], s[64:65], s[66:67]
    v_cvt_pk_bf16_f32 v5, v9, v13
    v_mov_b32_dpp v209, v209 row_ror:8 row_mask:0xc bank_mask:0xf
    v_mfma_f32_16x16x32_bf16 v[52:55], v[104:107], a[108:111], v[52:55]
    s_nop 0
    v_mov_b32_dpp v220, v209 row_newbcast:0 row_mask:0xf bank_mask:0xf
    v_mov_b32_dpp v221, v209 row_newbcast:1 row_mask:0xf bank_mask:0xf
    v_mfma_f32_16x16x32_bf16 v[56:59], v[104:107], a[112:115], v[56:59]
    v_mov_b32_dpp v222, v209 row_newbcast:2 row_mask:0xf bank_mask:0xf
    v_mov_b32_dpp v223, v209 row_newbcast:3 row_mask:0xf bank_mask:0xf
    v_mfma_f32_16x16x32_bf16 v[60:63], v[104:107], a[124:127], v[60:63]
    v_cvt_pk_bf16_f32 v8, v2, v6
    v_cvt_pk_bf16_f32 v12, v3, v7
    v_cvt_pk_bf16_f32 v9, v10, v14
    v_cvt_pk_bf16_f32 v13, v11, v15
    v_cvt_pk_bf16_f32 v2, v16, v20
    v_cvt_pk_bf16_f32 v6, v17, v21
    v_cvt_pk_bf16_f32 v10, v18, v22
    v_cvt_pk_bf16_f32 v14, v19, v23
    v_pk_mul_f32 v[32:33], v[32:33], v[220:221]
    v_mfma_f32_4x4x4_16b_bf16 v[16:19], v[0:1], a[160:161], 0 cbsz:1 abid:0
    v_cvt_pk_bf16_f32 v3, v24, v28
    v_mfma_f32_4x4x4_16b_bf16 v[20:23], v[0:1], a[160:161], 0 cbsz:1 abid:1
    v_cvt_pk_bf16_f32 v7, v25, v29
    v_cvt_pk_bf16_f32 v11, v26, v30
    v_mfma_f32_4x4x4_16b_bf16 v[16:19], v[2:3], a[162:163], v[16:19] cbsz:1 abid:0
    v_cvt_pk_bf16_f32 v15, v27, v31
    v_mfma_f32_4x4x4_16b_bf16 v[20:23], v[2:3], a[162:163], v[20:23] cbsz:1 abid:1
    v_mfma_f32_4x4x4_16b_bf16 v[24:27], v[4:5], a[160:161], 0 cbsz:1 abid:0
    v_mfma_f32_4x4x4_16b_bf16 v[28:31], v[4:5], a[160:161], 0 cbsz:1 abid:1
    v_cvt_pk_bf16_f32 v0, v16, v17
    v_mfma_f32_4x4x4_16b_bf16 v[24:27], v[6:7], a[162:163], v[24:27] cbsz:1 abid:0
    v_cvt_pk_bf16_f32 v1, v18, v19
    v_cvt_pk_bf16_f32 v2, v20, v21
    v_cvt_pk_bf16_f32 v3, v22, v23
    v_mfma_f32_4x4x4_16b_bf16 v[28:31], v[6:7], a[162:163], v[28:31] cbsz:1 abid:1
    buffer_store_dwordx4 v[0:3], v208, s[16:19], s40 offen sc1 nt
    s_add_i32 s40, s40, 0x4000
    v_pk_mul_f32 v[34:35], v[34:35], v[222:223]
    v_pk_mul_f32 v[36:37], v[36:37], v[220:221]
    v_mfma_f32_4x4x4_16b_bf16 v[16:19], v[8:9], a[160:161], 0 cbsz:1 abid:0
    v_cvt_pk_bf16_f32 v4, v24, v25
    v_mfma_f32_4x4x4_16b_bf16 v[20:23], v[8:9], a[160:161], 0 cbsz:1 abid:1
    v_cvt_pk_bf16_f32 v5, v26, v27
    v_mfma_f32_4x4x4_16b_bf16 v[16:19], v[10:11], a[162:163], v[16:19] cbsz:1 abid:0
    v_cvt_pk_bf16_f32 v6, v28, v29
    v_cvt_pk_bf16_f32 v7, v30, v31
    v_mfma_f32_4x4x4_16b_bf16 v[20:23], v[10:11], a[162:163], v[20:23] cbsz:1 abid:1
    buffer_store_dwordx4 v[4:7], v208, s[16:19], s40 offen sc1 nt
    s_add_i32 s40, s40, 0x4000
    v_pk_mul_f32 v[38:39], v[38:39], v[222:223]
    v_pk_mul_f32 v[40:41], v[40:41], v[220:221]
    v_mfma_f32_4x4x4_16b_bf16 v[24:27], v[12:13], a[160:161], 0 cbsz:1 abid:0
    v_cvt_pk_bf16_f32 v8, v16, v17
    v_mfma_f32_4x4x4_16b_bf16 v[28:31], v[12:13], a[160:161], 0 cbsz:1 abid:1
    v_cvt_pk_bf16_f32 v9, v18, v19
    v_mfma_f32_4x4x4_16b_bf16 v[24:27], v[14:15], a[162:163], v[24:27] cbsz:1 abid:0
    v_cvt_pk_bf16_f32 v10, v20, v21
    v_cvt_pk_bf16_f32 v11, v22, v23
    v_mfma_f32_4x4x4_16b_bf16 v[28:31], v[14:15], a[162:163], v[28:31] cbsz:1 abid:1
    buffer_store_dwordx4 v[8:11], v208, s[16:19], s40 offen sc1 nt
    s_add_i32 s40, s40, 0x4000
    v_pk_mul_f32 v[42:43], v[42:43], v[222:223]
    v_pk_mul_f32 v[44:45], v[44:45], v[220:221]
    v_pk_mul_f32 v[46:47], v[46:47], v[222:223]
    v_pk_mul_f32 v[48:49], v[48:49], v[220:221]
    v_pk_mul_f32 v[50:51], v[50:51], v[222:223]
    v_pk_mul_f32 v[52:53], v[52:53], v[220:221]
    v_pk_mul_f32 v[54:55], v[54:55], v[222:223]
    v_pk_mul_f32 v[56:57], v[56:57], v[220:221]
    v_pk_mul_f32 v[58:59], v[58:59], v[222:223]
    v_pk_mul_f32 v[60:61], v[60:61], v[220:221]
    v_pk_mul_f32 v[62:63], v[62:63], v[222:223]
    v_mfma_f32_16x16x32_bf16 v[192:195], a[0:3], v[160:163], v[232:235]
    v_cvt_pk_bf16_f32 v12, v24, v25
    v_cvt_pk_bf16_f32 v13, v26, v27
    v_mfma_f32_16x16x32_bf16 v[192:195], a[4:7], v[164:167], v[192:195]
    v_cvt_pk_bf16_f32 v14, v28, v29
    v_cvt_pk_bf16_f32 v15, v30, v31
    v_mfma_f32_16x16x32_bf16 v[192:195], a[8:11], v[168:171], v[192:195]
    buffer_store_dwordx4 v[12:15], v208, s[16:19], s40 offen sc1 nt
    s_add_i32 s40, s40, 0x4000
    v_cvt_pk_bf16_f32 v32, v32, v36
    v_mfma_f32_16x16x32_bf16 v[192:195], a[12:15], v[172:175], v[192:195]
    v_cvt_pk_bf16_f32 v36, v33, v37
    v_cvt_pk_bf16_f32 v33, v40, v44
    v_mfma_f32_16x16x32_bf16 v[196:199], a[16:19], v[172:175], v[232:235]
    v_cvt_pk_bf16_f32 v37, v41, v45
    v_cvt_pk_bf16_f32 v40, v34, v38
    v_mfma_f32_16x16x32_bf16 v[196:199], a[20:23], v[168:171], v[196:199]
    v_exp_f32 v192, v192
    v_mfma_f32_16x16x32_bf16 v[196:199], a[24:27], v[164:167], v[196:199]
    v_exp_f32 v193, v193
    v_mfma_f32_16x16x32_bf16 v[196:199], a[28:31], v[160:163], v[196:199]
    v_cvt_pk_bf16_f32 v44, v35, v39
    v_cvt_pk_bf16_f32 v41, v42, v46
    v_cvt_pk_bf16_f32 v45, v43, v47
    v_cvt_pk_bf16_f32 v34, v48, v52
    v_cvt_pk_bf16_f32 v38, v49, v53
    v_cvt_pk_bf16_f32 v42, v50, v54
    v_cvt_pk_bf16_f32 v46, v51, v55
    v_mfma_f32_4x4x4_16b_bf16 v[48:51], v[32:33], a[160:161], 0 cbsz:1 abid:0
    v_cvt_pk_bf16_f32 v35, v56, v60
    v_mfma_f32_4x4x4_16b_bf16 v[52:55], v[32:33], a[160:161], 0 cbsz:1 abid:1
    v_cvt_pk_bf16_f32 v39, v57, v61
    v_cvt_pk_bf16_f32 v43, v58, v62
    v_mfma_f32_4x4x4_16b_bf16 v[48:51], v[34:35], a[162:163], v[48:51] cbsz:1 abid:0
    v_cvt_pk_bf16_f32 v47, v59, v63
    v_mfma_f32_4x4x4_16b_bf16 v[52:55], v[34:35], a[162:163], v[52:55] cbsz:1 abid:1
    v_exp_f32_e64 v194, v194
    v_mfma_f32_4x4x4_16b_bf16 v[56:59], v[36:37], a[160:161], 0 cbsz:1 abid:0
    v_cvt_pk_bf16_f32 v116, v192, v193
    v_mfma_f32_4x4x4_16b_bf16 v[60:63], v[36:37], a[160:161], 0 cbsz:1 abid:1
    v_cvt_pk_bf16_f32 v32, v48, v49
    v_mfma_f32_4x4x4_16b_bf16 v[56:59], v[38:39], a[162:163], v[56:59] cbsz:1 abid:0
    v_cvt_pk_bf16_f32 v33, v50, v51
    v_cvt_pk_bf16_f32 v34, v52, v53
    v_cvt_pk_bf16_f32 v35, v54, v55
    v_mfma_f32_4x4x4_16b_bf16 v[60:63], v[38:39], a[162:163], v[60:63] cbsz:1 abid:1
    buffer_store_dwordx4 v[32:35], v208, s[16:19], s40 offen sc1 nt
    s_addk_i32 s40, 0x4000
    v_exp_f32 v195, v195
    v_mfma_f32_4x4x4_16b_bf16 v[48:51], v[40:41], a[160:161], 0 cbsz:1 abid:0
    v_cvt_pk_bf16_f32 v36, v56, v57
    v_mfma_f32_4x4x4_16b_bf16 v[52:55], v[40:41], a[160:161], 0 cbsz:1 abid:1
    v_cvt_pk_bf16_f32 v37, v58, v59
    v_mfma_f32_4x4x4_16b_bf16 v[48:51], v[42:43], a[162:163], v[48:51] cbsz:1 abid:0
    v_cvt_pk_bf16_f32 v38, v60, v61
    v_cvt_pk_bf16_f32 v39, v62, v63
    v_mfma_f32_4x4x4_16b_bf16 v[52:55], v[42:43], a[162:163], v[52:55] cbsz:1 abid:1
    buffer_store_dwordx4 v[36:39], v208, s[16:19], s40 offen sc1 nt
    s_addk_i32 s40, 0x4000
    v_exp_f32 v196, v196
    v_mfma_f32_4x4x4_16b_bf16 v[56:59], v[44:45], a[160:161], 0 cbsz:1 abid:0
    v_cvt_pk_bf16_f32 v40, v48, v49
    v_mfma_f32_4x4x4_16b_bf16 v[60:63], v[44:45], a[160:161], 0 cbsz:1 abid:1
    v_cvt_pk_bf16_f32 v41, v50, v51
    v_mfma_f32_4x4x4_16b_bf16 v[56:59], v[46:47], a[162:163], v[56:59] cbsz:1 abid:0
    v_cvt_pk_bf16_f32 v42, v52, v53
    v_cvt_pk_bf16_f32 v43, v54, v55
    v_mfma_f32_4x4x4_16b_bf16 v[60:63], v[46:47], a[162:163], v[60:63] cbsz:1 abid:1
    buffer_store_dwordx4 v[40:43], v208, s[16:19], s40 offen sc1 nt
    s_add_i32 s40, s40, 0x4000
    v_cvt_pk_bf16_f32 v117, v194, v195
    v_exp_f32_e64 v197, v197
    v_exp_f32_e64 v198, v198
    v_cvt_pk_bf16_f32 v118, v196, v197
    v_exp_f32_e64 v199, v199
    s_nop 0
    v_cvt_pk_bf16_f32 v119, v198, v199
    s_nop 1
    v_smfmac_f32_16x16x64_bf16 v[244:247], a[132:135], v[112:119], v255
    v_cvt_pk_bf16_f32 v44, v56, v57
    v_mfma_f32_16x16x32_bf16 v[64:67], v[116:119], a[64:67], v[64:67]
    v_cvt_pk_bf16_f32 v45, v58, v59
    v_cvt_pk_bf16_f32 v46, v60, v61
    v_mfma_f32_16x16x32_bf16 v[68:71], v[116:119], a[76:79], v[68:71]
    v_add_f32 v209, v244, v245
    v_subrev_u32 v210, 0x37800000, v209
    v_mfma_f32_16x16x32_bf16 v[72:75], v[116:119], a[80:83], v[72:75]
    v_rcp_f32 v209, v209
    v_mfma_f32_16x16x32_bf16 v[76:79], v[116:119], a[92:95], v[76:79]
    s_nop 0
    v_cmp_lt_u32 s[66:67], s79, v210
    v_mov_b32_dpp v209, v209 row_ror:12 row_mask:0xa bank_mask:0xf
    v_mfma_f32_16x16x32_bf16 v[80:83], v[116:119], a[96:99], v[80:83]
    s_or_b64 s[64:65], s[64:65], s[66:67]
    v_cvt_pk_bf16_f32 v47, v62, v63
    v_mov_b32_dpp v209, v209 row_ror:8 row_mask:0xc bank_mask:0xf
    v_mfma_f32_16x16x32_bf16 v[84:87], v[116:119], a[108:111], v[84:87]
    buffer_store_dwordx4 v[44:47], v208, s[16:19], s40 offen sc1 nt
    s_add_i32 s40, s40, 0x4000
    v_mov_b32_dpp v220, v209 row_newbcast:0 row_mask:0xf bank_mask:0xf
    v_mov_b32_dpp v221, v209 row_newbcast:1 row_mask:0xf bank_mask:0xf
    v_mfma_f32_16x16x32_bf16 v[88:91], v[116:119], a[112:115], v[88:91]
    v_mov_b32_dpp v222, v209 row_newbcast:2 row_mask:0xf bank_mask:0xf
    v_mov_b32_dpp v223, v209 row_newbcast:3 row_mask:0xf bank_mask:0xf
    v_mfma_f32_16x16x32_bf16 v[92:95], v[116:119], a[124:127], v[92:95]
    v_pk_mul_f32 v[64:65], v[64:65], v[220:221]
    v_pk_mul_f32 v[66:67], v[66:67], v[222:223]
    v_pk_mul_f32 v[68:69], v[68:69], v[220:221]
    v_cvt_pk_bf16_f32 v64, v64, v68
    v_cvt_pk_bf16_f32 v68, v65, v69
    v_pk_mul_f32 v[70:71], v[70:71], v[222:223]
    v_pk_mul_f32 v[72:73], v[72:73], v[220:221]
    v_pk_mul_f32 v[74:75], v[74:75], v[222:223]
    v_pk_mul_f32 v[76:77], v[76:77], v[220:221]
    v_cvt_pk_bf16_f32 v65, v72, v76
    v_cvt_pk_bf16_f32 v69, v73, v77
    v_cvt_pk_bf16_f32 v72, v66, v70
    v_cvt_pk_bf16_f32 v76, v67, v71
    v_pk_mul_f32 v[78:79], v[78:79], v[222:223]
    v_cvt_pk_bf16_f32 v73, v74, v78
    v_cvt_pk_bf16_f32 v77, v75, v79
    v_pk_mul_f32 v[80:81], v[80:81], v[220:221]
    v_pk_mul_f32 v[82:83], v[82:83], v[222:223]
    v_pk_mul_f32 v[84:85], v[84:85], v[220:221]
    v_cvt_pk_bf16_f32 v66, v80, v84
    v_cvt_pk_bf16_f32 v70, v81, v85
    v_pk_mul_f32 v[86:87], v[86:87], v[222:223]
    v_cvt_pk_bf16_f32 v74, v82, v86
    v_cvt_pk_bf16_f32 v78, v83, v87
    v_pk_mul_f32 v[88:89], v[88:89], v[220:221]
    v_pk_mul_f32 v[90:91], v[90:91], v[222:223]
    v_pk_mul_f32 v[92:93], v[92:93], v[220:221]
    v_pk_mul_f32 v[94:95], v[94:95], v[222:223]
    v_mfma_f32_4x4x4_16b_bf16 v[80:83], v[64:65], a[160:161], 0 cbsz:1 abid:0
    v_cvt_pk_bf16_f32 v67, v88, v92
    v_mfma_f32_4x4x4_16b_bf16 v[84:87], v[64:65], a[160:161], 0 cbsz:1 abid:1
    v_cvt_pk_bf16_f32 v71, v89, v93
    v_cvt_pk_bf16_f32 v75, v90, v94
    v_mfma_f32_4x4x4_16b_bf16 v[80:83], v[66:67], a[162:163], v[80:83] cbsz:1 abid:0
    v_cvt_pk_bf16_f32 v79, v91, v95
    v_mfma_f32_4x4x4_16b_bf16 v[84:87], v[66:67], a[162:163], v[84:87] cbsz:1 abid:1
    v_mfma_f32_4x4x4_16b_bf16 v[88:91], v[68:69], a[160:161], 0 cbsz:1 abid:0
    v_mfma_f32_4x4x4_16b_bf16 v[92:95], v[68:69], a[160:161], 0 cbsz:1 abid:1
    v_cvt_pk_bf16_f32 v64, v80, v81
    v_mfma_f32_4x4x4_16b_bf16 v[88:91], v[70:71], a[162:163], v[88:91] cbsz:1 abid:0
    v_cvt_pk_bf16_f32 v65, v82, v83
    v_cvt_pk_bf16_f32 v66, v84, v85
    v_cvt_pk_bf16_f32 v67, v86, v87
    v_mfma_f32_4x4x4_16b_bf16 v[92:95], v[70:71], a[162:163], v[92:95] cbsz:1 abid:1
    buffer_store_dwordx4 v[64:67], v208, s[16:19], s40 offen sc1 nt
    s_add_i32 s40, s40, 0x4000
    v_mfma_f32_4x4x4_16b_bf16 v[80:83], v[72:73], a[160:161], 0 cbsz:1 abid:0
    v_cvt_pk_bf16_f32 v68, v88, v89
    v_mfma_f32_4x4x4_16b_bf16 v[84:87], v[72:73], a[160:161], 0 cbsz:1 abid:1
    v_cvt_pk_bf16_f32 v69, v90, v91
    v_mfma_f32_4x4x4_16b_bf16 v[80:83], v[74:75], a[162:163], v[80:83] cbsz:1 abid:0
    v_cvt_pk_bf16_f32 v70, v92, v93
    v_cvt_pk_bf16_f32 v71, v94, v95
    v_mfma_f32_4x4x4_16b_bf16 v[84:87], v[74:75], a[162:163], v[84:87] cbsz:1 abid:1
    buffer_store_dwordx4 v[68:71], v208, s[16:19], s40 offen sc1 nt
    s_add_i32 s40, s40, 0x4000
    v_mfma_f32_4x4x4_16b_bf16 v[88:91], v[76:77], a[160:161], 0 cbsz:1 abid:0
    v_cvt_pk_bf16_f32 v72, v80, v81
    v_mfma_f32_4x4x4_16b_bf16 v[92:95], v[76:77], a[160:161], 0 cbsz:1 abid:1
    v_cvt_pk_bf16_f32 v73, v82, v83
    v_mfma_f32_4x4x4_16b_bf16 v[88:91], v[78:79], a[162:163], v[88:91] cbsz:1 abid:0
    v_cvt_pk_bf16_f32 v74, v84, v85
    v_cvt_pk_bf16_f32 v75, v86, v87
    v_mfma_f32_4x4x4_16b_bf16 v[92:95], v[78:79], a[162:163], v[92:95] cbsz:1 abid:1
    buffer_store_dwordx4 v[72:75], v208, s[16:19], s40 offen sc1 nt
    s_addk_i32 s40, 0x4000
    v_cvt_pk_bf16_f32 v76, v88, v89
    v_cvt_pk_bf16_f32 v77, v90, v91
    s_nop 0
    v_cvt_pk_bf16_f32 v78, v92, v93
    v_cvt_pk_bf16_f32 v79, v94, v95
    buffer_store_dwordx4 v[76:79], v208, s[16:19], s40 offen sc1 nt
L_fin_3:
    s_lshl_b32 s41, s20, 2
    s_add_u32 s41, s41, 157440
    s_cmp_lg_u64 s[64:65], 0
    s_cselect_b32 s40, 1, 0
    v_mov_b32 v192, s40
    v_mov_b32 v193, s41
    ds_write_b32 v193, v192
    v_mov_b32 v193, 157440
    s_waitcnt lgkmcnt(0)
    s_barrier
    ds_read_b128 v[196:199], v193
    s_waitcnt lgkmcnt(0)
    v_or3_b32 v192, v196, v197, v198
    v_or_b32 v192, v192, v199
    s_nop 0
    v_readfirstlane_b32 s40, v192
    s_nop 0
    s_andn2_b32 s40, s40, s54
    s_cbranch_scc1 L_redo
    s_endpgm
.p2align 12
.p2align 5
P_first2p_3:
    s_setpc_b64 s[62:63]
.fill 1, 4, 0xbf800000
L_first2p_3:
    v_mfma_f32_16x16x32_bf16 v[192:195], a[0:3], v[128:131], v[224:227]
    s_addk_i32 s32, 17536
    s_mov_b32 m0, s32
    ds_read_b64_tr_b16 a[64:65], v249 offset:2176
    ds_read_b64_tr_b16 a[66:67], v249 offset:2688
    v_mfma_f32_16x16x32_bf16 v[192:195], a[4:7], v[132:135], v[192:195]
    s_mov_b32 s14, 0x13da880
    v_mov_b32 v240, 0
    v_mov_b32 v241, 0
    v_mfma_f32_16x16x32_bf16 v[192:195], a[8:11], v[136:139], v[192:195]
    ds_read_b64_tr_b16 a[68:69], v249 offset:19712
    ds_read_b64_tr_b16 a[70:71], v249 offset:20224
    v_mfma_f32_16x16x32_bf16 v[192:195], a[12:15], v[140:143], v[192:195]
    s_add_u32 s31, s30, s33
    buffer_load_dwordx4 v250, s[8:11], s23 offen offset:0 lds
    v_mfma_f32_16x16x32_bf16 v[196:199], a[16:19], v[140:143], v[224:227]
    s_add_u32 s30, s30, s80
    ds_read_b64_tr_b16 a[72:73], v249 offset:19728
    ds_read_b64_tr_b16 a[74:75], v249 offset:20240
    v_mfma_f32_16x16x32_bf16 v[196:199], a[20:23], v[136:139], v[196:199]
    s_cmp_eq_u32 s30, 105216
    v_mov_b32_e64 v242, 0
    v_mov_b32 v243, 0
    v_mfma_f32_16x16x32_bf16 v[196:199], a[24:27], v[132:135], v[196:199]
    s_cmov_b32 s30, 0
    ds_read_b64_tr_b16 a[76:77], v249 offset:2192
    ds_read_b64_tr_b16 a[78:79], v249 offset:2704
    v_mfma_f32_16x16x32_bf16 v[196:199], a[28:31], v[128:131], v[196:199]
    s_cselect_b32 s35, s81, s80
    v_mov_b32 v244, 0
    v_mov_b32_e64 v245, 0
    v_mfma_f32_16x16x32_bf16 v[200:203], a[32:35], v[128:131], v[224:227]
    ds_read_b64_tr_b16 a[80:81], v249 offset:2208
    ds_read_b64_tr_b16 a[82:83], v249 offset:2720
    v_mfma_f32_16x16x32_bf16 v[200:203], a[36:39], v[132:135], v[200:203]
    buffer_load_dwordx4 v251, s[8:11], s23 offen offset:1152 lds
    v_mfma_f32_16x16x32_bf16 v[200:203], a[40:43], v[136:139], v[200:203]
    ds_read_b64_tr_b16 a[84:85], v249 offset:19744
    ds_read_b64_tr_b16 a[86:87], v249 offset:20256
    v_mfma_f32_16x16x32_bf16 v[200:203], a[44:47], v[140:143], v[200:203]
    v_mov_b32 v246, 0
    v_mov_b32 v247, 0
    v_mfma_f32_16x16x32_bf16 v[204:207], a[48:51], v[140:143], v[224:227]
    ds_read_b64_tr_b16 a[88:89], v249 offset:19760
    ds_read_b64_tr_b16 a[90:91], v249 offset:20272
    v_mfma_f32_16x16x32_bf16 v[204:207], a[52:55], v[136:139], v[204:207]
    v_exp_f32_e64 v192, v192
    v_mfma_f32_16x16x32_bf16 v[204:207], a[56:59], v[132:135], v[204:207]
    ds_read_b64_tr_b16 a[92:93], v249 offset:2224
    ds_read_b64_tr_b16 a[94:95], v249 offset:2736
    v_mfma_f32_16x16x32_bf16 v[204:207], a[60:63], v[128:131], v[204:207]
    buffer_load_dwordx4 v250, s[12:15], s23 offen offset:2176 lds
    v_mfma_f32_4x4x4_16b_bf16 v[64:67], a[156:157], v[160:161], 0
    v_exp_f32 v193, v193
    v_mfma_f32_4x4x4_16b_bf16 v[68:71], a[156:157], v[162:163], 0
    v_exp_f32 v194, v194
    v_mfma_f32_4x4x4_16b_bf16 v[72:75], a[156:157], v[164:165], 0
    v_cvt_pk_bf16_f32 v100, v192, v193
    v_mfma_f32_4x4x4_16b_bf16 v[64:67], a[158:159], v[160:161], v[64:67]
    v_exp_f32 v195, v195
    v_mfma_f32_4x4x4_16b_bf16 v[76:79], a[156:157], v[166:167], 0
    v_exp_f32 v196, v196
    v_cvt_pk_bf16_f32 v101, v194, v195
    v_mfma_f32_16x16x32_bf16 v[192:195], a[0:3], v[144:147], v[228:231]
    ds_read_b64_tr_b16 a[96:97], v249 offset:2240
    ds_read_b64_tr_b16 a[98:99], v249 offset:2752
    v_mfma_f32_16x16x32_bf16 v[192:195], a[4:7], v[148:151], v[192:195]
    v_exp_f32_e64 v197, v197
    v_mfma_f32_16x16x32_bf16 v[192:195], a[8:11], v[152:155], v[192:195]
    ds_read_b64_tr_b16 a[100:101], v249 offset:19776
    ds_read_b64_tr_b16 a[102:103], v249 offset:20288
    v_mfma_f32_16x16x32_bf16 v[192:195], a[12:15], v[156:159], v[192:195]
    v_exp_f32 v198, v198
    v_cvt_pk_bf16_f32 v102, v196, v197
    v_mfma_f32_4x4x4_16b_bf16 v[68:71], a[158:159], v[162:163], v[68:71]
    v_exp_f32 v199, v199
    v_mfma_f32_4x4x4_16b_bf16 v[80:83], a[156:157], v[168:169], 0
    v_cvt_pk_bf16_f32 v160, v64, v65
    v_mfma_f32_4x4x4_16b_bf16 v[72:75], a[158:159], v[164:165], v[72:75]
    v_cvt_pk_bf16_f32 v161, v66, v67
    v_mfma_f32_4x4x4_16b_bf16 v[84:87], a[156:157], v[170:171], 0
    v_cvt_pk_bf16_f32 v162, v68, v69
    v_mfma_f32_4x4x4_16b_bf16 v[76:79], a[158:159], v[166:167], v[76:79]
    v_cvt_pk_bf16_f32 v163, v70, v71
    v_mfma_f32_4x4x4_16b_bf16 v[88:91], a[156:157], v[172:173], 0
    v_cvt_pk_bf16_f32 v164, v72, v73
    v_mfma_f32_4x4x4_16b_bf16 v[80:83], a[158:159], v[168:169], v[80:83]
    v_cvt_pk_bf16_f32 v165, v74, v75
    v_mfma_f32_4x4x4_16b_bf16 v[92:95], a[156:157], v[174:175], 0
    v_cvt_pk_bf16_f32 v166, v76, v77
    v_mfma_f32_4x4x4_16b_bf16 v[84:87], a[158:159], v[170:171], v[84:87]
    v_cvt_pk_bf16_f32 v167, v78, v79
    v_mfma_f32_4x4x4_16b_bf16 v[88:91], a[158:159], v[172:173], v[88:91]
    v_cvt_pk_bf16_f32 v168, v80, v81
    v_mfma_f32_4x4x4_16b_bf16 v[92:95], a[158:159], v[174:175], v[92:95]
    v_exp_f32_e64 v200, v200
    v_cvt_pk_bf16_f32 v103, v198, v199
    v_mfma_f32_16x16x32_bf16 v[196:199], a[16:19], v[156:159], v[228:231]
    ds_read_b64_tr_b16 a[104:105], v249 offset:19792
    ds_read_b64_tr_b16 a[106:107], v249 offset:20304
    v_mfma_f32_16x16x32_bf16 v[196:199], a[20:23], v[152:155], v[196:199]
    buffer_load_dwordx4 v252, s[12:15], s23 offen offset:3216 lds
    v_mfma_f32_16x16x32_bf16 v[196:199], a[24:27], v[148:151], v[196:199]
    ds_read_b64_tr_b16 a[108:109], v249 offset:2256
    ds_read_b64_tr_b16 a[110:111], v249 offset:2768
    v_mfma_f32_16x16x32_bf16 v[196:199], a[28:31], v[144:147], v[196:199]
    v_exp_f32 v201, v201
    v_exp_f32 v202, v202
    v_cvt_pk_bf16_f32 v96, v200, v201
    v_exp_f32 v203, v203
    v_exp_f32 v204, v204
    v_cvt_pk_bf16_f32 v97, v202, v203
    v_mfma_f32_16x16x32_bf16 v[200:203], a[32:35], v[144:147], v[228:231]
    ds_read_b64_tr_b16 a[112:113], v249 offset:2272
    ds_read_b64_tr_b16 a[114:115], v249 offset:2784
    v_mfma_f32_16x16x32_bf16 v[200:203], a[36:39], v[148:151], v[200:203]
    v_exp_f32_e64 v205, v205
    v_mfma_f32_16x16x32_bf16 v[200:203], a[40:43], v[152:155], v[200:203]
    ds_read_b64_tr_b16 a[116:117], v249 offset:19808
    ds_read_b64_tr_b16 a[118:119], v249 offset:20320
    v_mfma_f32_16x16x32_bf16 v[200:203], a[44:47], v[156:159], v[200:203]
    v_exp_f32_e64 v206, v206
    v_cvt_pk_bf16_f32 v98, v204, v205
    v_exp_f32 v207, v207
    s_nop 0
    v_cvt_pk_bf16_f32 v99, v206, v207
    v_mfma_f32_16x16x32_bf16 v[204:207], a[48:51], v[156:159], v[228:231]
    ds_read_b64_tr_b16 a[120:121], v249 offset:19824
    ds_read_b64_tr_b16 a[122:123], v249 offset:20336
    v_mfma_f32_16x16x32_bf16 v[204:207], a[52:55], v[152:155], v[204:207]
    v_exp_f32_e64 v192, v192
    v_mfma_f32_16x16x32_bf16 v[204:207], a[56:59], v[148:151], v[204:207]
    ds_read_b64_tr_b16 a[124:125], v249 offset:2288
    ds_read_b64_tr_b16 a[126:127], v249 offset:2800
    v_mfma_f32_16x16x32_bf16 v[204:207], a[60:63], v[144:147], v[204:207]
    s_waitcnt lgkmcnt(15)
    v_exp_f32 v193, v193
    v_mfma_f32_16x16x32_bf16 v[0:3], v[100:103], a[64:67], 0
    v_exp_f32_e64 v194, v194
    v_mfma_f32_16x16x32_bf16 v[0:3], v[96:99], a[68:71], v[0:3]
    v_cvt_pk_bf16_f32 v169, v82, v83
    v_cvt_pk_bf16_f32 v104, v192, v193
    v_mfma_f32_16x16x32_bf16 v[4:7], v[96:99], a[72:75], 0
    v_exp_f32_e64 v195, v195
    v_mfma_f32_16x16x32_bf16 v[4:7], v[100:103], a[76:79], v[4:7]
    v_exp_f32_e64 v196, v196
    v_mfma_f32_16x16x32_bf16 v[8:11], v[100:103], a[80:83], 0
    v_cvt_pk_bf16_f32 v170, v84, v85
    v_cvt_pk_bf16_f32 v105, v194, v195
    v_mfma_f32_16x16x32_bf16 v[8:11], v[96:99], a[84:87], v[8:11]
    v_exp_f32_e64 v197, v197
    v_mfma_f32_16x16x32_bf16 v[12:15], v[96:99], a[88:91], 0
    v_exp_f32 v198, v198
    v_mfma_f32_16x16x32_bf16 v[12:15], v[100:103], a[92:95], v[12:15]
    s_waitcnt lgkmcnt(8)
    v_cvt_pk_bf16_f32 v171, v86, v87
    v_cvt_pk_bf16_f32 v106, v196, v197
    v_mfma_f32_16x16x32_bf16 v[16:19], v[100:103], a[96:99], 0
    v_exp_f32 v199, v199
    v_mfma_f32_16x16x32_bf16 v[16:19], v[96:99], a[100:103], v[16:19]
    v_exp_f32 v200, v200
    v_mfma_f32_16x16x32_bf16 v[20:23], v[96:99], a[104:107], 0
    v_cvt_pk_bf16_f32 v172, v88, v89
    v_cvt_pk_bf16_f32 v107, v198, v199
    v_mfma_f32_16x16x32_bf16 v[20:23], v[100:103], a[108:111], v[20:23]
    s_waitcnt lgkmcnt(0)
    v_exp_f32 v201, v201
    v_mfma_f32_16x16x32_bf16 v[24:27], v[100:103], a[112:115], 0
    v_exp_f32_e64 v202, v202
    v_mfma_f32_16x16x32_bf16 v[24:27], v[96:99], a[116:119], v[24:27]
    v_cvt_pk_bf16_f32 v173, v90, v91
    v_cvt_pk_bf16_f32 v108, v200, v201
    v_mfma_f32_16x16x32_bf16 v[28:31], v[96:99], a[120:123], 0
    v_exp_f32 v203, v203
    v_mfma_f32_16x16x32_bf16 v[28:31], v[100:103], a[124:127], v[28:31]
    v_exp_f32 v204, v204
    v_smfmac_f32_16x16x64_bf16 v[240:243], a[148:151], v[96:103], v255
    v_cvt_pk_bf16_f32 v109, v202, v203
    v_mfma_f32_16x16x32_bf16 v[192:195], a[0:3], v[160:163], v[232:235]
    v_exp_f32_e64 v205, v205
    v_mfma_f32_16x16x32_bf16 v[192:195], a[4:7], v[164:167], v[192:195]
    v_exp_f32_e64 v206, v206
    v_mfma_f32_16x16x32_bf16 v[192:195], a[8:11], v[168:171], v[192:195]
    v_cvt_pk_bf16_f32 v174, v92, v93
    v_cvt_pk_bf16_f32 v175, v94, v95
    v_cvt_pk_bf16_f32 v110, v204, v205
    s_nop 0
    v_mfma_f32_16x16x32_bf16 v[192:195], a[12:15], v[172:175], v[192:195]
    v_exp_f32 v207, v207
    v_mfma_f32_16x16x32_bf16 v[196:199], a[16:19], v[172:175], v[232:235]
    v_cvt_pk_bf16_f32 v111, v206, v207
    v_mfma_f32_16x16x32_bf16 v[196:199], a[20:23], v[168:171], v[196:199]
    v_exp_f32_e64 v192, v192
    v_mfma_f32_16x16x32_bf16 v[196:199], a[24:27], v[164:167], v[196:199]
    v_exp_f32 v193, v193
    v_mfma_f32_16x16x32_bf16 v[196:199], a[28:31], v[160:163], v[196:199]
    v_exp_f32 v194, v194
    v_mfma_f32_16x16x32_bf16 v[200:203], a[32:35], v[160:163], v[232:235]
    v_cvt_pk_bf16_f32 v116, v192, v193
    v_mfma_f32_16x16x32_bf16 v[200:203], a[36:39], v[164:167], v[200:203]
    v_exp_f32 v195, v195
    v_mfma_f32_16x16x32_bf16 v[200:203], a[40:43], v[168:171], v[200:203]
    v_exp_f32 v196, v196
    v_mfma_f32_16x16x32_bf16 v[200:203], a[44:47], v[172:175], v[200:203]
    v_cvt_pk_bf16_f32 v117, v194, v195
    v_exp_f32_e64 v197, v197
    v_mfma_f32_16x16x32_bf16 v[204:207], a[48:51], v[172:175], v[232:235]
    v_exp_f32_e64 v198, v198
    v_mfma_f32_16x16x32_bf16 v[204:207], a[52:55], v[168:171], v[204:207]
    v_cvt_pk_bf16_f32 v118, v196, v197
    v_add_u32_e64 v248, s35, v248
    v_mfma_f32_16x16x32_bf16 v[204:207], a[56:59], v[164:167], v[204:207]
    s_waitcnt vmcnt(20)
    v_exp_f32_e64 v199, v199
    v_mfma_f32_16x16x32_bf16 v[204:207], a[60:63], v[160:163], v[204:207]
    s_barrier
    v_exp_f32_e64 v200, v200
    v_mfma_f32_16x16x32_bf16 v[32:35], v[104:107], a[64:67], 0
    s_mov_b32 s22, s24
    s_add_u32 s23, s24, s25
    ds_read_b128 a[0:3], v248 offset:0
    v_mfma_f32_16x16x32_bf16 v[32:35], v[108:111], a[68:71], v[32:35]
    s_add_u32 s24, s23, s25
    s_mov_b32 s32, s31
    ds_read_b128 a[4:7], v248 offset:64
    v_mfma_f32_16x16x32_bf16 v[36:39], v[108:111], a[72:75], 0
    s_mov_b32 m0, s31
    ds_read_b128 a[8:11], v248 offset:128
    v_cvt_pk_bf16_f32 v119, v198, v199
    v_mfma_f32_16x16x32_bf16 v[36:39], v[104:107], a[76:79], v[36:39]
    s_nop 0
    ds_read_b128 a[12:15], v248 offset:192
    buffer_load_dwordx4 v250, s[8:11], s22 offen offset:0 lds
    v_mfma_f32_16x16x32_bf16 v[40:43], v[104:107], a[80:83], 0
    ds_read_b128 a[16:19], v248 offset:704
    v_exp_f32 v201, v201
    v_mfma_f32_16x16x32_bf16 v[40:43], v[108:111], a[84:87], v[40:43]
    ds_read_b128 a[20:23], v248 offset:640
    v_exp_f32 v202, v202
    v_mfma_f32_16x16x32_bf16 v[44:47], v[108:111], a[88:91], 0
    ds_read_b128 a[24:27], v248 offset:576
    v_cvt_pk_bf16_f32 v112, v200, v201
    v_mfma_f32_16x16x32_bf16 v[44:47], v[104:107], a[92:95], v[44:47]
    ds_read_b128 a[28:31], v248 offset:512
    v_exp_f32_e64 v203, v203
    v_mfma_f32_16x16x32_bf16 v[48:51], v[104:107], a[96:99], 0
    ds_read_b128 a[32:35], v248 offset:17536
    buffer_load_dwordx4 v251, s[8:11], s22 offen offset:1152 lds
    v_mfma_f32_16x16x32_bf16 v[48:51], v[108:111], a[100:103], v[48:51]
    ds_read_b128 a[36:39], v248 offset:17600
    v_exp_f32_e64 v204, v204
    v_mfma_f32_16x16x32_bf16 v[52:55], v[108:111], a[104:107], 0
    ds_read_b128 a[40:43], v248 offset:17664
    v_cvt_pk_bf16_f32 v113, v202, v203
    v_mfma_f32_16x16x32_bf16 v[52:55], v[104:107], a[108:111], v[52:55]
    ds_read_b128 a[44:47], v248 offset:17728
    v_mfma_f32_16x16x32_bf16 v[56:59], v[104:107], a[112:115], 0
    ds_read_b128 a[48:51], v248 offset:18240
    v_mfma_f32_16x16x32_bf16 v[56:59], v[108:111], a[116:119], v[56:59]
    ds_read_b128 a[52:55], v248 offset:18176
    buffer_load_dwordx4 v250, s[12:15], s22 offen offset:2176 lds
    v_mfma_f32_16x16x32_bf16 v[60:63], v[108:111], a[120:123], 0
    ds_read_b128 a[56:59], v248 offset:18112
    v_mfma_f32_16x16x32_bf16 v[60:63], v[104:107], a[124:127], v[60:63]
    ds_read_b128 a[60:63], v248 offset:18048
    v_smfmac_f32_16x16x64_bf16 v[240:243], a[152:155], v[104:111], v255
    s_waitcnt lgkmcnt(12)
    v_mfma_f32_16x16x32_bf16 v[192:195], a[0:3], v[128:131], v[224:227]
    v_exp_f32 v205, v205
    v_mfma_f32_16x16x32_bf16 v[192:195], a[4:7], v[132:135], v[192:195]
    buffer_load_dwordx4 v252, s[12:15], s22 offen offset:3216 lds
    v_add_u32 v249, s35, v249
    v_mfma_f32_16x16x32_bf16 v[192:195], a[8:11], v[136:139], v[192:195]
    v_exp_f32 v206, v206
    v_mfma_f32_16x16x32_bf16 v[192:195], a[12:15], v[140:143], v[192:195]
    s_waitcnt lgkmcnt(8)
    v_cvt_pk_bf16_f32 v114, v204, v205
    v_mfma_f32_16x16x32_bf16 v[196:199], a[16:19], v[140:143], v[224:227]
    v_exp_f32 v207, v207
    v_mfma_f32_16x16x32_bf16 v[196:199], a[20:23], v[136:139], v[196:199]
    s_addk_i32 s32, 17536
    v_cvt_pk_bf16_f32 v115, v206, v207
    s_mov_b32 m0, s32
    v_mfma_f32_16x16x32_bf16 v[196:199], a[24:27], v[132:135], v[196:199]
    s_mov_b32 s14, 0x13da880
    v_exp_f32 v192, v192
    v_mfma_f32_16x16x32_bf16 v[196:199], a[28:31], v[128:131], v[196:199]
    s_waitcnt lgkmcnt(4)
    buffer_load_dwordx4 v250, s[8:11], s23 offen offset:0 lds
    v_mfma_f32_16x16x32_bf16 v[200:203], a[32:35], v[128:131], v[224:227]
    v_exp_f32 v193, v193
    v_mfma_f32_16x16x32_bf16 v[200:203], a[36:39], v[132:135], v[200:203]
    v_exp_f32 v194, v194
    v_mfma_f32_16x16x32_bf16 v[200:203], a[40:43], v[136:139], v[200:203]
    v_exp_f32 v195, v195
    v_mfma_f32_16x16x32_bf16 v[200:203], a[44:47], v[140:143], v[200:203]
    s_waitcnt lgkmcnt(0)
    v_cvt_pk_bf16_f32 v100, v192, v193
    v_cvt_pk_bf16_f32 v101, v194, v195
    v_mfma_f32_16x16x32_bf16 v[204:207], a[48:51], v[140:143], v[224:227]
    buffer_load_dwordx4 v251, s[8:11], s23 offen offset:1152 lds
    v_mfma_f32_16x16x32_bf16 v[204:207], a[52:55], v[136:139], v[204:207]
    v_exp_f32_e64 v196, v196
    v_mfma_f32_16x16x32_bf16 v[204:207], a[56:59], v[132:135], v[204:207]
    v_exp_f32 v197, v197
    v_mfma_f32_16x16x32_bf16 v[204:207], a[60:63], v[128:131], v[204:207]
    v_exp_f32 v198, v198
    v_mfma_f32_16x16x32_bf16 v[64:67], v[116:119], a[64:67], 0
    ds_read_b64_tr_b16 a[64:65], v249 offset:2176
    ds_read_b64_tr_b16 a[66:67], v249 offset:2688
    v_mfma_f32_16x16x32_bf16 v[64:67], v[112:115], a[68:71], v[64:67]
    v_exp_f32_e64 v199, v199
    v_mfma_f32_16x16x32_bf16 v[68:71], v[112:115], a[72:75], 0
    ds_read_b64_tr_b16 a[68:69], v249 offset:19712
    ds_read_b64_tr_b16 a[70:71], v249 offset:20224
    v_mfma_f32_16x16x32_bf16 v[68:71], v[116:119], a[76:79], v[68:71]
    v_cvt_pk_bf16_f32 v102, v196, v197
    v_cvt_pk_bf16_f32 v103, v198, v199
    v_mfma_f32_16x16x32_bf16 v[72:75], v[116:119], a[80:83], 0
    ds_read_b64_tr_b16 a[72:73], v249 offset:19728
    ds_read_b64_tr_b16 a[74:75], v249 offset:20240
    v_mfma_f32_16x16x32_bf16 v[72:75], v[112:115], a[84:87], v[72:75]
    v_exp_f32_e64 v200, v200
    v_mfma_f32_16x16x32_bf16 v[76:79], v[112:115], a[88:91], 0
    ds_read_b64_tr_b16 a[76:77], v249 offset:2192
    ds_read_b64_tr_b16 a[78:79], v249 offset:2704
    v_mfma_f32_16x16x32_bf16 v[76:79], v[116:119], a[92:95], v[76:79]
    v_exp_f32_e64 v201, v201
    v_mfma_f32_16x16x32_bf16 v[80:83], v[116:119], a[96:99], 0
    ds_read_b64_tr_b16 a[80:81], v249 offset:2208
    ds_read_b64_tr_b16 a[82:83], v249 offset:2720
    v_mfma_f32_16x16x32_bf16 v[80:83], v[112:115], a[100:103], v[80:83]
    v_exp_f32_e64 v202, v202
    v_mfma_f32_16x16x32_bf16 v[84:87], v[112:115], a[104:107], 0
    ds_read_b64_tr_b16 a[84:85], v249 offset:19744
    ds_read_b64_tr_b16 a[86:87], v249 offset:20256
    v_mfma_f32_16x16x32_bf16 v[84:87], v[116:119], a[108:111], v[84:87]
    v_exp_f32_e64 v203, v203
    v_mfma_f32_16x16x32_bf16 v[88:91], v[116:119], a[112:115], 0
    ds_read_b64_tr_b16 a[88:89], v249 offset:19760
    ds_read_b64_tr_b16 a[90:91], v249 offset:20272
    v_mfma_f32_16x16x32_bf16 v[88:91], v[112:115], a[116:119], v[88:91]
    v_cvt_pk_bf16_f32 v96, v200, v201
    v_cvt_pk_bf16_f32 v97, v202, v203
    v_mfma_f32_16x16x32_bf16 v[92:95], v[112:115], a[120:123], 0
    ds_read_b64_tr_b16 a[92:93], v249 offset:2224
    ds_read_b64_tr_b16 a[94:95], v249 offset:2736
    v_mfma_f32_16x16x32_bf16 v[92:95], v[116:119], a[124:127], v[92:95]
    v_exp_f32 v204, v204
    v_smfmac_f32_16x16x64_bf16 v[244:247], a[148:151], v[112:119], v255
    s_branch L_loop_3
.p2align 12
.p2align 5
P_laste_2:
    s_setpc_b64 s[62:63]
.fill 1, 4, 0xbf800000
L_laste_2:
    v_exp_f32 v193, v193
    v_mfma_f32_16x16x32_bf16 v[200:203], a[0:3], v[144:147], v[228:231]
    v_exp_f32 v207, v207
    v_mfma_f32_16x16x32_bf16 v[200:203], a[4:7], v[148:151], v[200:203]
    v_exp_f32 v194, v194
    v_mfma_f32_16x16x32_bf16 v[200:203], a[8:11], v[152:155], v[200:203]
    v_cvt_pk_bf16_f32 v222, v204, v205
    v_exp_f32 v195, v195
    v_mfma_f32_16x16x32_bf16 v[200:203], a[12:15], v[156:159], v[200:203]
    v_cvt_pk_bf16_f32 v223, v206, v207
    v_cvt_pk_bf16_f32 v212, v192, v193
    v_mfma_f32_16x16x32_bf16 v[204:207], a[16:19], v[156:159], v[228:231]
    v_cvt_pk_bf16_f32 v213, v194, v195
    v_exp_f32 v196, v196
    v_mfma_f32_16x16x32_bf16 v[204:207], a[20:23], v[152:155], v[204:207]
    v_exp_f32 v197, v197
    v_mfma_f32_16x16x32_bf16 v[204:207], a[24:27], v[148:151], v[204:207]
    v_exp_f32_e64 v198, v198
    v_mfma_f32_16x16x32_bf16 v[204:207], a[28:31], v[144:147], v[204:207]
    v_exp_f32_e64 v199, v199
    v_mfma_f32_16x16x32_bf16 v[32:35], v[216:219], a[64:67], v[32:35]
    ds_read_b64_tr_b16 a[64:65], v249 offset:2176
    ds_read_b64_tr_b16 a[66:67], v249 offset:2688
    v_mfma_f32_16x16x32_bf16 v[32:35], v[220:223], a[68:71], v[32:35]
    v_cvt_pk_bf16_f32 v214, v196, v197
    v_cvt_pk_bf16_f32 v215, v198, v199
    v_mfma_f32_16x16x32_bf16 v[36:39], v[220:223], a[72:75], v[36:39]
    v_exp_f32_e64 v200, v200
    v_mfma_f32_16x16x32_bf16 v[36:39], v[216:219], a[76:79], v[36:39]
    ds_read_b64_tr_b16 a[76:77], v249 offset:2192
    ds_read_b64_tr_b16 a[78:79], v249 offset:2704
    v_mfma_f32_16x16x32_bf16 v[40:43], v[216:219], a[80:83], v[40:43]
    ds_read_b64_tr_b16 a[80:81], v249 offset:2208
    ds_read_b64_tr_b16 a[82:83], v249 offset:2720
    v_mfma_f32_16x16x32_bf16 v[40:43], v[220:223], a[84:87], v[40:43]
    v_exp_f32 v201, v201
    v_mfma_f32_16x16x32_bf16 v[44:47], v[220:223], a[88:91], v[44:47]
    v_exp_f32 v202, v202
    v_mfma_f32_16x16x32_bf16 v[44:47], v[216:219], a[92:95], v[44:47]
    ds_read_b64_tr_b16 a[92:93], v249 offset:2224
    ds_read_b64_tr_b16 a[94:95], v249 offset:2736
    v_mfma_f32_16x16x32_bf16 v[48:51], v[216:219], a[96:99], v[48:51]
    ds_read_b64_tr_b16 a[96:97], v249 offset:2240
    ds_read_b64_tr_b16 a[98:99], v249 offset:2752
    v_mfma_f32_16x16x32_bf16 v[48:51], v[220:223], a[100:103], v[48:51]
    v_exp_f32_e64 v203, v203
    v_mfma_f32_16x16x32_bf16 v[52:55], v[220:223], a[104:107], v[52:55]
    v_exp_f32_e64 v204, v204
    v_mfma_f32_16x16x32_bf16 v[52:55], v[216:219], a[108:111], v[52:55]
    ds_read_b64_tr_b16 a[108:109], v249 offset:2256
    ds_read_b64_tr_b16 a[110:111], v249 offset:2768
    v_mfma_f32_16x16x32_bf16 v[56:59], v[216:219], a[112:115], v[56:59]
    ds_read_b64_tr_b16 a[112:113], v249 offset:2272
    ds_read_b64_tr_b16 a[114:115], v249 offset:2784
    v_mfma_f32_16x16x32_bf16 v[56:59], v[220:223], a[116:119], v[56:59]
    v_exp_f32_e64 v205, v205
    v_mfma_f32_16x16x32_bf16 v[60:63], v[220:223], a[120:123], v[60:63]
    v_exp_f32_e64 v206, v206
    v_mfma_f32_16x16x32_bf16 v[60:63], v[216:219], a[124:127], v[60:63]
    s_nop 0
    ds_read_b64_tr_b16 a[124:125], v249 offset:2288
    ds_read_b64_tr_b16 a[126:127], v249 offset:2800
    v_smfmac_f32_16x16x64_bf16 v[240:243], a[136:139], v[216:223], v255
    s_mov_b32 s40, s73
    v_smfmac_f32_16x16x64_bf16 v[240:243], a[168:171], v[212:219], v255
    s_waitcnt lgkmcnt(4)
    v_mfma_f32_16x16x32_bf16 v[0:3], v[212:215], a[64:67], v[0:3]
    v_exp_f32 v207, v207
    v_mfma_f32_16x16x32_bf16 v[4:7], v[212:215], a[76:79], v[4:7]
    v_accvgpr_read_b32 v208, a164
    v_add_f32_e64 v209, v240, v241
    v_mfma_f32_16x16x32_bf16 v[8:11], v[212:215], a[80:83], v[8:11]
    v_subrev_u32 v210, 0x37800000, v209
    v_rcp_f32_e64 v209, v209
    v_mfma_f32_16x16x32_bf16 v[12:15], v[212:215], a[92:95], v[12:15]
    v_cmp_lt_u32 s[66:67], s79, v210
    v_mov_b32_dpp v209, v209 row_ror:12 row_mask:0xa bank_mask:0xf
    v_mfma_f32_16x16x32_bf16 v[16:19], v[212:215], a[96:99], v[16:19]
    s_or_b64 s[64:65], s[64:65], s[66:67]
    v_mov_b32_dpp v209, v209 row_ror:8 row_mask:0xc bank_mask:0xf
    v_mfma_f32_16x16x32_bf16 v[20:23], v[212:215], a[108:111], v[20:23]
    s_waitcnt lgkmcnt(0)
    v_mov_b32_dpp v220, v209 row_newbcast:0 row_mask:0xf bank_mask:0xf
    v_mov_b32_dpp v221, v209 row_newbcast:1 row_mask:0xf bank_mask:0xf
    v_mfma_f32_16x16x32_bf16 v[24:27], v[212:215], a[112:115], v[24:27]
    v_mov_b32_dpp v222, v209 row_newbcast:2 row_mask:0xf bank_mask:0xf
    v_mov_b32_dpp v223, v209 row_newbcast:3 row_mask:0xf bank_mask:0xf
    v_mfma_f32_16x16x32_bf16 v[28:31], v[212:215], a[124:127], v[28:31]
    v_cvt_pk_bf16_f32 v216, v200, v201
    v_cvt_pk_bf16_f32 v217, v202, v203
    v_cvt_pk_bf16_f32 v218, v204, v205
    v_cvt_pk_bf16_f32 v219, v206, v207
    v_pk_mul_f32 v[0:1], v[0:1], v[220:221]
    v_pk_mul_f32 v[2:3], v[2:3], v[222:223]
    v_pk_mul_f32 v[4:5], v[4:5], v[220:221]
    v_pk_mul_f32 v[6:7], v[6:7], v[222:223]
    v_pk_mul_f32 v[8:9], v[8:9], v[220:221]
    v_pk_mul_f32 v[10:11], v[10:11], v[222:223]
    v_pk_mul_f32 v[12:13], v[12:13], v[220:221]
    v_pk_mul_f32 v[14:15], v[14:15], v[222:223]
    v_pk_mul_f32 v[16:17], v[16:17], v[220:221]
    v_pk_mul_f32 v[18:19], v[18:19], v[222:223]
    v_pk_mul_f32 v[20:21], v[20:21], v[220:221]
    v_pk_mul_f32 v[22:23], v[22:23], v[222:223]
    v_pk_mul_f32 v[24:25], v[24:25], v[220:221]
    v_pk_mul_f32 v[26:27], v[26:27], v[222:223]
    v_pk_mul_f32 v[28:29], v[28:29], v[220:221]
    v_pk_mul_f32 v[30:31], v[30:31], v[222:223]
    v_smfmac_f32_16x16x64_bf16 v[240:243], a[172:175], v[212:219], v255
    v_cvt_pk_bf16_f32 v0, v0, v4
    v_mfma_f32_16x16x32_bf16 v[32:35], v[216:219], a[64:67], v[32:35]
    v_cvt_pk_bf16_f32 v4, v1, v5
    v_cvt_pk_bf16_f32 v1, v8, v12
    v_mfma_f32_16x16x32_bf16 v[36:39], v[216:219], a[76:79], v[36:39]
    v_add_f32_e64 v209, v242, v243
    v_subrev_u32 v210, 0x37800000, v209
    v_mfma_f32_16x16x32_bf16 v[40:43], v[216:219], a[80:83], v[40:43]
    v_rcp_f32_e64 v209, v209
    v_mfma_f32_16x16x32_bf16 v[44:47], v[216:219], a[92:95], v[44:47]
    v_cmp_lt_u32 s[66:67], s79, v210
    v_mov_b32_dpp v209, v209 row_ror:12 row_mask:0xa bank_mask:0xf
    v_mfma_f32_16x16x32_bf16 v[48:51], v[216:219], a[96:99], v[48:51]
    s_or_b64 s[64:65], s[64:65], s[66:67]
    v_cvt_pk_bf16_f32 v5, v9, v13
    v_mov_b32_dpp v209, v209 row_ror:8 row_mask:0xc bank_mask:0xf
    v_mfma_f32_16x16x32_bf16 v[52:55], v[216:219], a[108:111], v[52:55]
    s_nop 0
    v_mov_b32_dpp v220, v209 row_newbcast:0 row_mask:0xf bank_mask:0xf
    v_mov_b32_dpp v221, v209 row_newbcast:1 row_mask:0xf bank_mask:0xf
    v_mfma_f32_16x16x32_bf16 v[56:59], v[216:219], a[112:115], v[56:59]
    v_mov_b32_dpp v222, v209 row_newbcast:2 row_mask:0xf bank_mask:0xf
    v_mov_b32_dpp v223, v209 row_newbcast:3 row_mask:0xf bank_mask:0xf
    v_mfma_f32_16x16x32_bf16 v[60:63], v[216:219], a[124:127], v[60:63]
    v_cvt_pk_bf16_f32 v8, v2, v6
    v_cvt_pk_bf16_f32 v12, v3, v7
    v_cvt_pk_bf16_f32 v9, v10, v14
    v_cvt_pk_bf16_f32 v13, v11, v15
    v_cvt_pk_bf16_f32 v2, v16, v20
    v_cvt_pk_bf16_f32 v6, v17, v21
    v_cvt_pk_bf16_f32 v10, v18, v22
    v_cvt_pk_bf16_f32 v14, v19, v23
    v_pk_mul_f32 v[32:33], v[32:33], v[220:221]
    v_mfma_f32_4x4x4_16b_bf16 v[16:19], v[0:1], a[160:161], 0 cbsz:1 abid:0
    v_cvt_pk_bf16_f32 v3, v24, v28
    v_mfma_f32_4x4x4_16b_bf16 v[20:23], v[0:1], a[160:161], 0 cbsz:1 abid:1
    v_cvt_pk_bf16_f32 v7, v25, v29
    v_cvt_pk_bf16_f32 v11, v26, v30
    v_mfma_f32_4x4x4_16b_bf16 v[16:19], v[2:3], a[162:163], v[16:19] cbsz:1 abid:0
    v_cvt_pk_bf16_f32 v15, v27, v31
    v_mfma_f32_4x4x4_16b_bf16 v[20:23], v[2:3], a[162:163], v[20:23] cbsz:1 abid:1
    v_mfma_f32_4x4x4_16b_bf16 v[24:27], v[4:5], a[160:161], 0 cbsz:1 abid:0
    v_mfma_f32_4x4x4_16b_bf16 v[28:31], v[4:5], a[160:161], 0 cbsz:1 abid:1
    v_cvt_pk_bf16_f32 v0, v16, v17
    v_mfma_f32_4x4x4_16b_bf16 v[24:27], v[6:7], a[162:163], v[24:27] cbsz:1 abid:0
    v_cvt_pk_bf16_f32 v1, v18, v19
    v_cvt_pk_bf16_f32 v2, v20, v21
    v_cvt_pk_bf16_f32 v3, v22, v23
    v_mfma_f32_4x4x4_16b_bf16 v[28:31], v[6:7], a[162:163], v[28:31] cbsz:1 abid:1
    buffer_store_dwordx4 v[0:3], v208, s[16:19], s40 offen sc1 nt
    s_add_i32 s40, s40, 0x4000
    v_pk_mul_f32 v[34:35], v[34:35], v[222:223]
    v_pk_mul_f32 v[36:37], v[36:37], v[220:221]
    v_mfma_f32_4x4x4_16b_bf16 v[16:19], v[8:9], a[160:161], 0 cbsz:1 abid:0
    v_cvt_pk_bf16_f32 v4, v24, v25
    v_mfma_f32_4x4x4_16b_bf16 v[20:23], v[8:9], a[160:161], 0 cbsz:1 abid:1
    v_cvt_pk_bf16_f32 v5, v26, v27
    v_mfma_f32_4x4x4_16b_bf16 v[16:19], v[10:11], a[162:163], v[16:19] cbsz:1 abid:0
    v_cvt_pk_bf16_f32 v6, v28, v29
    v_cvt_pk_bf16_f32 v7, v30, v31
    v_mfma_f32_4x4x4_16b_bf16 v[20:23], v[10:11], a[162:163], v[20:23] cbsz:1 abid:1
    buffer_store_dwordx4 v[4:7], v208, s[16:19], s40 offen sc1 nt
    s_add_i32 s40, s40, 0x4000
    v_pk_mul_f32 v[38:39], v[38:39], v[222:223]
    v_pk_mul_f32 v[40:41], v[40:41], v[220:221]
    v_mfma_f32_4x4x4_16b_bf16 v[24:27], v[12:13], a[160:161], 0 cbsz:1 abid:0
    v_cvt_pk_bf16_f32 v8, v16, v17
    v_mfma_f32_4x4x4_16b_bf16 v[28:31], v[12:13], a[160:161], 0 cbsz:1 abid:1
    v_cvt_pk_bf16_f32 v9, v18, v19
    v_mfma_f32_4x4x4_16b_bf16 v[24:27], v[14:15], a[162:163], v[24:27] cbsz:1 abid:0
    v_cvt_pk_bf16_f32 v10, v20, v21
    v_cvt_pk_bf16_f32 v11, v22, v23
    v_mfma_f32_4x4x4_16b_bf16 v[28:31], v[14:15], a[162:163], v[28:31] cbsz:1 abid:1
    buffer_store_dwordx4 v[8:11], v208, s[16:19], s40 offen sc1 nt
    s_add_i32 s40, s40, 0x4000
    v_cvt_pk_bf16_f32 v12, v24, v25
    v_cvt_pk_bf16_f32 v13, v26, v27
    v_pk_mul_f32 v[42:43], v[42:43], v[222:223]
    v_cvt_pk_bf16_f32 v14, v28, v29
    v_cvt_pk_bf16_f32 v15, v30, v31
    v_pk_mul_f32 v[44:45], v[44:45], v[220:221]
    v_pk_mul_f32 v[46:47], v[46:47], v[222:223]
    v_pk_mul_f32 v[48:49], v[48:49], v[220:221]
    buffer_store_dwordx4 v[12:15], v208, s[16:19], s40 offen sc1 nt
    s_add_i32 s40, s40, 0x4000
    v_cvt_pk_bf16_f32 v32, v32, v36
    v_cvt_pk_bf16_f32 v36, v33, v37
    v_cvt_pk_bf16_f32 v33, v40, v44
    v_cvt_pk_bf16_f32 v37, v41, v45
    v_cvt_pk_bf16_f32 v40, v34, v38
    v_cvt_pk_bf16_f32 v44, v35, v39
    v_cvt_pk_bf16_f32 v41, v42, v46
    v_cvt_pk_bf16_f32 v45, v43, v47
    v_pk_mul_f32 v[50:51], v[50:51], v[222:223]
    v_pk_mul_f32 v[52:53], v[52:53], v[220:221]
    v_cvt_pk_bf16_f32 v34, v48, v52
    v_cvt_pk_bf16_f32 v38, v49, v53
    v_pk_mul_f32 v[54:55], v[54:55], v[222:223]
    v_cvt_pk_bf16_f32 v42, v50, v54
    v_cvt_pk_bf16_f32 v46, v51, v55
    v_pk_mul_f32 v[56:57], v[56:57], v[220:221]
    v_pk_mul_f32 v[58:59], v[58:59], v[222:223]
    v_pk_mul_f32 v[60:61], v[60:61], v[220:221]
    v_pk_mul_f32 v[62:63], v[62:63], v[222:223]
    v_mfma_f32_4x4x4_16b_bf16 v[48:51], v[32:33], a[160:161], 0 cbsz:1 abid:0
    v_cvt_pk_bf16_f32 v35, v56, v60
    v_mfma_f32_4x4x4_16b_bf16 v[52:55], v[32:33], a[160:161], 0 cbsz:1 abid:1
    v_cvt_pk_bf16_f32 v39, v57, v61
    v_cvt_pk_bf16_f32 v43, v58, v62
    v_mfma_f32_4x4x4_16b_bf16 v[48:51], v[34:35], a[162:163], v[48:51] cbsz:1 abid:0
    v_cvt_pk_bf16_f32 v47, v59, v63
    v_mfma_f32_4x4x4_16b_bf16 v[52:55], v[34:35], a[162:163], v[52:55] cbsz:1 abid:1
    v_mfma_f32_4x4x4_16b_bf16 v[56:59], v[36:37], a[160:161], 0 cbsz:1 abid:0
    v_mfma_f32_4x4x4_16b_bf16 v[60:63], v[36:37], a[160:161], 0 cbsz:1 abid:1
    v_cvt_pk_bf16_f32 v32, v48, v49
    v_mfma_f32_4x4x4_16b_bf16 v[56:59], v[38:39], a[162:163], v[56:59] cbsz:1 abid:0
    v_cvt_pk_bf16_f32 v33, v50, v51
    v_cvt_pk_bf16_f32 v34, v52, v53
    v_cvt_pk_bf16_f32 v35, v54, v55
    v_mfma_f32_4x4x4_16b_bf16 v[60:63], v[38:39], a[162:163], v[60:63] cbsz:1 abid:1
    buffer_store_dwordx4 v[32:35], v208, s[16:19], s40 offen sc1 nt
    s_add_i32 s40, s40, 0x4000
    v_mfma_f32_4x4x4_16b_bf16 v[48:51], v[40:41], a[160:161], 0 cbsz:1 abid:0
    v_cvt_pk_bf16_f32 v36, v56, v57
    v_mfma_f32_4x4x4_16b_bf16 v[52:55], v[40:41], a[160:161], 0 cbsz:1 abid:1
    v_cvt_pk_bf16_f32 v37, v58, v59
    v_mfma_f32_4x4x4_16b_bf16 v[48:51], v[42:43], a[162:163], v[48:51] cbsz:1 abid:0
    v_cvt_pk_bf16_f32 v38, v60, v61
    v_cvt_pk_bf16_f32 v39, v62, v63
    v_mfma_f32_4x4x4_16b_bf16 v[52:55], v[42:43], a[162:163], v[52:55] cbsz:1 abid:1
    buffer_store_dwordx4 v[36:39], v208, s[16:19], s40 offen sc1 nt
    s_add_i32 s40, s40, 0x4000
    v_mfma_f32_4x4x4_16b_bf16 v[56:59], v[44:45], a[160:161], 0 cbsz:1 abid:0
    v_cvt_pk_bf16_f32 v40, v48, v49
    v_mfma_f32_4x4x4_16b_bf16 v[60:63], v[44:45], a[160:161], 0 cbsz:1 abid:1
    v_cvt_pk_bf16_f32 v41, v50, v51
    v_mfma_f32_4x4x4_16b_bf16 v[56:59], v[46:47], a[162:163], v[56:59] cbsz:1 abid:0
    v_cvt_pk_bf16_f32 v42, v52, v53
    v_cvt_pk_bf16_f32 v43, v54, v55
    v_mfma_f32_4x4x4_16b_bf16 v[60:63], v[46:47], a[162:163], v[60:63] cbsz:1 abid:1
    buffer_store_dwordx4 v[40:43], v208, s[16:19], s40 offen sc1 nt
    s_addk_i32 s40, 0x4000
    v_cvt_pk_bf16_f32 v44, v56, v57
    v_cvt_pk_bf16_f32 v45, v58, v59
    s_nop 0
    v_cvt_pk_bf16_f32 v46, v60, v61
    v_cvt_pk_bf16_f32 v47, v62, v63
    buffer_store_dwordx4 v[44:47], v208, s[16:19], s40 offen sc1 nt
L_fin_2:
    s_lshl_b32 s41, s20, 2
    s_add_u32 s41, s41, 157440
    s_cmp_lg_u64 s[64:65], 0
    s_cselect_b32 s40, 1, 0
    v_mov_b32 v192, s40
    v_mov_b32_e64 v193, s41
    ds_write_b32 v193, v192
    v_mov_b32 v193, 157440
    s_waitcnt lgkmcnt(0)
    s_barrier
    ds_read_b128 v[196:199], v193
    s_waitcnt lgkmcnt(0)
    v_or3_b32 v192, v196, v197, v198
    v_or_b32 v192, v192, v199
    s_nop 0
    v_readfirstlane_b32 s40, v192
    s_nop 0
    s_andn2_b32 s40, s40, s54
    s_cbranch_scc1 L_redo
    s_endpgm
.p2align 5
P_first2s_3:
    s_setpc_b64 s[62:63]
.fill 1, 4, 0xbf800000
L_first2s_3:
    v_mfma_f32_16x16x32_bf16 v[200:203], a[0:3], v[128:131], v[224:227]
    s_addk_i32 s32, 17536
    s_mov_b32 m0, s32
    ds_read_b64_tr_b16 a[64:65], v249 offset:2176
    ds_read_b64_tr_b16 a[66:67], v249 offset:2688
    v_mfma_f32_16x16x32_bf16 v[200:203], a[4:7], v[132:135], v[200:203]
    s_mov_b32 s14, 0x13da880
    v_mov_b32 v240, 0
    v_mov_b32 v241, 0
    v_mfma_f32_16x16x32_bf16 v[200:203], a[8:11], v[136:139], v[200:203]
    ds_read_b64_tr_b16 a[76:77], v249 offset:2192
    ds_read_b64_tr_b16 a[78:79], v249 offset:2704
    v_mfma_f32_16x16x32_bf16 v[200:203], a[12:15], v[140:143], v[200:203]
    s_add_u32 s31, s30, s33
    buffer_load_dwordx4 v250, s[8:11], s23 offen offset:0 lds
    v_mfma_f32_16x16x32_bf16 v[204:207], a[16:19], v[140:143], v[224:227]
    s_add_u32 s30, s30, s80
    ds_read_b64_tr_b16 a[80:81], v249 offset:2208
    ds_read_b64_tr_b16 a[82:83], v249 offset:2720
    v_mfma_f32_16x16x32_bf16 v[204:207], a[20:23], v[136:139], v[204:207]
    s_cmp_eq_u32 s30, 105216
    v_mov_b32_e64 v242, 0
    v_mov_b32 v243, 0
    v_mfma_f32_16x16x32_bf16 v[204:207], a[24:27], v[132:135], v[204:207]
    s_cmov_b32 s30, 0
    ds_read_b64_tr_b16 a[92:93], v249 offset:2224
    ds_read_b64_tr_b16 a[94:95], v249 offset:2736
    v_mfma_f32_16x16x32_bf16 v[204:207], a[28:31], v[128:131], v[204:207]
    s_cselect_b32 s35, s81, s80
    v_mov_b32 v244, 0
    v_mov_b32_e64 v245, 0
    v_mfma_f32_16x16x32_bf16 v[192:195], a[0:3], v[144:147], v[228:231]
    ds_read_b64_tr_b16 a[96:97], v249 offset:2240
    ds_read_b64_tr_b16 a[98:99], v249 offset:2752
    v_mfma_f32_16x16x32_bf16 v[192:195], a[4:7], v[148:151], v[192:195]
    buffer_load_dwordx4 v251, s[8:11], s23 offen offset:1152 lds
    v_mfma_f32_16x16x32_bf16 v[192:195], a[8:11], v[152:155], v[192:195]
    ds_read_b64_tr_b16 a[108:109], v249 offset:2256
    ds_read_b64_tr_b16 a[110:111], v249 offset:2768
    v_mfma_f32_16x16x32_bf16 v[192:195], a[12:15], v[156:159], v[192:195]
    v_mov_b32 v246, 0
    v_mov_b32 v247, 0
    v_mfma_f32_16x16x32_bf16 v[196:199], a[16:19], v[156:159], v[228:231]
    ds_read_b64_tr_b16 a[112:113], v249 offset:2272
    ds_read_b64_tr_b16 a[114:115], v249 offset:2784
    v_mfma_f32_16x16x32_bf16 v[196:199], a[20:23], v[152:155], v[196:199]
    v_mov_b32 v96, 0
    v_mov_b32 v97, 0
    v_mfma_f32_16x16x32_bf16 v[196:199], a[24:27], v[148:151], v[196:199]
    ds_read_b64_tr_b16 a[124:125], v249 offset:2288
    ds_read_b64_tr_b16 a[126:127], v249 offset:2800
    v_mfma_f32_16x16x32_bf16 v[196:199], a[28:31], v[144:147], v[196:199]
    buffer_load_dwordx4 v250, s[12:15], s23 offen offset:2176 lds
    v_mfma_f32_4x4x4_16b_bf16 v[64:67], a[156:157], v[160:161], 0
    v_mov_b32 v98, 0
    v_mfma_f32_4x4x4_16b_bf16 v[68:71], a[156:157], v[162:163], 0
    v_mov_b32 v99, 0
    v_mfma_f32_4x4x4_16b_bf16 v[72:75], a[156:157], v[164:165], 0
    v_mov_b32_e64 v108, 0
    v_mfma_f32_4x4x4_16b_bf16 v[64:67], a[158:159], v[160:161], v[64:67]
    v_mov_b32 v109, 0
    v_mfma_f32_4x4x4_16b_bf16 v[76:79], a[156:157], v[166:167], 0
    v_mov_b32 v110, 0
    v_mfma_f32_4x4x4_16b_bf16 v[68:71], a[158:159], v[162:163], v[68:71]
    v_mov_b32_e64 v111, 0
    v_mfma_f32_4x4x4_16b_bf16 v[80:83], a[156:157], v[168:169], 0
    v_cvt_pk_bf16_f32 v160, v64, v65
    v_mfma_f32_4x4x4_16b_bf16 v[72:75], a[158:159], v[164:165], v[72:75]
    v_cvt_pk_bf16_f32 v161, v66, v67
    v_mfma_f32_4x4x4_16b_bf16 v[84:87], a[156:157], v[170:171], 0
    v_cvt_pk_bf16_f32 v162, v68, v69
    v_mfma_f32_4x4x4_16b_bf16 v[76:79], a[158:159], v[166:167], v[76:79]
    v_cvt_pk_bf16_f32 v163, v70, v71
    v_mfma_f32_4x4x4_16b_bf16 v[88:91], a[156:157], v[172:173], 0
    v_cvt_pk_bf16_f32 v164, v72, v73
    v_mfma_f32_4x4x4_16b_bf16 v[80:83], a[158:159], v[168:169], v[80:83]
    v_cvt_pk_bf16_f32 v165, v74, v75
    v_mfma_f32_4x4x4_16b_bf16 v[92:95], a[156:157], v[174:175], 0
    v_cvt_pk_bf16_f32 v166, v76, v77
    v_mfma_f32_4x4x4_16b_bf16 v[84:87], a[158:159], v[170:171], v[84:87]
    v_cvt_pk_bf16_f32 v167, v78, v79
    v_mfma_f32_4x4x4_16b_bf16 v[88:91], a[158:159], v[172:173], v[88:91]
    v_cvt_pk_bf16_f32 v168, v80, v81
    v_mfma_f32_4x4x4_16b_bf16 v[92:95], a[158:159], v[174:175], v[92:95]
    v_mov_b32 v112, 0
    v_mov_b32 v113, 0
    v_mov_b32 v114, 0
    v_mov_b32 v115, 0
    v_exp_f32 v200, v200
    v_exp_f32 v201, v201
    v_exp_f32_e64 v202, v202
    v_cvt_pk_bf16_f32 v100, v200, v201
    v_exp_f32 v203, v203
    v_exp_f32 v204, v204
    v_cvt_pk_bf16_f32 v101, v202, v203
    v_exp_f32 v205, v205
    v_exp_f32 v206, v206
    v_cvt_pk_bf16_f32 v102, v204, v205
    v_exp_f32 v207, v207
    s_nop 0
    v_cvt_pk_bf16_f32 v103, v206, v207
    s_waitcnt lgkmcnt(14)
    s_nop 0
    v_mfma_f32_16x16x32_bf16 v[0:3], v[100:103], a[64:67], 0
    v_exp_f32 v192, v192
    s_waitcnt lgkmcnt(12)
    v_mfma_f32_16x16x32_bf16 v[4:7], v[100:103], a[76:79], 0
    v_exp_f32 v193, v193
    s_waitcnt lgkmcnt(10)
    v_mfma_f32_16x16x32_bf16 v[8:11], v[100:103], a[80:83], 0
    v_exp_f32_e64 v194, v194
    s_waitcnt lgkmcnt(8)
    v_mfma_f32_16x16x32_bf16 v[12:15], v[100:103], a[92:95], 0
    s_waitcnt lgkmcnt(0)
    v_cvt_pk_bf16_f32 v169, v82, v83
    v_cvt_pk_bf16_f32 v104, v192, v193
    v_mfma_f32_16x16x32_bf16 v[16:19], v[100:103], a[96:99], 0
    buffer_load_dwordx4 v252, s[12:15], s23 offen offset:3216 lds
    v_mfma_f32_16x16x32_bf16 v[20:23], v[100:103], a[108:111], 0
    v_exp_f32 v195, v195
    v_mfma_f32_16x16x32_bf16 v[24:27], v[100:103], a[112:115], 0
    v_exp_f32 v196, v196
    v_mfma_f32_16x16x32_bf16 v[28:31], v[100:103], a[124:127], 0
    v_cvt_pk_bf16_f32 v170, v84, v85
    v_cvt_pk_bf16_f32 v105, v194, v195
    v_smfmac_f32_16x16x64_bf16 v[240:243], a[148:151], v[96:103], v255
    v_cvt_pk_bf16_f32 v171, v86, v87
    v_mfma_f32_16x16x32_bf16 v[200:203], a[0:3], v[160:163], v[232:235]
    v_exp_f32 v197, v197
    v_mfma_f32_16x16x32_bf16 v[200:203], a[4:7], v[164:167], v[200:203]
    v_exp_f32 v198, v198
    v_mfma_f32_16x16x32_bf16 v[200:203], a[8:11], v[168:171], v[200:203]
    v_cvt_pk_bf16_f32 v172, v88, v89
    v_cvt_pk_bf16_f32 v173, v90, v91
    v_cvt_pk_bf16_f32 v174, v92, v93
    v_cvt_pk_bf16_f32 v175, v94, v95
    v_cvt_pk_bf16_f32 v106, v196, v197
    s_nop 0
    v_mfma_f32_16x16x32_bf16 v[200:203], a[12:15], v[172:175], v[200:203]
    v_exp_f32 v199, v199
    v_mfma_f32_16x16x32_bf16 v[204:207], a[16:19], v[172:175], v[232:235]
    v_cvt_pk_bf16_f32 v107, v198, v199
    v_mfma_f32_16x16x32_bf16 v[204:207], a[20:23], v[168:171], v[204:207]
    v_exp_f32 v200, v200
    v_add_u32 v248, s35, v248
    v_mfma_f32_16x16x32_bf16 v[204:207], a[24:27], v[164:167], v[204:207]
    s_waitcnt vmcnt(20)
    v_exp_f32 v201, v201
    v_mfma_f32_16x16x32_bf16 v[204:207], a[28:31], v[160:163], v[204:207]
    s_barrier
    v_exp_f32 v202, v202
    v_mfma_f32_16x16x32_bf16 v[32:35], v[104:107], a[64:67], 0
    s_mov_b32 s22, s24
    s_add_u32 s23, s24, s25
    ds_read_b128 a[0:3], v248 offset:0
    ds_read_b128 a[4:7], v248 offset:64
    v_mfma_f32_16x16x32_bf16 v[36:39], v[104:107], a[76:79], 0
    s_add_u32 s24, s23, s25
    s_mov_b32 s32, s31
    ds_read_b128 a[8:11], v248 offset:128
    ds_read_b128 a[12:15], v248 offset:192
    v_mfma_f32_16x16x32_bf16 v[40:43], v[104:107], a[80:83], 0
    s_mov_b32 m0, s31
    ds_read_b128 a[16:19], v248 offset:704
    ds_read_b128 a[20:23], v248 offset:640
    v_mfma_f32_16x16x32_bf16 v[44:47], v[104:107], a[92:95], 0
    s_nop 0
    ds_read_b128 a[24:27], v248 offset:576
    ds_read_b128 a[28:31], v248 offset:512
    buffer_load_dwordx4 v250, s[8:11], s22 offen offset:0 lds
    v_mfma_f32_16x16x32_bf16 v[48:51], v[104:107], a[96:99], 0
    ds_read_b128 a[32:35], v248 offset:17536
    ds_read_b128 a[36:39], v248 offset:17600
    v_mfma_f32_16x16x32_bf16 v[52:55], v[104:107], a[108:111], 0
    ds_read_b128 a[40:43], v248 offset:17664
    ds_read_b128 a[44:47], v248 offset:17728
    v_mfma_f32_16x16x32_bf16 v[56:59], v[104:107], a[112:115], 0
    ds_read_b128 a[48:51], v248 offset:18240
    ds_read_b128 a[52:55], v248 offset:18176
    buffer_load_dwordx4 v251, s[8:11], s22 offen offset:1152 lds
    v_mfma_f32_16x16x32_bf16 v[60:63], v[104:107], a[124:127], 0
    ds_read_b128 a[56:59], v248 offset:18112
    ds_read_b128 a[60:63], v248 offset:18048
    v_smfmac_f32_16x16x64_bf16 v[240:243], a[152:155], v[104:111], v255
    s_waitcnt lgkmcnt(14)
    v_cvt_pk_bf16_f32 v116, v200, v201
    v_mfma_f32_16x16x32_bf16 v[192:195], a[0:3], v[128:131], v[224:227]
    s_nop 0
    buffer_load_dwordx4 v250, s[12:15], s22 offen offset:2176 lds
    v_mfma_f32_16x16x32_bf16 v[192:195], a[4:7], v[132:135], v[192:195]
    s_waitcnt lgkmcnt(12)
    v_exp_f32 v203, v203
    v_add_u32_e64 v249, s35, v249
    v_mfma_f32_16x16x32_bf16 v[192:195], a[8:11], v[136:139], v[192:195]
    v_exp_f32 v204, v204
    v_mfma_f32_16x16x32_bf16 v[192:195], a[12:15], v[140:143], v[192:195]
    s_waitcnt lgkmcnt(10)
    buffer_load_dwordx4 v252, s[12:15], s22 offen offset:3216 lds
    v_mfma_f32_16x16x32_bf16 v[196:199], a[16:19], v[140:143], v[224:227]
    v_cvt_pk_bf16_f32 v117, v202, v203
    v_exp_f32_e64 v205, v205
    v_mfma_f32_16x16x32_bf16 v[196:199], a[20:23], v[136:139], v[196:199]
    s_waitcnt lgkmcnt(8)
    s_add_i32 s32, s32, 17536
    s_mov_b32 m0, s32
    v_mfma_f32_16x16x32_bf16 v[196:199], a[24:27], v[132:135], v[196:199]
    s_mov_b32 s14, 0x13da880
    v_exp_f32 v206, v206
    v_mfma_f32_16x16x32_bf16 v[196:199], a[28:31], v[128:131], v[196:199]
    s_waitcnt lgkmcnt(6)
    buffer_load_dwordx4 v250, s[8:11], s23 offen offset:0 lds
    v_mfma_f32_16x16x32_bf16 v[200:203], a[32:35], v[128:131], v[224:227]
    v_cvt_pk_bf16_f32 v118, v204, v205
    v_exp_f32 v207, v207
    v_mfma_f32_16x16x32_bf16 v[200:203], a[36:39], v[132:135], v[200:203]
    s_waitcnt lgkmcnt(4)
    v_cvt_pk_bf16_f32 v119, v206, v207
    v_exp_f32 v192, v192
    v_mfma_f32_16x16x32_bf16 v[200:203], a[40:43], v[136:139], v[200:203]
    buffer_load_dwordx4 v251, s[8:11], s23 offen offset:1152 lds
    v_mfma_f32_16x16x32_bf16 v[200:203], a[44:47], v[140:143], v[200:203]
    s_waitcnt lgkmcnt(2)
    v_exp_f32 v193, v193
    v_mfma_f32_16x16x32_bf16 v[204:207], a[48:51], v[140:143], v[224:227]
    v_exp_f32 v194, v194
    v_mfma_f32_16x16x32_bf16 v[204:207], a[52:55], v[136:139], v[204:207]
    s_waitcnt lgkmcnt(0)
    v_exp_f32 v195, v195
    v_mfma_f32_16x16x32_bf16 v[204:207], a[56:59], v[132:135], v[204:207]
    v_cvt_pk_bf16_f32 v100, v192, v193
    v_cvt_pk_bf16_f32 v101, v194, v195
    v_mfma_f32_16x16x32_bf16 v[204:207], a[60:63], v[128:131], v[204:207]
    v_exp_f32_e64 v196, v196
    v_mfma_f32_16x16x32_bf16 v[64:67], v[116:119], a[64:67], 0
    ds_read_b64_tr_b16 a[64:65], v249 offset:2176
    ds_read_b64_tr_b16 a[66:67], v249 offset:2688
    ds_read_b64_tr_b16 a[68:69], v249 offset:19712
    ds_read_b64_tr_b16 a[70:71], v249 offset:20224
    v_mfma_f32_16x16x32_bf16 v[68:71], v[116:119], a[76:79], 0
    ds_read_b64_tr_b16 a[72:73], v249 offset:19728
    ds_read_b64_tr_b16 a[74:75], v249 offset:20240
    ds_read_b64_tr_b16 a[76:77], v249 offset:2192
    ds_read_b64_tr_b16 a[78:79], v249 offset:2704
    v_mfma_f32_16x16x32_bf16 v[72:75], v[116:119], a[80:83], 0
    ds_read_b64_tr_b16 a[80:81], v249 offset:2208
    ds_read_b64_tr_b16 a[82:83], v249 offset:2720
    ds_read_b64_tr_b16 a[84:85], v249 offset:19744
    ds_read_b64_tr_b16 a[86:87], v249 offset:20256
    v_mfma_f32_16x16x32_bf16 v[76:79], v[116:119], a[92:95], 0
    ds_read_b64_tr_b16 a[88:89], v249 offset:19760
    ds_read_b64_tr_b16 a[90:91], v249 offset:20272
    ds_read_b64_tr_b16 a[92:93], v249 offset:2224
    ds_read_b64_tr_b16 a[94:95], v249 offset:2736
    v_mfma_f32_16x16x32_bf16 v[80:83], v[116:119], a[96:99], 0
    v_exp_f32 v197, v197
    v_mfma_f32_16x16x32_bf16 v[84:87], v[116:119], a[108:111], 0
    v_exp_f32 v198, v198
    v_mfma_f32_16x16x32_bf16 v[88:91], v[116:119], a[112:115], 0
    v_exp_f32_e64 v199, v199
    v_mfma_f32_16x16x32_bf16 v[92:95], v[116:119], a[124:127], 0
    v_cvt_pk_bf16_f32 v102, v196, v197
    v_cvt_pk_bf16_f32 v103, v198, v199
    v_smfmac_f32_16x16x64_bf16 v[244:247], a[148:151], v[112:119], v255
    v_exp_f32 v200, v200
    v_exp_f32 v201, v201
    v_exp_f32 v202, v202
    v_exp_f32 v203, v203
    v_cvt_pk_bf16_f32 v96, v200, v201
    v_cvt_pk_bf16_f32 v97, v202, v203
    v_exp_f32 v204, v204
    s_branch L_loop_3
L_hot_end:
L_end:
    s_endpgm
L_redo:
    s_mov_b32 s54, 1
    s_waitcnt vmcnt(0)
    s_barrier
    s_branch L_restart
L_maxpass2:
    s_mov_b32 s72, s36
    s_mov_b32 s75, s77
    s_mov_b32 s57, 1
L_maxpass:
    s_nop 1
    v_mbcnt_lo_u32_b32 v36, -1, 0
    v_mbcnt_hi_u32_b32 v36, -1, v36
    v_lshrrev_b32 v37, 4, v36
    v_lshlrev_b32 v37, 4, v37
    v_and_b32 v38, 15, v36
    v_lshl_add_u32 v41, v38, 12, v37
    v_and_b32 v38, 3, v36
    v_bfe_u32 v39, v36, 2, 2
    v_lshl_add_u32 v38, v38, 2, v39
    v_lshl_add_u32 v40, v38, 12, v37
    s_add_u32 s40, s73, 0
    buffer_load_dwordx4 v[64:67], v40, s[4:7], s40 offen offset:0
    buffer_load_dwordx4 v[68:71], v40, s[4:7], s40 offen offset:64
    buffer_load_dwordx4 v[72:75], v40, s[4:7], s40 offen offset:128
    buffer_load_dwordx4 v[76:79], v40, s[4:7], s40 offen offset:192
    v_mov_b32 v32, 0xff800000
    s_add_u32 s40, s73, 65536
    buffer_load_dwordx4 v[80:83], v40, s[4:7], s40 offen offset:0
    buffer_load_dwordx4 v[84:87], v40, s[4:7], s40 offen offset:64
    buffer_load_dwordx4 v[88:91], v40, s[4:7], s40 offen offset:128
    buffer_load_dwordx4 v[92:95], v40, s[4:7], s40 offen offset:192
    v_mov_b32 v33, 0xff800000
    s_add_u32 s40, s73, 131072
    buffer_load_dwordx4 v[96:99], v40, s[4:7], s40 offen offset:0
    buffer_load_dwordx4 v[100:103], v40, s[4:7], s40 offen offset:64
    buffer_load_dwordx4 v[104:107], v40, s[4:7], s40 offen offset:128
    buffer_load_dwordx4 v[108:111], v40, s[4:7], s40 offen offset:192
    v_mov_b32 v34, 0xff800000
    s_add_u32 s40, s73, 196608
    buffer_load_dwordx4 v[112:115], v40, s[4:7], s40 offen offset:0
    buffer_load_dwordx4 v[116:119], v40, s[4:7], s40 offen offset:64
    buffer_load_dwordx4 v[120:123], v40, s[4:7], s40 offen offset:128
    buffer_load_dwordx4 v[124:127], v40, s[4:7], s40 offen offset:192
    v_mov_b32 v35, 0xff800000
    s_waitcnt vmcnt(0)
    v_mfma_f32_4x4x4_16b_bf16 v[0:3], a[156:157], v[64:65], 0
    v_mfma_f32_4x4x4_16b_bf16 v[4:7], a[156:157], v[66:67], 0
    v_mfma_f32_4x4x4_16b_bf16 v[8:11], a[156:157], v[68:69], 0
    v_mfma_f32_4x4x4_16b_bf16 v[0:3], a[158:159], v[64:65], v[0:3]
    v_mfma_f32_4x4x4_16b_bf16 v[12:15], a[156:157], v[70:71], 0
    v_mfma_f32_4x4x4_16b_bf16 v[4:7], a[158:159], v[66:67], v[4:7]
    v_mfma_f32_4x4x4_16b_bf16 v[16:19], a[156:157], v[72:73], 0
    v_cvt_pk_bf16_f32 v64, v0, v1
    v_mfma_f32_4x4x4_16b_bf16 v[8:11], a[158:159], v[68:69], v[8:11]
    v_cvt_pk_bf16_f32 v65, v2, v3
    v_mfma_f32_4x4x4_16b_bf16 v[20:23], a[156:157], v[74:75], 0
    v_cvt_pk_bf16_f32 v66, v4, v5
    v_mfma_f32_4x4x4_16b_bf16 v[12:15], a[158:159], v[70:71], v[12:15]
    v_cvt_pk_bf16_f32 v67, v6, v7
    v_mfma_f32_4x4x4_16b_bf16 v[24:27], a[156:157], v[76:77], 0
    v_cvt_pk_bf16_f32 v68, v8, v9
    v_mfma_f32_4x4x4_16b_bf16 v[16:19], a[158:159], v[72:73], v[16:19]
    v_cvt_pk_bf16_f32 v69, v10, v11
    v_mfma_f32_4x4x4_16b_bf16 v[28:31], a[156:157], v[78:79], 0
    v_cvt_pk_bf16_f32 v70, v12, v13
    v_mfma_f32_4x4x4_16b_bf16 v[20:23], a[158:159], v[74:75], v[20:23]
    v_cvt_pk_bf16_f32 v71, v14, v15
    v_mfma_f32_4x4x4_16b_bf16 v[24:27], a[158:159], v[76:77], v[24:27]
    v_cvt_pk_bf16_f32 v72, v16, v17
    v_mfma_f32_4x4x4_16b_bf16 v[28:31], a[158:159], v[78:79], v[28:31]
    v_cvt_pk_bf16_f32 v73, v18, v19
    v_cvt_pk_bf16_f32 v74, v20, v21
    v_cvt_pk_bf16_f32 v75, v22, v23
    v_cvt_pk_bf16_f32 v76, v24, v25
    v_cvt_pk_bf16_f32 v77, v26, v27
    v_cvt_pk_bf16_f32 v78, v28, v29
    v_cvt_pk_bf16_f32 v79, v30, v31
    v_mfma_f32_4x4x4_16b_bf16 v[0:3], a[156:157], v[80:81], 0
    v_mfma_f32_4x4x4_16b_bf16 v[4:7], a[156:157], v[82:83], 0
    v_mfma_f32_4x4x4_16b_bf16 v[8:11], a[156:157], v[84:85], 0
    v_mfma_f32_4x4x4_16b_bf16 v[0:3], a[158:159], v[80:81], v[0:3]
    v_mfma_f32_4x4x4_16b_bf16 v[12:15], a[156:157], v[86:87], 0
    v_mfma_f32_4x4x4_16b_bf16 v[4:7], a[158:159], v[82:83], v[4:7]
    v_mfma_f32_4x4x4_16b_bf16 v[16:19], a[156:157], v[88:89], 0
    v_cvt_pk_bf16_f32 v80, v0, v1
    v_mfma_f32_4x4x4_16b_bf16 v[8:11], a[158:159], v[84:85], v[8:11]
    v_cvt_pk_bf16_f32 v81, v2, v3
    v_mfma_f32_4x4x4_16b_bf16 v[20:23], a[156:157], v[90:91], 0
    v_cvt_pk_bf16_f32 v82, v4, v5
    v_mfma_f32_4x4x4_16b_bf16 v[12:15], a[158:159], v[86:87], v[12:15]
    v_cvt_pk_bf16_f32 v83, v6, v7
    v_mfma_f32_4x4x4_16b_bf16 v[24:27], a[156:157], v[92:93], 0
    v_cvt_pk_bf16_f32 v84, v8, v9
    v_mfma_f32_4x4x4_16b_bf16 v[16:19], a[158:159], v[88:89], v[16:19]
    v_cvt_pk_bf16_f32 v85, v10, v11
    v_mfma_f32_4x4x4_16b_bf16 v[28:31], a[156:157], v[94:95], 0
    v_cvt_pk_bf16_f32 v86, v12, v13
    v_mfma_f32_4x4x4_16b_bf16 v[20:23], a[158:159], v[90:91], v[20:23]
    v_cvt_pk_bf16_f32 v87, v14, v15
    v_mfma_f32_4x4x4_16b_bf16 v[24:27], a[158:159], v[92:93], v[24:27]
    v_cvt_pk_bf16_f32 v88, v16, v17
    v_mfma_f32_4x4x4_16b_bf16 v[28:31], a[158:159], v[94:95], v[28:31]
    v_cvt_pk_bf16_f32 v89, v18, v19
    v_cvt_pk_bf16_f32 v90, v20, v21
    v_cvt_pk_bf16_f32 v91, v22, v23
    v_cvt_pk_bf16_f32 v92, v24, v25
    v_cvt_pk_bf16_f32 v93, v26, v27
    v_cvt_pk_bf16_f32 v94, v28, v29
    v_cvt_pk_bf16_f32 v95, v30, v31
    v_mfma_f32_4x4x4_16b_bf16 v[0:3], a[156:157], v[96:97], 0
    v_mfma_f32_4x4x4_16b_bf16 v[4:7], a[156:157], v[98:99], 0
    v_mfma_f32_4x4x4_16b_bf16 v[8:11], a[156:157], v[100:101], 0
    v_mfma_f32_4x4x4_16b_bf16 v[0:3], a[158:159], v[96:97], v[0:3]
    v_mfma_f32_4x4x4_16b_bf16 v[12:15], a[156:157], v[102:103], 0
    v_mfma_f32_4x4x4_16b_bf16 v[4:7], a[158:159], v[98:99], v[4:7]
    v_mfma_f32_4x4x4_16b_bf16 v[16:19], a[156:157], v[104:105], 0
    v_cvt_pk_bf16_f32 v96, v0, v1
    v_mfma_f32_4x4x4_16b_bf16 v[8:11], a[158:159], v[100:101], v[8:11]
    v_cvt_pk_bf16_f32 v97, v2, v3
    v_mfma_f32_4x4x4_16b_bf16 v[20:23], a[156:157], v[106:107], 0
    v_cvt_pk_bf16_f32 v98, v4, v5
    v_mfma_f32_4x4x4_16b_bf16 v[12:15], a[158:159], v[102:103], v[12:15]
    v_cvt_pk_bf16_f32 v99, v6, v7
    v_mfma_f32_4x4x4_16b_bf16 v[24:27], a[156:157], v[108:109], 0
    v_cvt_pk_bf16_f32 v100, v8, v9
    v_mfma_f32_4x4x4_16b_bf16 v[16:19], a[158:159], v[104:105], v[16:19]
    v_cvt_pk_bf16_f32 v101, v10, v11
    v_mfma_f32_4x4x4_16b_bf16 v[28:31], a[156:157], v[110:111], 0
    v_cvt_pk_bf16_f32 v102, v12, v13
    v_mfma_f32_4x4x4_16b_bf16 v[20:23], a[158:159], v[106:107], v[20:23]
    v_cvt_pk_bf16_f32 v103, v14, v15
    v_mfma_f32_4x4x4_16b_bf16 v[24:27], a[158:159], v[108:109], v[24:27]
    v_cvt_pk_bf16_f32 v104, v16, v17
    v_mfma_f32_4x4x4_16b_bf16 v[28:31], a[158:159], v[110:111], v[28:31]
    v_cvt_pk_bf16_f32 v105, v18, v19
    v_cvt_pk_bf16_f32 v106, v20, v21
    v_cvt_pk_bf16_f32 v107, v22, v23
    v_cvt_pk_bf16_f32 v108, v24, v25
    v_cvt_pk_bf16_f32 v109, v26, v27
    v_cvt_pk_bf16_f32 v110, v28, v29
    v_cvt_pk_bf16_f32 v111, v30, v31
    v_mfma_f32_4x4x4_16b_bf16 v[0:3], a[156:157], v[112:113], 0
    v_mfma_f32_4x4x4_16b_bf16 v[4:7], a[156:157], v[114:115], 0
    v_mfma_f32_4x4x4_16b_bf16 v[8:11], a[156:157], v[116:117], 0
    v_mfma_f32_4x4x4_16b_bf16 v[0:3], a[158:159], v[112:113], v[0:3]
    v_mfma_f32_4x4x4_16b_bf16 v[12:15], a[156:157], v[118:119], 0
    v_mfma_f32_4x4x4_16b_bf16 v[4:7], a[158:159], v[114:115], v[4:7]
    v_mfma_f32_4x4x4_16b_bf16 v[16:19], a[156:157], v[120:121], 0
    v_cvt_pk_bf16_f32 v112, v0, v1
    v_mfma_f32_4x4x4_16b_bf16 v[8:11], a[158:159], v[116:117], v[8:11]
    v_cvt_pk_bf16_f32 v113, v2, v3
    v_mfma_f32_4x4x4_16b_bf16 v[20:23], a[156:157], v[122:123], 0
    v_cvt_pk_bf16_f32 v114, v4, v5
    v_mfma_f32_4x4x4_16b_bf16 v[12:15], a[158:159], v[118:119], v[12:15]
    v_cvt_pk_bf16_f32 v115, v6, v7
    v_mfma_f32_4x4x4_16b_bf16 v[24:27], a[156:157], v[124:125], 0
    v_cvt_pk_bf16_f32 v116, v8, v9
    v_mfma_f32_4x4x4_16b_bf16 v[16:19], a[158:159], v[120:121], v[16:19]
    v_cvt_pk_bf16_f32 v117, v10, v11
    v_mfma_f32_4x4x4_16b_bf16 v[28:31], a[156:157], v[126:127], 0
    v_cvt_pk_bf16_f32 v118, v12, v13
    v_mfma_f32_4x4x4_16b_bf16 v[20:23], a[158:159], v[122:123], v[20:23]
    v_cvt_pk_bf16_f32 v119, v14, v15
    v_mfma_f32_4x4x4_16b_bf16 v[24:27], a[158:159], v[124:125], v[24:27]
    v_cvt_pk_bf16_f32 v120, v16, v17
    v_mfma_f32_4x4x4_16b_bf16 v[28:31], a[158:159], v[126:127], v[28:31]
    v_cvt_pk_bf16_f32 v121, v18, v19
    v_cvt_pk_bf16_f32 v122, v20, v21
    v_cvt_pk_bf16_f32 v123, v22, v23
    v_cvt_pk_bf16_f32 v124, v24, v25
    v_cvt_pk_bf16_f32 v125, v26, v27
    v_cvt_pk_bf16_f32 v126, v28, v29
    v_cvt_pk_bf16_f32 v127, v30, v31
    s_mov_b32 s40, s74
    s_mov_b32 s41, s72
    s_mov_b32 s42, s75
L_maxloop:
    s_add_u32 s43, s40, 65536
    buffer_load_dwordx4 a[64:67], v41, s[8:11], s40 offen offset:0
    buffer_load_dwordx4 a[68:71], v41, s[8:11], s40 offen offset:64
    buffer_load_dwordx4 a[72:75], v41, s[8:11], s40 offen offset:128
    buffer_load_dwordx4 a[76:79], v41, s[8:11], s40 offen offset:192
    buffer_load_dwordx4 a[80:83], v41, s[8:11], s43 offen offset:192
    buffer_load_dwordx4 a[84:87], v41, s[8:11], s43 offen offset:128
    buffer_load_dwordx4 a[88:91], v41, s[8:11], s43 offen offset:64
    buffer_load_dwordx4 a[92:95], v41, s[8:11], s43 offen offset:0
    s_waitcnt vmcnt(0)
    v_mfma_f32_16x16x32_bf16 v[0:3], a[64:67], v[64:67], 0
    v_mfma_f32_16x16x32_bf16 v[0:3], a[68:71], v[68:71], v[0:3]
    v_mfma_f32_16x16x32_bf16 v[0:3], a[72:75], v[72:75], v[0:3]
    v_mfma_f32_16x16x32_bf16 v[0:3], a[76:79], v[76:79], v[0:3]
    v_mfma_f32_16x16x32_bf16 v[4:7], a[80:83], v[76:79], 0
    v_mfma_f32_16x16x32_bf16 v[4:7], a[84:87], v[72:75], v[4:7]
    v_mfma_f32_16x16x32_bf16 v[4:7], a[88:91], v[68:71], v[4:7]
    v_mfma_f32_16x16x32_bf16 v[4:7], a[92:95], v[64:67], v[4:7]
    v_mfma_f32_16x16x32_bf16 v[8:11], a[64:67], v[80:83], 0
    v_mfma_f32_16x16x32_bf16 v[8:11], a[68:71], v[84:87], v[8:11]
    v_mfma_f32_16x16x32_bf16 v[8:11], a[72:75], v[88:91], v[8:11]
    v_mfma_f32_16x16x32_bf16 v[8:11], a[76:79], v[92:95], v[8:11]
    v_mfma_f32_16x16x32_bf16 v[12:15], a[80:83], v[92:95], 0
    v_mfma_f32_16x16x32_bf16 v[12:15], a[84:87], v[88:91], v[12:15]
    v_mfma_f32_16x16x32_bf16 v[12:15], a[88:91], v[84:87], v[12:15]
    v_mfma_f32_16x16x32_bf16 v[12:15], a[92:95], v[80:83], v[12:15]
    v_mfma_f32_16x16x32_bf16 v[16:19], a[64:67], v[96:99], 0
    v_mfma_f32_16x16x32_bf16 v[16:19], a[68:71], v[100:103], v[16:19]
    v_mfma_f32_16x16x32_bf16 v[16:19], a[72:75], v[104:107], v[16:19]
    v_mfma_f32_16x16x32_bf16 v[16:19], a[76:79], v[108:111], v[16:19]
    v_mfma_f32_16x16x32_bf16 v[20:23], a[80:83], v[108:111], 0
    v_mfma_f32_16x16x32_bf16 v[20:23], a[84:87], v[104:107], v[20:23]
    v_mfma_f32_16x16x32_bf16 v[20:23], a[88:91], v[100:103], v[20:23]
    v_mfma_f32_16x16x32_bf16 v[20:23], a[92:95], v[96:99], v[20:23]
    v_mfma_f32_16x16x32_bf16 v[24:27], a[64:67], v[112:115], 0
    v_mfma_f32_16x16x32_bf16 v[24:27], a[68:71], v[116:119], v[24:27]
    v_mfma_f32_16x16x32_bf16 v[24:27], a[72:75], v[120:123], v[24:27]
    v_mfma_f32_16x16x32_bf16 v[24:27], a[76:79], v[124:127], v[24:27]
    v_mfma_f32_16x16x32_bf16 v[28:31], a[80:83], v[124:127], 0
    v_mfma_f32_16x16x32_bf16 v[28:31], a[84:87], v[120:123], v[28:31]
    v_mfma_f32_16x16x32_bf16 v[28:31], a[88:91], v[116:119], v[28:31]
    v_mfma_f32_16x16x32_bf16 v[28:31], a[92:95], v[112:115], v[28:31]
    s_nop 8
    v_max3_f32 v32, v32, v0, v1
    v_max3_f32 v33, v33, v8, v9
    v_max3_f32 v34, v34, v16, v17
    v_max3_f32 v35, v35, v24, v25
    v_max3_f32 v32, v32, v2, v3
    v_max3_f32 v33, v33, v10, v11
    v_max3_f32 v34, v34, v18, v19
    v_max3_f32 v35, v35, v26, v27
    v_max3_f32 v32, v32, v4, v5
    v_max3_f32 v33, v33, v12, v13
    v_max3_f32 v34, v34, v20, v21
    v_max3_f32 v35, v35, v28, v29
    v_max3_f32 v32, v32, v6, v7
    v_max3_f32 v33, v33, v14, v15
    v_max3_f32 v34, v34, v22, v23
    v_max3_f32 v35, v35, v30, v31
    s_add_u32 s40, s40, s42
    s_mov_b32 s42, 0x20000
    s_sub_u32 s41, s41, 1
    s_cmp_lg_u32 s41, 0
    s_cbranch_scc1 L_maxloop
    v_mov_b32 v36, v32
    s_nop 1
    v_permlane16_swap_b32 v32, v36
    s_nop 1
    v_max_f32 v32, v32, v36
    v_mov_b32 v36, v32
    s_nop 1
    v_permlane32_swap_b32 v32, v36
    s_nop 1
    v_max_f32 v32, v32, v36
    v_sub_f32 v224, 0, v32
    v_sub_f32 v225, 0, v32
    v_sub_f32 v226, 0, v32
    v_sub_f32 v227, 0, v32
    v_mov_b32 v36, v33
    s_nop 1
    v_permlane16_swap_b32 v33, v36
    s_nop 1
    v_max_f32 v33, v33, v36
    v_mov_b32 v36, v33
    s_nop 1
    v_permlane32_swap_b32 v33, v36
    s_nop 1
    v_max_f32 v33, v33, v36
    v_sub_f32 v228, 0, v33
    v_sub_f32 v229, 0, v33
    v_sub_f32 v230, 0, v33
    v_sub_f32 v231, 0, v33
    v_mov_b32 v36, v34
    s_nop 1
    v_permlane16_swap_b32 v34, v36
    s_nop 1
    v_max_f32 v34, v34, v36
    v_mov_b32 v36, v34
    s_nop 1
    v_permlane32_swap_b32 v34, v36
    s_nop 1
    v_max_f32 v34, v34, v36
    v_sub_f32 v232, 0, v34
    v_sub_f32 v233, 0, v34
    v_sub_f32 v234, 0, v34
    v_sub_f32 v235, 0, v34
    v_mov_b32 v36, v35
    s_nop 1
    v_permlane16_swap_b32 v35, v36
    s_nop 1
    v_max_f32 v35, v35, v36
    v_mov_b32 v36, v35
    s_nop 1
    v_permlane32_swap_b32 v35, v36
    s_nop 1
    v_max_f32 v35, v35, v36
    v_sub_f32 v236, 0, v35
    v_sub_f32 v237, 0, v35
    v_sub_f32 v238, 0, v35
    v_sub_f32 v239, 0, v35
    s_nop 1
    s_cmp_eq_u32 s57, 0
    s_cbranch_scc1 L_go1
    s_cmp_eq_u32 s76, 7
    s_cbranch_scc1 L_first2p_3
    s_cmp_eq_u32 s76, 6
    s_cbranch_scc1 L_first2s_3
    s_branch L_first2p_2
.section .rodata,"a"
.p2align 6
.amdhsa_kernel standalone__varlen_attn_packed__ragged_kernel
  .amdhsa_next_free_vgpr 432
  .amdhsa_next_free_sgpr 102
  .amdhsa_accum_offset 256
  .amdhsa_group_segment_fixed_size 0
  .amdhsa_kernarg_size 56
  .amdhsa_user_sgpr_count 2
  .amdhsa_user_sgpr_kernarg_segment_ptr 1
  .amdhsa_system_sgpr_workgroup_id_x 1
.end_amdhsa_kernel
```
